```python
import torch

def _softmax(x, axis=-1):
    return torch.softmax(x, dim=axis)
def _gelu(x):
    return torch.nn.functional.gelu(x, approximate="tanh")
def _silu(x):
    return torch.nn.functional.silu(x)
def _sigmoid(x):
    return torch.sigmoid(x)
def _layernorm(x, axis=-1, eps=1e-5):
    m = x.mean(dim=axis, keepdim=True)
    v = x.var(dim=axis, keepdim=True, unbiased=False)
    return (x - m) / torch.sqrt(v + eps)
def _scatter_add(tgt, idx, src, axis=0):
    return tgt.clone().index_add_(axis, idx, src)
def _segment_sum(src, seg, n):
    out = torch.zeros((n,) + src.shape[1:], dtype=src.dtype)
    return out.index_add_(0, seg, src)
def _pad(x, pw):
    flat = tuple(v for pair in reversed(pw) for v in pair)
    return torch.nn.functional.pad(x, flat)

kernel_name = 'interleave_layers__linear_kernel_hedgehog__mixer_channel_mlp__prompt'

def setup_inputs():

    _w = (lambda a: (lambda t: t.to(torch.bfloat16) if t.is_floating_point() else t)(torch.as_tensor(a)))
    def _A_setup():
        B, S, D, H = 1, 2048, 640, 32
        Dh = D // H
        return {
            "x": _w((lambda *s: torch.randn(*s, dtype=torch.bfloat16) * 0.05)(B, S, D)),
            "wqkv": _w((lambda *s: torch.randn(*s, dtype=torch.bfloat16) * 0.4)(D, 3 * D)),
            "w_phi": _w((lambda *s: torch.randn(*s, dtype=torch.bfloat16) * 0.4)(H, Dh, Dh) * (Dh ** -0.5)),
            "wo": _w((lambda *s: torch.randn(*s, dtype=torch.bfloat16) * 0.05)(D, D)),
        }
    _A_in = _A_setup()

    def _B_setup():
        B, S, D, F = 1, 2048, 640, 1536
        return {
            "x": _w((lambda *s: torch.randn(*s, dtype=torch.bfloat16) * 0.05)(B, S, D)),
            "w1": _w((lambda *s: torch.randn(*s, dtype=torch.bfloat16) * 3.2)(D, F) * (D ** -0.5)),
            "b1": _w((lambda *s: torch.randn(*s, dtype=torch.bfloat16) * 0.8)(F)),
            "w2": _w((lambda *s: torch.randn(*s, dtype=torch.bfloat16) * 0.8)(F, D) * (F ** -0.5)),
            "b2": _w((lambda *s: torch.randn(*s, dtype=torch.bfloat16) * 0.8)(D)),
        }
    _B_in = _B_setup()

    return {
        "A_x": _A_in["x"],
        "A_wqkv": _A_in["wqkv"],
        "A_w_phi": _A_in["w_phi"],
        "A_wo": _A_in["wo"],
        "B_x": _B_in["x"],
        "B_w1": _B_in["w1"],
        "B_b1": _B_in["b1"],
        "B_w2": _B_in["w2"],
        "B_b2": _B_in["b2"],
    }

def reference(A_x, A_wqkv, A_w_phi, A_wo, B_x, B_w1, B_b1, B_w2, B_b2):
    def _A_ref(x, wqkv, w_phi, wo):
        B, S, D = x.shape
        H = 32; Dh = D // H
        qkv = (lambda x, *d: x.permute(*d))((x @ wqkv).reshape(B, S, 3, H, Dh), 2, 0, 3, 1, 4)
        q, k, v = qkv[0], qkv[1], qkv[2]
        pq = torch.einsum("bhsd,hdf->bhsf", q, w_phi)
        pk = torch.einsum("bhsd,hdf->bhsf", k, w_phi)
        phi_q = torch.concatenate([_softmax(pq, axis=-1), _softmax(-pq, axis=-1)], axis=-1)
        phi_k = torch.concatenate([_softmax(pk, axis=-1), _softmax(-pk, axis=-1)], axis=-1)
        kv = torch.einsum("bhsf,bhsd->bhfd", phi_k, v)
        z  = torch.einsum("bhsf->bhf", phi_k)
        num = torch.einsum("bhqf,bhfd->bhqd", phi_q, kv)
        den = torch.einsum("bhqf,bhf->bhq", phi_q, z)[..., None] + 1e-6
        o = num / den
        return (lambda x, *d: x.permute(*d))(o, 0, 2, 1, 3).reshape(B, S, D) @ wo

    def _B_ref(x, w1, b1, w2, b2):
        y = _layernorm(x, axis=-1)
        h = _gelu(torch.einsum("bsd,df->bsf", y, w1) + b1)
        return torch.einsum("bsf,fd->bsd", h, w2) + b2

    x = A_x
    x = x + _A_ref(_layernorm(x, axis=-1), A_wqkv, A_w_phi, A_wo)
    x = x + _B_ref(_layernorm(x, axis=-1), B_w1, B_b1, B_w2, B_b2)
    x = x + _A_ref(_layernorm(x, axis=-1), A_wqkv, A_w_phi, A_wo)
    x = x + _B_ref(_layernorm(x, axis=-1), B_w1, B_b1, B_w2, B_b2)
    return x
```

```asm
; @launch grid=(256,1,1) block=(256,1,1) lds=163840
.amdgcn_target "amdgcn-amd-amdhsa--gfx950"
.text
.globl interleave_layers__linear_kernel_hedgehog__mixer_channel_mlp__prompt_kernel
.p2align 8
.type interleave_layers__linear_kernel_hedgehog__mixer_channel_mlp__prompt_kernel,@function
interleave_layers__linear_kernel_hedgehog__mixer_channel_mlp__prompt_kernel:
    s_cmp_ge_u32 s2, 256
    s_cbranch_scc1 L_end
    s_getpc_b64 s[94:95]
    v_lshlrev_b32 v250, 4, v0
    global_load_dwordx4 v[200:203], v250, s[94:95]
    v_add_u32 v250, 0x1000, v250
    global_load_dwordx4 v[204:207], v250, s[94:95]
    v_add_u32 v250, 0x1000, v250
    global_load_dwordx4 v[208:211], v250, s[94:95]
    v_add_u32 v250, 0x1000, v250
    global_load_dwordx4 v[212:215], v250, s[94:95]
    v_add_u32 v250, 0x1000, v250
    global_load_dwordx4 v[216:219], v250, s[94:95]
    v_add_u32 v250, 0x1000, v250
    global_load_dwordx4 v[220:223], v250, s[94:95]
    v_add_u32 v250, 0x1000, v250
    global_load_dwordx4 v[224:227], v250, s[94:95]
    v_add_u32 v250, 0x1000, v250
    global_load_dwordx4 v[228:231], v250, s[94:95]
    v_add_u32 v250, 0x1000, v250
    global_load_dwordx4 v[232:235], v250, s[94:95]
    v_add_u32 v250, 0x1000, v250
    global_load_dwordx4 v[236:239], v250, s[94:95]
    s_load_dwordx8 s[40:47], s[0:1], 0
    s_load_dwordx4 s[48:51], s[0:1], 40
    s_load_dwordx4 s[52:55], s[0:1], 56
    s_load_dwordx4 s[56:59], s[0:1], 72
    s_load_dwordx2 s[60:61], s[0:1], 88
    v_and_b32 v1, 63, v0
    v_lshlrev_b32 v2, 4, v1
    v_and_b32 v3, 31, v1
    v_lshrrev_b32 v4, 5, v1
    v_lshrrev_b32 v5, 6, v0
    s_nop 0
    v_readfirstlane_b32 s24, v5
    s_and_b32 s32, s2, 7
    s_lshr_b32 s33, s2, 3
    s_lshr_b32 s34, s33, 4
    s_lshl_b32 s25, s32, 1
    s_add_u32 s25, s25, s34
    s_and_b32 s26, s33, 15
    s_and_b32 s27, s26, 1
    s_lshr_b32 s28, s26, 1
    s_mov_b32 s29, 0
    s_mov_b32 s31, 0
    s_mov_b32 s66, -1
    s_mov_b32 s67, 0
    s_mov_b32 s68, 0
    s_mov_b32 s69, -1
    s_getreg_b32 s62, hwreg(HW_REG_XCC_ID)
    s_and_b32 s62, s62, 15
    s_waitcnt lgkmcnt(0)
    s_mov_b32 s8, s60
    s_and_b32 s9, s61, 0xffff
    s_mov_b32 s10, 268435456
    s_mov_b32 s11, 0x00020000
    s_mov_b32 s4, s60
    s_and_b32 s5, s61, 0xffff
    s_mov_b32 s6, s10
    s_mov_b32 s7, 0x00020000
    s_mov_b32 s16, s40
    s_and_b32 s17, s41, 0xffff
    s_mov_b32 s18, 2621440
    s_mov_b32 s19, 0x00020000
    s_mov_b32 s20, s58
    s_and_b32 s21, s59, 0xffff
    s_mov_b32 s22, 256
    s_mov_b32 s23, 0x00020000
    s_mov_b32 s12, s42
    s_and_b32 s13, s43, 0xffff
    s_mov_b32 s14, 256
    s_mov_b32 s15, 0x00020000
    s_add_u32 s29, s29, 0
    s_add_u32 s31, s31, 0
    s_mov_b32 s84, 0
    s_add_u32 s84, s84, 0
    s_or_b32 s32, s2, s24
    s_cmp_lg_u32 s32, 0
    s_cbranch_scc1 L_no_nonce
    s_memrealtime s[32:33]
    s_waitcnt lgkmcnt(0)
    s_and_b32 s32, s32, 0xfffffff0
    s_or_b32 s32, s32, 16
    s_lshl_b32 s32, s32, 1
    s_or_b32 s32, s32, 32
    v_mov_b32 v5, s32
    v_mov_b32 v6, 0
    s_mov_b64 s[64:65], exec
    s_mov_b64 exec, 1
    buffer_store_dword v5, v6, s[20:23], 0 offen sc1
    s_mov_b64 exec, s[64:65]
L_no_nonce:
    s_cmp_lt_u32 s2, 128
    s_cbranch_scc0 L_p0_b1
    s_lshr_b32 s32, s2, 3
    s_lshl_b32 s32, s32, 2
    s_add_u32 s32, s32, s24
    s_lshl_b32 s32, s32, 3
    s_and_b32 s33, s2, 7
    s_add_u32 s76, s32, s33
    s_branch L_p0_j1
L_p0_b1:
    s_sub_u32 s32, s2, 128
    s_lshl_b32 s32, s32, 2
    s_add_u32 s32, s32, s24
    s_add_u32 s76, s32, 512
L_p0_j1:
    s_mov_b32 s82, 3
    s_mul_i32 s87, s24, 10240
    s_add_u32 s87, s87, 0
    s_mul_i32 s84, s76, 5120
    s_add_u32 s84, s84, 65536
    s_cmp_lt_u32 s76, 512
    s_cbranch_scc0 L_j1_notq
    s_lshr_b32 s32, s76, 5
    s_and_b32 s34, s76, 7
    s_mov_b32 s12, s42
    s_and_b32 s13, s43, 0xffff
    s_mov_b32 s14, 2457600
    s_mov_b32 s15, 0x00020000
    s_mul_i32 s70, s34, 307200
    s_mul_i32 s35, s32, 80
    s_add_u32 s70, s70, s35
    s_lshr_b32 s35, s76, 3
    s_lshl_b32 s74, s35, 10
    s_lshl_b32 s35, s34, 2
    s_add_u32 s74, s74, s35
    s_add_u32 s83, s74, 10092544
    s_mov_b32 s82, 0
    s_mul_i32 s35, s24, 320
    v_add_u32 v16, s35, v1
    v_mul_u32_u24 v17, 4370, v16
    v_lshrrev_b32 v17, 16, v17
    v_mul_u32_u24 v18, 15, v17
    v_sub_u32 v18, v16, v18
    v_mul_u32_u24 v17, 3840, v17
    s_lshl_b32 s35, s35, 4
    s_add_u32 s35, s35, 40960
    v_lshlrev_b32 v19, 4, v18
    v_cmp_lt_u32 vcc, 4, v18
    s_nop 1
    v_cndmask_b32 v20, 0, 1, vcc
    v_cmp_lt_u32 vcc, 9, v18
    v_mul_u32_u24 v20, 1200, v20
    v_add_u32 v20, 1280, v20
    v_mov_b32 v21, -160
    v_cndmask_b32 v20, v20, v21, vcc
    v_add3_u32 v19, v19, v20, v17
    s_mov_b32 m0, s35
    s_nop 0
    buffer_load_dwordx4 v19, s[12:15], s70 offen lds
    s_add_u32 s35, s35, 1024
    v_add_u32 v18, 4, v18
    v_add_u32 v17, 15360, v17
    v_cmp_lt_u32 vcc, 14, v18
    v_subrev_u32 v19, 15, v18
    s_nop 0
    v_cndmask_b32 v18, v18, v19, vcc
    v_add_u32 v19, 3840, v17
    v_cndmask_b32 v17, v17, v19, vcc
    v_lshlrev_b32 v19, 4, v18
    v_cmp_lt_u32 vcc, 4, v18
    s_nop 1
    v_cndmask_b32 v20, 0, 1, vcc
    v_cmp_lt_u32 vcc, 9, v18
    v_mul_u32_u24 v20, 1200, v20
    v_add_u32 v20, 1280, v20
    v_mov_b32 v21, -160
    v_cndmask_b32 v20, v20, v21, vcc
    v_add3_u32 v19, v19, v20, v17
    s_mov_b32 m0, s35
    s_nop 0
    buffer_load_dwordx4 v19, s[12:15], s70 offen lds
    s_add_u32 s35, s35, 1024
    v_add_u32 v18, 4, v18
    v_add_u32 v17, 15360, v17
    v_cmp_lt_u32 vcc, 14, v18
    v_subrev_u32 v19, 15, v18
    s_nop 0
    v_cndmask_b32 v18, v18, v19, vcc
    v_add_u32 v19, 3840, v17
    v_cndmask_b32 v17, v17, v19, vcc
    v_lshlrev_b32 v19, 4, v18
    v_cmp_lt_u32 vcc, 4, v18
    s_nop 1
    v_cndmask_b32 v20, 0, 1, vcc
    v_cmp_lt_u32 vcc, 9, v18
    v_mul_u32_u24 v20, 1200, v20
    v_add_u32 v20, 1280, v20
    v_mov_b32 v21, -160
    v_cndmask_b32 v20, v20, v21, vcc
    v_add3_u32 v19, v19, v20, v17
    s_mov_b32 m0, s35
    s_nop 0
    buffer_load_dwordx4 v19, s[12:15], s70 offen lds
    s_add_u32 s35, s35, 1024
    v_add_u32 v18, 4, v18
    v_add_u32 v17, 15360, v17
    v_cmp_lt_u32 vcc, 14, v18
    v_subrev_u32 v19, 15, v18
    s_nop 0
    v_cndmask_b32 v18, v18, v19, vcc
    v_add_u32 v19, 3840, v17
    v_cndmask_b32 v17, v17, v19, vcc
    v_lshlrev_b32 v19, 4, v18
    v_cmp_lt_u32 vcc, 4, v18
    s_nop 1
    v_cndmask_b32 v20, 0, 1, vcc
    v_cmp_lt_u32 vcc, 9, v18
    v_mul_u32_u24 v20, 1200, v20
    v_add_u32 v20, 1280, v20
    v_mov_b32 v21, -160
    v_cndmask_b32 v20, v20, v21, vcc
    v_add3_u32 v19, v19, v20, v17
    s_mov_b32 m0, s35
    s_nop 0
    buffer_load_dwordx4 v19, s[12:15], s70 offen lds
    s_add_u32 s35, s35, 1024
    v_add_u32 v18, 4, v18
    v_add_u32 v17, 15360, v17
    v_cmp_lt_u32 vcc, 14, v18
    v_subrev_u32 v19, 15, v18
    s_nop 0
    v_cndmask_b32 v18, v18, v19, vcc
    v_add_u32 v19, 3840, v17
    v_cndmask_b32 v17, v17, v19, vcc
    v_lshlrev_b32 v19, 4, v18
    v_cmp_lt_u32 vcc, 4, v18
    s_nop 1
    v_cndmask_b32 v20, 0, 1, vcc
    v_cmp_lt_u32 vcc, 9, v18
    v_mul_u32_u24 v20, 1200, v20
    v_add_u32 v20, 1280, v20
    v_mov_b32 v21, -160
    v_cndmask_b32 v20, v20, v21, vcc
    v_add3_u32 v19, v19, v20, v17
    s_mov_b32 m0, s35
    s_nop 0
    buffer_load_dwordx4 v19, s[12:15], s70 offen lds
    v_lshrrev_b32 v18, 3, v3
    v_lshlrev_b32 v18, 2, v18
    v_and_b32 v19, 3, v3
    v_add_u32 v18, v18, v19
    s_lshl_b32 s35, s24, 4
    v_add_u32 v18, s35, v18
    v_mul_u32_u24 v19, 205, v18
    v_lshrrev_b32 v19, 11, v19
    v_mul_u32_u24 v20, 10, v19
    v_sub_u32 v20, v18, v20
    v_bfe_u32 v21, v3, 2, 1
    v_mul_u32_u24 v21, 10, v21
    v_add_u32 v20, v20, v21
    v_and_b32 v21, 1, v19
    v_mul_u32_u24 v21, 20, v21
    v_add_u32 v20, v20, v21
    v_lshlrev_b32 v20, 1, v20
    v_lshrrev_b32 v21, 1, v19
    v_mul_u32_u24 v21, 80, v21
    v_mul_u32_u24 v22, 1920, v4
    v_add3_u32 v20, v20, v21, v22
    v_cmp_gt_u32 vcc, 6, v19
    v_mov_b32 v21, 0x0c0c0c0c
    v_mov_b32 v22, 0x05040100
    v_cndmask_b32 v102, v21, v22, vcc
    v_cndmask_b32 v100, 0, v20, vcc
    s_branch L_j1_done
L_j1_notq:
    s_sub_u32 s35, s76, 512
    s_lshr_b32 s36, s35, 3
    s_and_b32 s37, s35, 7
    s_lshl_b32 s38, s36, 5
    v_add_u32 v16, s38, v3
    v_mul_u32_u24 v16, 1280, v16
    v_lshlrev_b32 v17, 4, v4
    v_add_u32 v16, v16, v17
    s_mul_i32 s38, s37, 160
    s_lshl_b32 s39, s35, 8
    s_add_u32 s83, s39, 25034752
    s_mov_b32 s82, 2
    buffer_load_dwordx4 v[24:27], v16, s[16:19], s38 offen offset:0
    buffer_load_dwordx4 v[28:31], v16, s[16:19], s38 offen offset:32
    buffer_load_dwordx4 v[32:35], v16, s[16:19], s38 offen offset:64
    buffer_load_dwordx4 v[36:39], v16, s[16:19], s38 offen offset:96
    buffer_load_dwordx4 v[40:43], v16, s[16:19], s38 offen offset:128
L_j1_done:
    s_add_u32 s82, s82, 0
    s_lshl_b32 s32, s2, 2
    s_add_u32 s32, s32, s24
    s_cmp_lt_u32 s2, 128
    s_cbranch_scc1 L_p0_r2lo
    s_sub_u32 s76, s32, 512
    s_add_u32 s76, s76, 1024
    s_cmp_lt_u32 s2, 224
    s_cbranch_scc1 L_p0_r2j
    s_sub_u32 s76, s32, 896
    s_add_u32 s76, s76, 1920
    s_cmp_lt_u32 s2, 232
    s_cbranch_scc1 L_p0_r2j
    s_mov_b32 s76, 4000
    s_branch L_p0_r2j
L_p0_r2lo:
    s_add_u32 s76, s32, 1408
L_p0_r2j:
    s_mov_b32 s94, s76
    s_waitcnt vmcnt(0)
    s_barrier
    v_mov_b32 v248, 0
    buffer_load_dword v249, v248, s[20:23], 0 offen sc1
    s_cmp_eq_u32 s82, 2
    s_cbranch_scc1 L_j1_fx
    ds_read_u16 v160, v100 offset:40960
    ds_read_u16 v161, v100 offset:41200
    ds_read_u16 v162, v100 offset:41440
    ds_read_u16 v163, v100 offset:41680
    ds_read_u16 v164, v100 offset:41920
    ds_read_u16 v165, v100 offset:42160
    ds_read_u16 v166, v100 offset:42400
    ds_read_u16 v167, v100 offset:42640
    ds_read_u16 v168, v100 offset:44800
    ds_read_u16 v169, v100 offset:45040
    ds_read_u16 v170, v100 offset:45280
    ds_read_u16 v171, v100 offset:45520
    ds_read_u16 v172, v100 offset:45760
    ds_read_u16 v173, v100 offset:46000
    ds_read_u16 v174, v100 offset:46240
    ds_read_u16 v175, v100 offset:46480
    ds_read_u16 v176, v100 offset:48640
    ds_read_u16 v177, v100 offset:48880
    ds_read_u16 v178, v100 offset:49120
    ds_read_u16 v179, v100 offset:49360
    ds_read_u16 v180, v100 offset:49600
    ds_read_u16 v181, v100 offset:49840
    ds_read_u16 v182, v100 offset:50080
    ds_read_u16 v183, v100 offset:50320
    ds_read_u16 v184, v100 offset:52480
    ds_read_u16 v185, v100 offset:52720
    ds_read_u16 v186, v100 offset:52960
    ds_read_u16 v187, v100 offset:53200
    ds_read_u16 v188, v100 offset:53440
    ds_read_u16 v189, v100 offset:53680
    ds_read_u16 v190, v100 offset:53920
    ds_read_u16 v191, v100 offset:54160
    ds_read_u16 v192, v100 offset:56320
    ds_read_u16 v193, v100 offset:56560
    ds_read_u16 v194, v100 offset:56800
    ds_read_u16 v195, v100 offset:57040
    ds_read_u16 v196, v100 offset:57280
    ds_read_u16 v197, v100 offset:57520
    ds_read_u16 v198, v100 offset:57760
    ds_read_u16 v199, v100 offset:58000
    s_waitcnt lgkmcnt(15)
    v_perm_b32 v224, v161, v160, v102
    v_perm_b32 v225, v163, v162, v102
    v_perm_b32 v226, v165, v164, v102
    v_perm_b32 v227, v167, v166, v102
    v_perm_b32 v228, v169, v168, v102
    v_perm_b32 v229, v171, v170, v102
    v_perm_b32 v230, v173, v172, v102
    v_perm_b32 v231, v175, v174, v102
    v_perm_b32 v232, v177, v176, v102
    v_perm_b32 v233, v179, v178, v102
    v_perm_b32 v234, v181, v180, v102
    v_perm_b32 v235, v183, v182, v102
    s_waitcnt lgkmcnt(14)
    v_perm_b32 v236, v185, v184, v102
    s_waitcnt lgkmcnt(12)
    v_perm_b32 v237, v187, v186, v102
    s_waitcnt lgkmcnt(10)
    v_perm_b32 v238, v189, v188, v102
    s_waitcnt lgkmcnt(8)
    v_perm_b32 v239, v191, v190, v102
    s_waitcnt lgkmcnt(6)
    v_perm_b32 v240, v193, v192, v102
    s_waitcnt lgkmcnt(4)
    v_perm_b32 v241, v195, v194, v102
    s_waitcnt lgkmcnt(2)
    v_perm_b32 v242, v197, v196, v102
    s_waitcnt lgkmcnt(0)
    v_perm_b32 v243, v199, v198, v102
    s_mov_b32 s77, s84
    buffer_store_dwordx4 v[224:227], v2, s[8:11], s77 offen sc1
    s_add_u32 s77, s77, 1024
    buffer_store_dwordx4 v[228:231], v2, s[8:11], s77 offen sc1
    s_add_u32 s77, s77, 1024
    buffer_store_dwordx4 v[232:235], v2, s[8:11], s77 offen sc1
    s_add_u32 s77, s77, 1024
    buffer_store_dwordx4 v[236:239], v2, s[8:11], s77 offen sc1
    s_add_u32 s77, s77, 1024
    buffer_store_dwordx4 v[240:243], v2, s[8:11], s77 offen sc1
    s_mov_b32 s77, 0x3f803f80
    v_dot2_f32_bf16 v244, v224, s77, 0
    v_dot2_f32_bf16 v245, v225, s77, 0
    v_dot2_f32_bf16 v246, v226, s77, 0
    v_dot2_f32_bf16 v247, v227, s77, 0
    v_dot2_f32_bf16 v244, v228, s77, v244
    v_dot2_f32_bf16 v245, v229, s77, v245
    v_dot2_f32_bf16 v246, v230, s77, v246
    v_dot2_f32_bf16 v247, v231, s77, v247
    v_dot2_f32_bf16 v244, v232, s77, v244
    v_dot2_f32_bf16 v245, v233, s77, v245
    v_dot2_f32_bf16 v246, v234, s77, v246
    v_dot2_f32_bf16 v247, v235, s77, v247
    v_dot2_f32_bf16 v244, v236, s77, v244
    v_dot2_f32_bf16 v245, v237, s77, v245
    v_dot2_f32_bf16 v246, v238, s77, v246
    v_dot2_f32_bf16 v247, v239, s77, v247
    v_dot2_f32_bf16 v244, v240, s77, v244
    v_dot2_f32_bf16 v245, v241, s77, v245
    v_dot2_f32_bf16 v246, v242, s77, v246
    v_dot2_f32_bf16 v247, v243, s77, v247
    s_nop 0
    v_add_f32 v244, v244, v245
    s_nop 0
    v_add_f32 v246, v246, v247
    v_add_f32 v244, v244, v246
    v_mov_b32 v246, v244
    s_nop 1
    v_permlane32_swap_b32 v244, v246
    v_add_f32 v244, v244, v246
    v_lshlrev_b32 v246, 5, v3
    s_mov_b64 exec, s[66:67]
    buffer_store_dword v244, v246, s[8:11], s83 offen sc1
    s_mov_b64 exec, -1
    s_branch L_j1_fend
L_j1_fx:
    s_mov_b32 s77, s84
    buffer_store_dwordx4 v[24:27], v2, s[8:11], s77 offen sc1
    s_add_u32 s77, s77, 1024
    buffer_store_dwordx4 v[28:31], v2, s[8:11], s77 offen sc1
    s_add_u32 s77, s77, 1024
    buffer_store_dwordx4 v[32:35], v2, s[8:11], s77 offen sc1
    s_add_u32 s77, s77, 1024
    buffer_store_dwordx4 v[36:39], v2, s[8:11], s77 offen sc1
    s_add_u32 s77, s77, 1024
    buffer_store_dwordx4 v[40:43], v2, s[8:11], s77 offen sc1
    s_mov_b32 s77, 0x3f803f80
    v_dot2_f32_bf16 v244, v24, s77, 0
    v_dot2_f32_bf16 v246, v24, v24, 0
    v_dot2_f32_bf16 v245, v25, s77, 0
    v_dot2_f32_bf16 v247, v25, v25, 0
    v_dot2_f32_bf16 v244, v26, s77, v244
    v_dot2_f32_bf16 v246, v26, v26, v246
    v_dot2_f32_bf16 v245, v27, s77, v245
    v_dot2_f32_bf16 v247, v27, v27, v247
    v_dot2_f32_bf16 v244, v28, s77, v244
    v_dot2_f32_bf16 v246, v28, v28, v246
    v_dot2_f32_bf16 v245, v29, s77, v245
    v_dot2_f32_bf16 v247, v29, v29, v247
    v_dot2_f32_bf16 v244, v30, s77, v244
    v_dot2_f32_bf16 v246, v30, v30, v246
    v_dot2_f32_bf16 v245, v31, s77, v245
    v_dot2_f32_bf16 v247, v31, v31, v247
    v_dot2_f32_bf16 v244, v32, s77, v244
    v_dot2_f32_bf16 v246, v32, v32, v246
    v_dot2_f32_bf16 v245, v33, s77, v245
    v_dot2_f32_bf16 v247, v33, v33, v247
    v_dot2_f32_bf16 v244, v34, s77, v244
    v_dot2_f32_bf16 v246, v34, v34, v246
    v_dot2_f32_bf16 v245, v35, s77, v245
    v_dot2_f32_bf16 v247, v35, v35, v247
    v_dot2_f32_bf16 v244, v36, s77, v244
    v_dot2_f32_bf16 v246, v36, v36, v246
    v_dot2_f32_bf16 v245, v37, s77, v245
    v_dot2_f32_bf16 v247, v37, v37, v247
    v_dot2_f32_bf16 v244, v38, s77, v244
    v_dot2_f32_bf16 v246, v38, v38, v246
    v_dot2_f32_bf16 v245, v39, s77, v245
    v_dot2_f32_bf16 v247, v39, v39, v247
    v_dot2_f32_bf16 v244, v40, s77, v244
    v_dot2_f32_bf16 v246, v40, v40, v246
    v_dot2_f32_bf16 v245, v41, s77, v245
    v_dot2_f32_bf16 v247, v41, v41, v247
    v_dot2_f32_bf16 v244, v42, s77, v244
    v_dot2_f32_bf16 v246, v42, v42, v246
    v_dot2_f32_bf16 v245, v43, s77, v245
    v_dot2_f32_bf16 v247, v43, v43, v247
    s_nop 1
    v_add_f32 v244, v244, v245
    v_add_f32 v245, v246, v247
    v_mov_b32 v246, v244
    v_mov_b32 v247, v245
    s_nop 0
    v_permlane32_swap_b32 v244, v246
    v_permlane32_swap_b32 v245, v247
    v_add_f32 v244, v244, v246
    v_add_f32 v245, v245, v247
    v_lshlrev_b32 v246, 3, v3
    s_mov_b64 exec, s[66:67]
    buffer_store_dwordx2 v[244:245], v246, s[8:11], s83 offen sc1
    s_mov_b64 exec, -1
L_j1_fend:
    s_waitcnt vmcnt(6)
    v_readfirstlane_b32 s30, v249
    s_mov_b32 s32, 0
    v_mov_b32 v240, 0
L_nonce_chk:
    s_cmp_eq_u32 s30, 0
    s_cbranch_scc1 L_nonce_poll
    s_memrealtime s[34:35]
    s_lshr_b32 s33, s30, 1
    s_waitcnt lgkmcnt(0)
    s_sub_u32 s33, s34, s33
    s_add_u32 s33, s33, 64
    s_and_b32 s33, s33, 0x7fffffff
    s_cmp_lt_u32 s33, 3000
    s_cbranch_scc1 L_nonce_ok
    s_cmp_gt_u32 s32, 0x1000
    s_cbranch_scc1 L_nonce_ok
L_nonce_poll:
    buffer_load_dword v241, v240, s[20:23], 0 offen sc1
    s_waitcnt vmcnt(0)
    v_readfirstlane_b32 s30, v241
    s_add_u32 s32, s32, 1
    s_cmp_lt_u32 s32, 0x100000
    s_cbranch_scc1 L_nonce_chk
L_nonce_ok:
    s_mov_b32 s76, s94
    s_mov_b32 s85, 3
    s_mul_i32 s90, s24, 10240
    s_add_u32 s90, s90, 5120
    s_mul_i32 s87, s76, 5120
    s_add_u32 s87, s87, 65536
    s_cmp_lt_u32 s76, 1952
    s_cbranch_scc0 L_j2_done
    s_cmp_lt_u32 s76, 1408
    s_cbranch_scc0 L_j2_not1
    s_sub_u32 s35, s76, 1024
    s_lshr_b32 s36, s35, 3
    s_and_b32 s34, s35, 7
    s_mov_b32 s12, s48
    s_and_b32 s13, s49, 0xffff
    s_mov_b32 s14, 1966080
    s_mov_b32 s15, 0x00020000
    s_mul_i32 s70, s34, 245760
    s_lshl_b32 s37, s36, 6
    s_add_u32 s70, s70, s37
    s_add_u32 s74, s36, 64
    s_lshl_b32 s74, s74, 10
    s_lshl_b32 s35, s34, 2
    s_add_u32 s74, s74, s35
    s_add_u32 s86, s74, 10092544
    s_mov_b32 s85, 1
    v_lshrrev_b32 v16, 2, v1
    v_mul_u32_u24 v16, 3072, v16
    v_and_b32 v17, 3, v1
    v_lshlrev_b32 v17, 4, v17
    v_add_u32 v16, v16, v17
    s_add_u32 s35, s90, 0
    s_mov_b32 m0, s35
    s_nop 0
    buffer_load_dwordx4 v16, s[12:15], s70 offen lds
    s_add_u32 s70, s70, 49152
    s_add_u32 s35, s90, 1024
    s_mov_b32 m0, s35
    s_nop 0
    buffer_load_dwordx4 v16, s[12:15], s70 offen lds
    s_add_u32 s70, s70, 49152
    s_add_u32 s35, s90, 2048
    s_mov_b32 m0, s35
    s_nop 0
    buffer_load_dwordx4 v16, s[12:15], s70 offen lds
    s_add_u32 s70, s70, 49152
    s_add_u32 s35, s90, 3072
    s_mov_b32 m0, s35
    s_nop 0
    buffer_load_dwordx4 v16, s[12:15], s70 offen lds
    s_add_u32 s70, s70, 49152
    s_add_u32 s35, s90, 4096
    s_mov_b32 m0, s35
    s_nop 0
    buffer_load_dwordx4 v16, s[12:15], s70 offen lds
    v_and_b32 v17, 15, v1
    v_lshrrev_b32 v18, 2, v17
    v_lshlrev_b32 v19, 3, v4
    v_add_u32 v18, v18, v19
    v_lshlrev_b32 v18, 6, v18
    v_bfe_u32 v19, v1, 4, 1
    v_lshlrev_b32 v19, 5, v19
    v_and_b32 v17, 3, v17
    v_lshlrev_b32 v17, 3, v17
    v_add3_u32 v18, v18, v19, v17
    v_add_u32 v60, s90, v18
    s_branch L_j2_done
L_j2_not1:
    s_mov_b32 s85, 4
    s_cmp_lt_u32 s76, 1792
    s_cbranch_scc0 L_j2_not2
    s_sub_u32 s35, s76, 1408
    s_mul_i32 s36, s35, 1366
    s_lshr_b32 s36, s36, 16
    s_mul_i32 s37, s36, 48
    s_sub_u32 s37, s35, s37
    s_mov_b32 s12, s52
    s_and_b32 s13, s53, 0xffff
    s_mov_b32 s14, 1966080
    s_mov_b32 s15, 0x00020000
    s_mul_i32 s70, s37, 40960
    s_mul_i32 s36, s36, 160
    s_add_u32 s70, s70, s36
    v_mul_u32_u24 v17, 6554, v1
    v_lshrrev_b32 v17, 16, v17
    v_mul_u32_u24 v18, 10, v17
    v_sub_u32 v18, v1, v18
    v_mul_u32_u24 v19, 1280, v17
    v_lshlrev_b32 v20, 4, v18
    v_add_u32 v19, v19, v20
    s_add_u32 s35, s90, 0
    s_mov_b32 m0, s35
    s_nop 0
    buffer_load_dwordx4 v19, s[12:15], s70 offen lds
    v_add_u32 v18, 4, v18
    v_add_u32 v19, 7744, v19
    v_cmp_lt_u32 vcc, 9, v18
    v_subrev_u32 v20, 10, v18
    s_nop 0
    v_cndmask_b32 v18, v18, v20, vcc
    v_add_u32 v20, 1120, v19
    v_cndmask_b32 v19, v19, v20, vcc
    s_add_u32 s35, s90, 1024
    s_mov_b32 m0, s35
    s_nop 0
    buffer_load_dwordx4 v19, s[12:15], s70 offen lds
    v_add_u32 v18, 4, v18
    v_add_u32 v19, 7744, v19
    v_cmp_lt_u32 vcc, 9, v18
    v_subrev_u32 v20, 10, v18
    s_nop 0
    v_cndmask_b32 v18, v18, v20, vcc
    v_add_u32 v20, 1120, v19
    v_cndmask_b32 v19, v19, v20, vcc
    s_add_u32 s35, s90, 2048
    s_mov_b32 m0, s35
    s_nop 0
    buffer_load_dwordx4 v19, s[12:15], s70 offen lds
    v_add_u32 v18, 4, v18
    v_add_u32 v19, 7744, v19
    v_cmp_lt_u32 vcc, 9, v18
    v_subrev_u32 v20, 10, v18
    s_nop 0
    v_cndmask_b32 v18, v18, v20, vcc
    v_add_u32 v20, 1120, v19
    v_cndmask_b32 v19, v19, v20, vcc
    s_add_u32 s35, s90, 3072
    s_mov_b32 m0, s35
    s_nop 0
    buffer_load_dwordx4 v19, s[12:15], s70 offen lds
    v_add_u32 v18, 4, v18
    v_add_u32 v19, 7744, v19
    v_cmp_lt_u32 vcc, 9, v18
    v_subrev_u32 v20, 10, v18
    s_nop 0
    v_cndmask_b32 v18, v18, v20, vcc
    v_add_u32 v20, 1120, v19
    v_cndmask_b32 v19, v19, v20, vcc
    s_add_u32 s35, s90, 4096
    s_mov_b32 m0, s35
    s_nop 0
    buffer_load_dwordx4 v19, s[12:15], s70 offen lds
    v_lshrrev_b32 v17, 5, v1
    v_lshlrev_b32 v17, 4, v17
    v_bfe_u32 v18, v1, 4, 1
    v_lshlrev_b32 v18, 2, v18
    v_bfe_u32 v19, v1, 2, 2
    v_add3_u32 v17, v17, v18, v19
    v_mul_u32_u24 v17, 160, v17
    v_and_b32 v18, 3, v1
    v_lshlrev_b32 v18, 3, v18
    v_add_u32 v17, v17, v18
    v_add_u32 v60, s90, v17
    v_mov_b32 v61, 1280
    s_branch L_j2_done
L_j2_not2:
    s_sub_u32 s35, s76, 1792
    s_mul_i32 s36, s35, 3277
    s_lshr_b32 s36, s36, 16
    s_mul_i32 s37, s36, 20
    s_sub_u32 s37, s35, s37
    s_mov_b32 s12, s46
    s_and_b32 s13, s47, 0xffff
    s_mov_b32 s14, 819200
    s_mov_b32 s15, 0x00020000
    s_mul_i32 s70, s36, 160
    s_lshl_b32 s37, s37, 2
    s_mov_b32 s38, 0x83620
    v_add_u32 v16, 0, v1
    v_mul_u32_u24 v17, 6554, v16
    v_lshrrev_b32 v17, 16, v17
    v_mul_u32_u24 v18, 10, v17
    v_sub_u32 v18, v16, v18
    v_lshrrev_b32 v19, 3, v17
    v_add_u32 v19, s37, v19
    v_mul_u32_u24 v20, 205, v19
    v_lshrrev_b32 v20, 10, v20
    v_mul_u32_u24 v21, 5, v20
    v_sub_u32 v21, v19, v21
    v_lshlrev_b32 v22, 2, v21
    v_lshrrev_b32 v22, v22, s38
    v_and_b32 v22, 15, v22
    v_lshlrev_b32 v22, 2, v22
    v_mul_u32_u24 v20, 40, v20
    v_and_b32 v23, 3, v17
    v_add3_u32 v20, v20, v22, v23
    v_cmp_eq_u32 vcc, 1, v21
    s_nop 1
    v_cndmask_b32 v22, 4, 12, vcc
    v_bfe_u32 v23, v17, 2, 1
    v_mul_u32_u24 v22, v22, v23
    v_add_u32 v20, v20, v22
    v_mul_u32_u24 v20, 1280, v20
    v_lshlrev_b32 v18, 4, v18
    v_add_u32 v20, v20, v18
    s_add_u32 s35, s90, 0
    s_mov_b32 m0, s35
    s_nop 0
    buffer_load_dwordx4 v20, s[12:15], s70 offen lds
    v_add_u32 v16, 64, v1
    v_mul_u32_u24 v17, 6554, v16
    v_lshrrev_b32 v17, 16, v17
    v_mul_u32_u24 v18, 10, v17
    v_sub_u32 v18, v16, v18
    v_lshrrev_b32 v19, 3, v17
    v_add_u32 v19, s37, v19
    v_mul_u32_u24 v20, 205, v19
    v_lshrrev_b32 v20, 10, v20
    v_mul_u32_u24 v21, 5, v20
    v_sub_u32 v21, v19, v21
    v_lshlrev_b32 v22, 2, v21
    v_lshrrev_b32 v22, v22, s38
    v_and_b32 v22, 15, v22
    v_lshlrev_b32 v22, 2, v22
    v_mul_u32_u24 v20, 40, v20
    v_and_b32 v23, 3, v17
    v_add3_u32 v20, v20, v22, v23
    v_cmp_eq_u32 vcc, 1, v21
    s_nop 1
    v_cndmask_b32 v22, 4, 12, vcc
    v_bfe_u32 v23, v17, 2, 1
    v_mul_u32_u24 v22, v22, v23
    v_add_u32 v20, v20, v22
    v_mul_u32_u24 v20, 1280, v20
    v_lshlrev_b32 v18, 4, v18
    v_add_u32 v20, v20, v18
    s_add_u32 s35, s90, 1024
    s_mov_b32 m0, s35
    s_nop 0
    buffer_load_dwordx4 v20, s[12:15], s70 offen lds
    v_add_u32 v16, 128, v1
    v_mul_u32_u24 v17, 6554, v16
    v_lshrrev_b32 v17, 16, v17
    v_mul_u32_u24 v18, 10, v17
    v_sub_u32 v18, v16, v18
    v_lshrrev_b32 v19, 3, v17
    v_add_u32 v19, s37, v19
    v_mul_u32_u24 v20, 205, v19
    v_lshrrev_b32 v20, 10, v20
    v_mul_u32_u24 v21, 5, v20
    v_sub_u32 v21, v19, v21
    v_lshlrev_b32 v22, 2, v21
    v_lshrrev_b32 v22, v22, s38
    v_and_b32 v22, 15, v22
    v_lshlrev_b32 v22, 2, v22
    v_mul_u32_u24 v20, 40, v20
    v_and_b32 v23, 3, v17
    v_add3_u32 v20, v20, v22, v23
    v_cmp_eq_u32 vcc, 1, v21
    s_nop 1
    v_cndmask_b32 v22, 4, 12, vcc
    v_bfe_u32 v23, v17, 2, 1
    v_mul_u32_u24 v22, v22, v23
    v_add_u32 v20, v20, v22
    v_mul_u32_u24 v20, 1280, v20
    v_lshlrev_b32 v18, 4, v18
    v_add_u32 v20, v20, v18
    s_add_u32 s35, s90, 2048
    s_mov_b32 m0, s35
    s_nop 0
    buffer_load_dwordx4 v20, s[12:15], s70 offen lds
    v_add_u32 v16, 192, v1
    v_mul_u32_u24 v17, 6554, v16
    v_lshrrev_b32 v17, 16, v17
    v_mul_u32_u24 v18, 10, v17
    v_sub_u32 v18, v16, v18
    v_lshrrev_b32 v19, 3, v17
    v_add_u32 v19, s37, v19
    v_mul_u32_u24 v20, 205, v19
    v_lshrrev_b32 v20, 10, v20
    v_mul_u32_u24 v21, 5, v20
    v_sub_u32 v21, v19, v21
    v_lshlrev_b32 v22, 2, v21
    v_lshrrev_b32 v22, v22, s38
    v_and_b32 v22, 15, v22
    v_lshlrev_b32 v22, 2, v22
    v_mul_u32_u24 v20, 40, v20
    v_and_b32 v23, 3, v17
    v_add3_u32 v20, v20, v22, v23
    v_cmp_eq_u32 vcc, 1, v21
    s_nop 1
    v_cndmask_b32 v22, 4, 12, vcc
    v_bfe_u32 v23, v17, 2, 1
    v_mul_u32_u24 v22, v22, v23
    v_add_u32 v20, v20, v22
    v_mul_u32_u24 v20, 1280, v20
    v_lshlrev_b32 v18, 4, v18
    v_add_u32 v20, v20, v18
    s_add_u32 s35, s90, 3072
    s_mov_b32 m0, s35
    s_nop 0
    buffer_load_dwordx4 v20, s[12:15], s70 offen lds
    v_add_u32 v16, 256, v1
    v_mul_u32_u24 v17, 6554, v16
    v_lshrrev_b32 v17, 16, v17
    v_mul_u32_u24 v18, 10, v17
    v_sub_u32 v18, v16, v18
    v_lshrrev_b32 v19, 3, v17
    v_add_u32 v19, s37, v19
    v_mul_u32_u24 v20, 205, v19
    v_lshrrev_b32 v20, 10, v20
    v_mul_u32_u24 v21, 5, v20
    v_sub_u32 v21, v19, v21
    v_lshlrev_b32 v22, 2, v21
    v_lshrrev_b32 v22, v22, s38
    v_and_b32 v22, 15, v22
    v_lshlrev_b32 v22, 2, v22
    v_mul_u32_u24 v20, 40, v20
    v_and_b32 v23, 3, v17
    v_add3_u32 v20, v20, v22, v23
    v_cmp_eq_u32 vcc, 1, v21
    s_nop 1
    v_cndmask_b32 v22, 4, 12, vcc
    v_bfe_u32 v23, v17, 2, 1
    v_mul_u32_u24 v22, v22, v23
    v_add_u32 v20, v20, v22
    v_mul_u32_u24 v20, 1280, v20
    v_lshlrev_b32 v18, 4, v18
    v_add_u32 v20, v20, v18
    s_add_u32 s35, s90, 4096
    s_mov_b32 m0, s35
    s_nop 0
    buffer_load_dwordx4 v20, s[12:15], s70 offen lds
    v_lshrrev_b32 v17, 4, v1
    v_lshlrev_b32 v17, 3, v17
    v_bfe_u32 v19, v1, 2, 2
    v_add_u32 v17, v17, v19
    v_mul_u32_u24 v17, 160, v17
    v_and_b32 v18, 3, v1
    v_lshlrev_b32 v18, 3, v18
    v_add_u32 v17, v17, v18
    v_add_u32 v60, s90, v17
    v_mov_b32 v61, 640
L_j2_done:
    s_add_u32 s85, s85, 0
    s_cmp_eq_u32 s85, 3
    s_cbranch_scc0 L_p0_hasj2
    s_waitcnt vmcnt(0)
L_p0_hasj2:
    s_add_u32 s34, s30, 1
    s_add_u32 s34, s34, s62
    s_waitcnt vmcnt(5)
    s_barrier
    s_cmp_lg_u32 s24, 0
    s_cbranch_scc1 L_fl_fa
    s_lshl_b32 s32, s2, 2
    s_add_u32 s32, s32, 0
    v_mov_b32 v254, s34
    v_mov_b32 v255, 0
    s_mov_b64 s[64:65], exec
    s_mov_b64 exec, 1
    buffer_store_dword v254, v255, s[8:11], s32 offen sc1
    s_mov_b64 exec, s[64:65]
L_fl_fa:
    s_cmp_lg_u32 s24, 0
    s_cbranch_scc1 L_wp_skip
    s_mov_b32 s12, s44
    s_and_b32 s13, s45, 0xffff
    s_mov_b32 s14, 25600
    s_mov_b32 s15, 0x00020000
    s_mul_i32 s32, s26, 1600
    s_mov_b32 m0, 40960
    s_nop 0
    buffer_load_dwordx4 v2, s[12:15], s32 offen lds
    s_add_u32 s32, s32, 1024
    s_mov_b32 m0, 41984
    s_nop 0
    buffer_load_dwordx4 v2, s[12:15], s32 offen lds
L_wp_skip:
    s_lshl_b32 s32, s25, 7
    s_lshl_b32 s33, s27, 6
    s_add_u32 s32, s32, s33
    s_lshl_b32 s33, s24, 4
    s_add_u32 s32, s32, s33
    v_and_b32 v19, 15, v1
    v_add_u32 v19, s32, v19
    v_mul_u32_u24 v19, 1280, v19
    v_lshrrev_b32 v20, 4, v1
    v_lshlrev_b32 v20, 3, v20
    v_add_u32 v19, v19, v20
    s_mul_i32 s33, s28, 160
    buffer_load_dwordx2 v[6:7], v19, s[16:19], s33 offen offset:0
    buffer_load_dwordx2 v[8:9], v19, s[16:19], s33 offen offset:32
    buffer_load_dwordx2 v[10:11], v19, s[16:19], s33 offen offset:64
    buffer_load_dwordx2 v[12:13], v19, s[16:19], s33 offen offset:96
    buffer_load_dwordx2 v[14:15], v19, s[16:19], s33 offen offset:128
    v_lshlrev_b32 v250, 2, v1
    global_load_dword v251, v250, s[50:51]
    global_load_dword v252, v250, s[54:55]
    s_waitcnt vmcnt(0)
    s_barrier
    s_cmp_eq_u32 s85, 3
    s_cbranch_scc1 L_j2_fend
    s_cmp_eq_u32 s85, 1
    s_cbranch_scc0 L_j2_f16
    ds_read_b64_tr_b16 v[224:225], v60 offset:0
    ds_read_b64_tr_b16 v[226:227], v60 offset:256
    ds_read_b64_tr_b16 v[228:229], v60 offset:1024
    ds_read_b64_tr_b16 v[230:231], v60 offset:1280
    ds_read_b64_tr_b16 v[232:233], v60 offset:2048
    ds_read_b64_tr_b16 v[234:235], v60 offset:2304
    ds_read_b64_tr_b16 v[236:237], v60 offset:3072
    ds_read_b64_tr_b16 v[238:239], v60 offset:3328
    ds_read_b64_tr_b16 v[240:241], v60 offset:4096
    ds_read_b64_tr_b16 v[242:243], v60 offset:4352
    s_mov_b32 s77, s87
    s_waitcnt lgkmcnt(8)
    buffer_store_dwordx4 v[224:227], v2, s[8:11], s77 offen sc1
    s_add_u32 s77, s77, 1024
    s_waitcnt lgkmcnt(6)
    buffer_store_dwordx4 v[228:231], v2, s[8:11], s77 offen sc1
    s_add_u32 s77, s77, 1024
    s_waitcnt lgkmcnt(4)
    buffer_store_dwordx4 v[232:235], v2, s[8:11], s77 offen sc1
    s_add_u32 s77, s77, 1024
    s_waitcnt lgkmcnt(2)
    buffer_store_dwordx4 v[236:239], v2, s[8:11], s77 offen sc1
    s_add_u32 s77, s77, 1024
    s_waitcnt lgkmcnt(0)
    buffer_store_dwordx4 v[240:243], v2, s[8:11], s77 offen sc1
    s_mov_b32 s77, 0x3f803f80
    v_dot2_f32_bf16 v244, v224, s77, 0
    v_dot2_f32_bf16 v245, v225, s77, 0
    v_dot2_f32_bf16 v246, v226, s77, 0
    v_dot2_f32_bf16 v247, v227, s77, 0
    v_dot2_f32_bf16 v244, v228, s77, v244
    v_dot2_f32_bf16 v245, v229, s77, v245
    v_dot2_f32_bf16 v246, v230, s77, v246
    v_dot2_f32_bf16 v247, v231, s77, v247
    v_dot2_f32_bf16 v244, v232, s77, v244
    v_dot2_f32_bf16 v245, v233, s77, v245
    v_dot2_f32_bf16 v246, v234, s77, v246
    v_dot2_f32_bf16 v247, v235, s77, v247
    v_dot2_f32_bf16 v244, v236, s77, v244
    v_dot2_f32_bf16 v245, v237, s77, v245
    v_dot2_f32_bf16 v246, v238, s77, v246
    v_dot2_f32_bf16 v247, v239, s77, v247
    v_dot2_f32_bf16 v244, v240, s77, v244
    v_dot2_f32_bf16 v245, v241, s77, v245
    v_dot2_f32_bf16 v246, v242, s77, v246
    v_dot2_f32_bf16 v247, v243, s77, v247
    s_nop 0
    v_add_f32 v244, v244, v245
    s_nop 0
    v_add_f32 v246, v246, v247
    v_add_f32 v244, v244, v246
    v_mov_b32 v246, v244
    s_nop 1
    v_permlane32_swap_b32 v244, v246
    v_add_f32 v244, v244, v246
    v_lshlrev_b32 v246, 5, v3
    s_mov_b64 exec, s[66:67]
    buffer_store_dword v244, v246, s[8:11], s86 offen sc1
    s_mov_b64 exec, -1
    s_branch L_j2_fend
L_j2_f16:
    v_add_u32 v61, v61, v60
    ds_read_b64_tr_b16 v[224:225], v60 offset:0
    ds_read_b64_tr_b16 v[226:227], v61 offset:0
    ds_read_b64_tr_b16 v[228:229], v60 offset:32
    ds_read_b64_tr_b16 v[230:231], v61 offset:32
    ds_read_b64_tr_b16 v[232:233], v60 offset:64
    ds_read_b64_tr_b16 v[234:235], v61 offset:64
    ds_read_b64_tr_b16 v[236:237], v60 offset:96
    ds_read_b64_tr_b16 v[238:239], v61 offset:96
    ds_read_b64_tr_b16 v[240:241], v60 offset:128
    ds_read_b64_tr_b16 v[242:243], v61 offset:128
    s_mov_b32 s77, s87
    s_waitcnt lgkmcnt(8)
    buffer_store_dwordx4 v[224:227], v2, s[8:11], s77 offen sc1
    s_add_u32 s77, s77, 1024
    s_waitcnt lgkmcnt(6)
    buffer_store_dwordx4 v[228:231], v2, s[8:11], s77 offen sc1
    s_add_u32 s77, s77, 1024
    s_waitcnt lgkmcnt(4)
    buffer_store_dwordx4 v[232:235], v2, s[8:11], s77 offen sc1
    s_add_u32 s77, s77, 1024
    s_waitcnt lgkmcnt(2)
    buffer_store_dwordx4 v[236:239], v2, s[8:11], s77 offen sc1
    s_add_u32 s77, s77, 1024
    s_waitcnt lgkmcnt(0)
    buffer_store_dwordx4 v[240:243], v2, s[8:11], s77 offen sc1
L_j2_fend:
    v_lshrrev_b32 v52, 3, v3
    v_lshlrev_b32 v52, 2, v52
    v_and_b32 v53, 3, v3
    v_add_u32 v52, v52, v53
    v_bfe_u32 v53, v3, 2, 1
    v_mul_u32_u24 v53, 10, v53
    v_add_u32 v53, v53, v52
    v_lshlrev_b32 v53, 1, v53
    v_mul_u32_u24 v54, 400, v4
    v_add_u32 v53, v53, v54
    v_add_u32 v53, 40960, v53
    v_cmp_gt_u32 vcc, 10, v52
    s_nop 1
    v_cndmask_b32 v54, 0, -1, vcc
    v_mov_b32 v55, 40960
    v_cndmask_b32 v53, v55, v53, vcc
    ds_read_u16 v16, v53 offset:0
    ds_read_u16 v17, v53 offset:40
    ds_read_u16 v18, v53 offset:80
    ds_read_u16 v19, v53 offset:120
    ds_read_u16 v20, v53 offset:160
    ds_read_u16 v21, v53 offset:200
    ds_read_u16 v22, v53 offset:240
    ds_read_u16 v23, v53 offset:280
    ds_read_u16 v24, v53 offset:320
    ds_read_u16 v25, v53 offset:360
    v_mov_b32 v26, 0
    v_mov_b32 v27, 0
    v_mov_b32 v28, 0
    v_mov_b32 v29, 0
    v_mov_b32 v30, 0
    v_mov_b32 v31, 0
    v_mov_b32 v32, 0
    v_mov_b32 v33, 0
    ds_read_u16 v34, v53 offset:800
    ds_read_u16 v35, v53 offset:840
    ds_read_u16 v36, v53 offset:880
    ds_read_u16 v37, v53 offset:920
    ds_read_u16 v38, v53 offset:960
    ds_read_u16 v39, v53 offset:1000
    ds_read_u16 v40, v53 offset:1040
    ds_read_u16 v41, v53 offset:1080
    ds_read_u16 v42, v53 offset:1120
    ds_read_u16 v43, v53 offset:1160
    v_mov_b32 v44, 0
    v_mov_b32 v45, 0
    v_mov_b32 v46, 0
    v_mov_b32 v47, 0
    s_waitcnt lgkmcnt(15)
    v_lshl_or_b32 v16, v17, 16, v16
    v_and_b32 v16, v16, v54
    v_accvgpr_write_b32 a240, v16
    v_lshl_or_b32 v18, v19, 16, v18
    v_and_b32 v18, v18, v54
    v_accvgpr_write_b32 a241, v18
    s_waitcnt lgkmcnt(14)
    v_lshl_or_b32 v20, v21, 16, v20
    v_and_b32 v20, v20, v54
    v_accvgpr_write_b32 a242, v20
    s_waitcnt lgkmcnt(12)
    v_lshl_or_b32 v22, v23, 16, v22
    v_and_b32 v22, v22, v54
    v_accvgpr_write_b32 a243, v22
    s_waitcnt lgkmcnt(10)
    v_lshl_or_b32 v24, v25, 16, v24
    v_and_b32 v24, v24, v54
    v_accvgpr_write_b32 a244, v24
    v_lshl_or_b32 v26, v27, 16, v26
    v_and_b32 v26, v26, v54
    v_accvgpr_write_b32 a245, v26
    v_lshl_or_b32 v28, v29, 16, v28
    v_and_b32 v28, v28, v54
    v_accvgpr_write_b32 a246, v28
    v_lshl_or_b32 v30, v31, 16, v30
    v_and_b32 v30, v30, v54
    v_accvgpr_write_b32 a247, v30
    v_lshl_or_b32 v32, v33, 16, v32
    v_and_b32 v32, v32, v54
    v_accvgpr_write_b32 a248, v32
    s_waitcnt lgkmcnt(8)
    v_lshl_or_b32 v34, v35, 16, v34
    v_and_b32 v34, v34, v54
    v_accvgpr_write_b32 a249, v34
    s_waitcnt lgkmcnt(6)
    v_lshl_or_b32 v36, v37, 16, v36
    v_and_b32 v36, v36, v54
    v_accvgpr_write_b32 a250, v36
    s_waitcnt lgkmcnt(4)
    v_lshl_or_b32 v38, v39, 16, v38
    v_and_b32 v38, v38, v54
    v_accvgpr_write_b32 a251, v38
    s_waitcnt lgkmcnt(2)
    v_lshl_or_b32 v40, v41, 16, v40
    v_and_b32 v40, v40, v54
    v_accvgpr_write_b32 a252, v40
    s_waitcnt lgkmcnt(0)
    v_lshl_or_b32 v42, v43, 16, v42
    v_and_b32 v42, v42, v54
    v_accvgpr_write_b32 a253, v42
    v_lshl_or_b32 v44, v45, 16, v44
    v_and_b32 v44, v44, v54
    v_accvgpr_write_b32 a254, v44
    v_lshl_or_b32 v46, v47, 16, v46
    v_and_b32 v46, v46, v54
    v_accvgpr_write_b32 a255, v46
    s_mul_i32 s90, s26, 163840
    s_add_u32 s90, s90, 65536
    s_mul_i32 s91, s26, 122880
    s_add_u32 s91, s91, 5308416
L_layer:
    s_cmp_eq_u32 s29, 0
    s_cbranch_scc0 L_dl_p1head_1
    s_lshl_b32 s92, s2, 2
    s_add_u32 s92, s92, s24
    s_lshl_b32 s92, s92, 12
    s_add_u32 s92, s92, 44040192
    s_mul_i32 s82, s28, 48
    s_mul_i32 s33, s24, 12
    s_add_u32 s82, s82, s33
    s_mul_i32 s82, s82, 5120
    s_add_u32 s82, s82, 7274496
    s_mov_b32 s72, 2686976
    s_mov_b32 s73, 25034752
    s_lshl_b32 s32, s25, 2
    s_add_u32 s32, s32, s24
    s_mul_i32 s81, s32, 40960
    s_add_u32 s81, s81, s72
    s_lshl_b32 s33, s32, 11
    s_add_u32 s95, s33, s73
    v_lshlrev_b32 v48, 3, v3
    v_lshlrev_b32 v49, 10, v4
    v_add_u32 v48, v48, v49
    v_add_u32 v242, 0x10000, v2
    v_add_u32 v243, 0x20000, v2
    v_mov_b32 v241, v2
    s_mov_b32 s70, 0
    s_add_u32 s71, s30, 1
    s_cmp_lg_u32 s24, 0
    s_cbranch_scc1 L_po_fa_done
    s_mov_b64 s[64:65], exec
    s_mov_b64 exec, 0xffff
    s_lshl_b32 s34, s26, 5
    s_lshl_b32 s35, s25, 5
    s_add_u32 s35, s35, 480
    v_lshlrev_b32 v255, 2, v1
    v_mov_b32 v254, s34
    v_mov_b32 v253, s35
    v_cmp_gt_u32 vcc, 8, v1
    s_nop 1
    v_cndmask_b32 v254, v253, v254, vcc
    v_add_u32 v255, v255, v254
    s_mov_b32 s33, 0
L_po_fa:
    buffer_load_dword v254, v255, s[8:11], s70 offen sc1
    s_waitcnt vmcnt(0)
    v_subrev_u32 v254, s71, v254
    v_cmp_gt_u32 vcc, 16, v254
    s_add_u32 s33, s33, 1
    s_cmp_eq_u64 vcc, exec
    s_cbranch_scc1 L_po_fa_ok
    s_sleep 2
    s_cmp_lt_u32 s33, 0x100000
    s_cbranch_scc1 L_po_fa
    v_mov_b32 v254, 36
    v_mov_b32 v255, s2
    v_add_u32 v255, 0x1000, v255
    buffer_store_dword v255, v254, s[20:23], 0 offen sc1
L_po_fa_ok:
    s_mov_b64 exec, s[64:65]
L_po_fa_done:
    s_barrier
    v_lshlrev_b32 v59, 5, v3
    s_lshl_b32 s33, s26, 12
    s_add_u32 s33, s33, 10092544
    buffer_load_dwordx4 a[0:3], v59, s[8:11], s33 offen offset:0 sc1
    buffer_load_dwordx4 a[4:7], v59, s[8:11], s33 offen offset:16 sc1
    buffer_load_dwordx4 a[8:11], v59, s[8:11], s33 offen offset:1024 sc1
    buffer_load_dwordx4 a[12:15], v59, s[8:11], s33 offen offset:1040 sc1
    buffer_load_dwordx4 a[16:19], v59, s[8:11], s33 offen offset:2048 sc1
    buffer_load_dwordx4 a[20:23], v59, s[8:11], s33 offen offset:2064 sc1
    buffer_load_dwordx4 a[24:27], v59, s[8:11], s33 offen offset:3072 sc1
    buffer_load_dwordx4 a[28:31], v59, s[8:11], s33 offen offset:3088 sc1
    s_sub_u32 s32, s24, 0
    s_mul_i32 s32, s32, 20
    s_add_u32 s32, s32, 0
    s_lshl_b32 s33, s32, 10
    s_add_u32 s34, s33, s90
    s_add_u32 s35, s33, 61440
    s_sub_u32 s36, s33, 102400
    s_cmp_lt_u32 s32, 100
    s_cselect_b32 s35, s35, s36
    s_mov_b32 m0, s35
    s_nop 0
    buffer_load_dwordx4 v2, s[8:11], s34 offen offset:0 lds
    buffer_load_dwordx4 v2, s[8:11], s34 offen offset:1024 lds
    buffer_load_dwordx4 v2, s[8:11], s34 offen offset:2048 lds
    buffer_load_dwordx4 v2, s[8:11], s34 offen offset:3072 lds
    s_add_u32 s34, s34, 4096
    s_add_u32 s35, s35, 4096
    s_mov_b32 m0, s35
    s_nop 0
    buffer_load_dwordx4 v2, s[8:11], s34 offen offset:0 lds
    buffer_load_dwordx4 v2, s[8:11], s34 offen offset:1024 lds
    buffer_load_dwordx4 v2, s[8:11], s34 offen offset:2048 lds
    buffer_load_dwordx4 v2, s[8:11], s34 offen offset:3072 lds
    s_add_u32 s34, s34, 4096
    s_add_u32 s35, s35, 4096
    s_mov_b32 m0, s35
    s_nop 0
    buffer_load_dwordx4 v2, s[8:11], s34 offen offset:0 lds
    buffer_load_dwordx4 v2, s[8:11], s34 offen offset:1024 lds
    buffer_load_dwordx4 v2, s[8:11], s34 offen offset:2048 lds
    buffer_load_dwordx4 v2, s[8:11], s34 offen offset:3072 lds
    s_add_u32 s34, s34, 4096
    s_add_u32 s35, s35, 4096
    s_mov_b32 m0, s35
    s_nop 0
    buffer_load_dwordx4 v2, s[8:11], s34 offen offset:0 lds
    buffer_load_dwordx4 v2, s[8:11], s34 offen offset:1024 lds
    buffer_load_dwordx4 v2, s[8:11], s34 offen offset:2048 lds
    buffer_load_dwordx4 v2, s[8:11], s34 offen offset:3072 lds
    s_add_u32 s34, s34, 4096
    s_add_u32 s35, s35, 4096
    s_mov_b32 m0, s35
    s_nop 0
    buffer_load_dwordx4 v2, s[8:11], s34 offen offset:0 lds
    buffer_load_dwordx4 v2, s[8:11], s34 offen offset:1024 lds
    buffer_load_dwordx4 v2, s[8:11], s34 offen offset:2048 lds
    buffer_load_dwordx4 v2, s[8:11], s34 offen offset:3072 lds
    buffer_load_dwordx4 v[64:67], v2, s[8:11], s81 offen offset:0 sc1
    buffer_load_dwordx4 v[68:71], v2, s[8:11], s81 offen offset:1024 sc1
    buffer_load_dwordx4 v[72:75], v2, s[8:11], s81 offen offset:2048 sc1
    buffer_load_dwordx4 v[76:79], v2, s[8:11], s81 offen offset:3072 sc1
    s_add_u32 s81, s81, 4096
    buffer_load_dwordx4 v[80:83], v2, s[8:11], s81 offen offset:0 sc1
    buffer_load_dwordx4 v[84:87], v2, s[8:11], s81 offen offset:1024 sc1
    buffer_load_dwordx4 v[88:91], v2, s[8:11], s81 offen offset:2048 sc1
    buffer_load_dwordx4 v[92:95], v2, s[8:11], s81 offen offset:3072 sc1
    s_add_u32 s81, s81, 4096
    buffer_load_dwordx4 v[96:99], v2, s[8:11], s81 offen offset:0 sc1
    buffer_load_dwordx4 v[100:103], v2, s[8:11], s81 offen offset:1024 sc1
    buffer_load_dwordx4 v[104:107], v2, s[8:11], s81 offen offset:2048 sc1
    buffer_load_dwordx4 v[108:111], v2, s[8:11], s81 offen offset:3072 sc1
    s_waitcnt vmcnt(12)
    s_barrier
    s_cmp_lg_u32 s24, 0
    s_cbranch_scc1 L_fo_fb
    s_lshl_b32 s32, s2, 2
    s_add_u32 s32, s32, 1024
    s_add_u32 s34, s30, 1
    v_mov_b32 v254, s34
    v_mov_b32 v255, 0
    s_mov_b64 s[64:65], exec
    s_mov_b64 exec, 1
    buffer_store_dword v254, v255, s[8:11], s32 offen sc1
    s_mov_b64 exec, s[64:65]
L_fo_fb:
    ds_read_b128 v[224:227], v241 offset:61440
    ds_read_b128 v[228:231], v242 offset:36864
    ds_read_b128 v[232:235], v241 offset:62464
    ds_read_b128 v[236:239], v242 offset:37888
    s_waitcnt vmcnt(11) lgkmcnt(3)
    v_mfma_f32_32x32x16_bf16 v[16:31], v[224:227], v[64:67], 0
    s_add_u32 s81, s81, 4096
    buffer_load_dwordx4 v[112:115], v2, s[8:11], s81 offen offset:0 sc1
    s_waitcnt lgkmcnt(2)
    v_mfma_f32_32x32x16_bf16 v[32:47], v[228:231], v[64:67], 0
    ds_read_b128 v[224:227], v241 offset:63488
    ds_read_b128 v[228:231], v242 offset:38912
    s_waitcnt vmcnt(11) lgkmcnt(3)
    v_mfma_f32_32x32x16_bf16 v[16:31], v[232:235], v[68:71], v[16:31]
    buffer_load_dwordx4 v[116:119], v2, s[8:11], s81 offen offset:1024 sc1
    s_waitcnt lgkmcnt(2)
    v_mfma_f32_32x32x16_bf16 v[32:47], v[236:239], v[68:71], v[32:47]
    ds_read_b128 v[232:235], v241 offset:64512
    ds_read_b128 v[236:239], v242 offset:39936
    s_waitcnt vmcnt(11) lgkmcnt(3)
    v_mfma_f32_32x32x16_bf16 v[16:31], v[224:227], v[72:75], v[16:31]
    buffer_load_dwordx4 v[120:123], v2, s[8:11], s81 offen offset:2048 sc1
    buffer_load_dwordx2 v[50:51], v48, s[8:11], s95 offen offset:0 sc1
    s_waitcnt lgkmcnt(2)
    v_mfma_f32_32x32x16_bf16 v[32:47], v[228:231], v[72:75], v[32:47]
    ds_read_b128 v[224:227], v242 offset:0
    ds_read_b128 v[228:231], v242 offset:40960
    s_waitcnt vmcnt(12) lgkmcnt(3)
    v_mfma_f32_32x32x16_bf16 v[16:31], v[232:235], v[76:79], v[16:31]
    buffer_load_dwordx4 v[124:127], v2, s[8:11], s81 offen offset:3072 sc1
    buffer_load_dwordx2 v[52:53], v48, s[8:11], s95 offen offset:256 sc1
    s_waitcnt lgkmcnt(2)
    v_mfma_f32_32x32x16_bf16 v[32:47], v[236:239], v[76:79], v[32:47]
    ds_read_b128 v[232:235], v242 offset:1024
    ds_read_b128 v[236:239], v242 offset:41984
    s_waitcnt vmcnt(13) lgkmcnt(3)
    v_mfma_f32_32x32x16_bf16 v[16:31], v[224:227], v[80:83], v[16:31]
    s_add_u32 s81, s81, 4096
    buffer_load_dwordx4 v[128:131], v2, s[8:11], s81 offen offset:0 sc1
    buffer_load_dwordx2 v[54:55], v48, s[8:11], s95 offen offset:512 sc1
    s_waitcnt lgkmcnt(2)
    v_mfma_f32_32x32x16_bf16 v[32:47], v[228:231], v[80:83], v[32:47]
    ds_read_b128 v[224:227], v242 offset:2048
    ds_read_b128 v[228:231], v242 offset:43008
    s_waitcnt vmcnt(14) lgkmcnt(3)
    v_mfma_f32_32x32x16_bf16 v[16:31], v[232:235], v[84:87], v[16:31]
    buffer_load_dwordx4 v[132:135], v2, s[8:11], s81 offen offset:1024 sc1
    buffer_load_dwordx2 v[56:57], v48, s[8:11], s95 offen offset:768 sc1
    s_waitcnt lgkmcnt(2)
    v_mfma_f32_32x32x16_bf16 v[32:47], v[236:239], v[84:87], v[32:47]
    ds_read_b128 v[232:235], v242 offset:3072
    ds_read_b128 v[236:239], v242 offset:44032
    s_waitcnt vmcnt(15) lgkmcnt(3)
    v_mfma_f32_32x32x16_bf16 v[16:31], v[224:227], v[88:91], v[16:31]
    buffer_load_dwordx4 v[136:139], v2, s[8:11], s81 offen offset:2048 sc1
    s_waitcnt lgkmcnt(2)
    v_mfma_f32_32x32x16_bf16 v[32:47], v[228:231], v[88:91], v[32:47]
    ds_read_b128 v[224:227], v242 offset:4096
    ds_read_b128 v[228:231], v242 offset:45056
    s_waitcnt vmcnt(15) lgkmcnt(3)
    v_mfma_f32_32x32x16_bf16 v[16:31], v[232:235], v[92:95], v[16:31]
    buffer_load_dwordx4 v[140:143], v2, s[8:11], s81 offen offset:3072 sc1
    s_waitcnt lgkmcnt(2)
    v_mfma_f32_32x32x16_bf16 v[32:47], v[236:239], v[92:95], v[32:47]
    ds_read_b128 v[232:235], v242 offset:5120
    ds_read_b128 v[236:239], v242 offset:46080
    s_waitcnt vmcnt(15) lgkmcnt(3)
    v_mfma_f32_32x32x16_bf16 v[16:31], v[224:227], v[96:99], v[16:31]
    s_add_u32 s81, s81, 4096
    buffer_load_dwordx4 v[144:147], v2, s[8:11], s81 offen offset:0 sc1
    s_waitcnt lgkmcnt(2)
    v_mfma_f32_32x32x16_bf16 v[32:47], v[228:231], v[96:99], v[32:47]
    ds_read_b128 v[224:227], v242 offset:6144
    ds_read_b128 v[228:231], v242 offset:47104
    s_waitcnt vmcnt(15) lgkmcnt(3)
    v_mfma_f32_32x32x16_bf16 v[16:31], v[232:235], v[100:103], v[16:31]
    buffer_load_dwordx4 v[148:151], v2, s[8:11], s81 offen offset:1024 sc1
    s_waitcnt lgkmcnt(2)
    v_mfma_f32_32x32x16_bf16 v[32:47], v[236:239], v[100:103], v[32:47]
    ds_read_b128 v[232:235], v242 offset:7168
    ds_read_b128 v[236:239], v242 offset:48128
    s_waitcnt vmcnt(15) lgkmcnt(3)
    v_mfma_f32_32x32x16_bf16 v[16:31], v[224:227], v[104:107], v[16:31]
    buffer_load_dwordx4 v[152:155], v2, s[8:11], s81 offen offset:2048 sc1
    s_waitcnt lgkmcnt(2)
    v_mfma_f32_32x32x16_bf16 v[32:47], v[228:231], v[104:107], v[32:47]
    ds_read_b128 v[224:227], v242 offset:8192
    ds_read_b128 v[228:231], v242 offset:49152
    s_waitcnt vmcnt(15) lgkmcnt(3)
    v_mfma_f32_32x32x16_bf16 v[16:31], v[232:235], v[108:111], v[16:31]
    buffer_load_dwordx4 v[156:159], v2, s[8:11], s81 offen offset:3072 sc1
    s_sub_u32 s32, s24, 0
    s_mul_i32 s32, s32, 5120
    s_add_u32 s93, s32, s90
    s_add_u32 s93, s93, 81920
    s_add_u32 s94, s32, 143360
    s_mov_b32 m0, s94
    s_waitcnt lgkmcnt(2)
    v_mfma_f32_32x32x16_bf16 v[32:47], v[236:239], v[108:111], v[32:47]
    ds_read_b128 v[232:235], v242 offset:9216
    ds_read_b128 v[236:239], v242 offset:50176
    s_waitcnt vmcnt(15) lgkmcnt(3)
    v_mfma_f32_32x32x16_bf16 v[16:31], v[224:227], v[112:115], v[16:31]
    s_add_u32 s81, s81, 4096
    buffer_load_dwordx4 v[160:163], v2, s[8:11], s81 offen offset:0 sc1
    buffer_load_dwordx4 v2, s[8:11], s93 offen offset:0 lds
    s_waitcnt lgkmcnt(2)
    v_mfma_f32_32x32x16_bf16 v[32:47], v[228:231], v[112:115], v[32:47]
    ds_read_b128 v[224:227], v242 offset:10240
    ds_read_b128 v[228:231], v242 offset:51200
    s_waitcnt vmcnt(16) lgkmcnt(3)
    v_mfma_f32_32x32x16_bf16 v[16:31], v[232:235], v[116:119], v[16:31]
    buffer_load_dwordx4 v[164:167], v2, s[8:11], s81 offen offset:1024 sc1
    s_waitcnt lgkmcnt(2)
    v_mfma_f32_32x32x16_bf16 v[32:47], v[236:239], v[116:119], v[32:47]
    ds_read_b128 v[232:235], v242 offset:11264
    ds_read_b128 v[236:239], v242 offset:52224
    s_waitcnt vmcnt(16) lgkmcnt(3)
    v_mfma_f32_32x32x16_bf16 v[16:31], v[224:227], v[120:123], v[16:31]
    buffer_load_dwordx4 v[168:171], v2, s[8:11], s81 offen offset:2048 sc1
    buffer_load_dwordx4 v2, s[8:11], s93 offen offset:1024 lds
    s_waitcnt lgkmcnt(2)
    v_mfma_f32_32x32x16_bf16 v[32:47], v[228:231], v[120:123], v[32:47]
    ds_read_b128 v[224:227], v242 offset:12288
    ds_read_b128 v[228:231], v242 offset:53248
    s_waitcnt vmcnt(16) lgkmcnt(3)
    v_mfma_f32_32x32x16_bf16 v[16:31], v[232:235], v[124:127], v[16:31]
    buffer_load_dwordx4 v[172:175], v2, s[8:11], s81 offen offset:3072 sc1
    s_waitcnt lgkmcnt(2)
    v_mfma_f32_32x32x16_bf16 v[32:47], v[236:239], v[124:127], v[32:47]
    ds_read_b128 v[232:235], v242 offset:13312
    ds_read_b128 v[236:239], v242 offset:54272
    s_waitcnt vmcnt(15) lgkmcnt(3)
    v_mfma_f32_32x32x16_bf16 v[16:31], v[224:227], v[128:131], v[16:31]
    s_add_u32 s81, s81, 4096
    buffer_load_dwordx4 v[176:179], v2, s[8:11], s81 offen offset:0 sc1
    buffer_load_dwordx4 v2, s[8:11], s93 offen offset:2048 lds
    s_waitcnt lgkmcnt(2)
    v_mfma_f32_32x32x16_bf16 v[32:47], v[228:231], v[128:131], v[32:47]
    ds_read_b128 v[224:227], v242 offset:14336
    ds_read_b128 v[228:231], v242 offset:55296
    s_waitcnt vmcnt(15) lgkmcnt(3)
    v_mfma_f32_32x32x16_bf16 v[16:31], v[232:235], v[132:135], v[16:31]
    buffer_load_dwordx4 v[180:183], v2, s[8:11], s81 offen offset:1024 sc1
    s_waitcnt lgkmcnt(2)
    v_mfma_f32_32x32x16_bf16 v[32:47], v[236:239], v[132:135], v[32:47]
    ds_read_b128 v[232:235], v242 offset:15360
    ds_read_b128 v[236:239], v242 offset:56320
    s_waitcnt vmcnt(14) lgkmcnt(3)
    v_mfma_f32_32x32x16_bf16 v[16:31], v[224:227], v[136:139], v[16:31]
    buffer_load_dwordx4 v[184:187], v2, s[8:11], s81 offen offset:2048 sc1
    buffer_load_dwordx4 v2, s[8:11], s93 offen offset:3072 lds
    s_waitcnt lgkmcnt(2)
    v_mfma_f32_32x32x16_bf16 v[32:47], v[228:231], v[136:139], v[32:47]
    ds_read_b128 v[224:227], v242 offset:16384
    ds_read_b128 v[228:231], v242 offset:57344
    s_waitcnt vmcnt(15) lgkmcnt(3)
    v_mfma_f32_32x32x16_bf16 v[16:31], v[232:235], v[140:143], v[16:31]
    buffer_load_dwordx4 v[188:191], v2, s[8:11], s81 offen offset:3072 sc1
    s_waitcnt lgkmcnt(2)
    v_mfma_f32_32x32x16_bf16 v[32:47], v[236:239], v[140:143], v[32:47]
    ds_read_b128 v[232:235], v242 offset:17408
    ds_read_b128 v[236:239], v242 offset:58368
    s_waitcnt vmcnt(15) lgkmcnt(3)
    v_mfma_f32_32x32x16_bf16 v[16:31], v[224:227], v[144:147], v[16:31]
    s_add_u32 s81, s81, 4096
    buffer_load_dwordx4 v[192:195], v2, s[8:11], s81 offen offset:0 sc1
    s_add_u32 s94, s94, 4096
    s_mov_b32 m0, s94
    s_add_u32 s93, s93, 4096
    buffer_load_dwordx4 v2, s[8:11], s93 offen offset:0 lds
    s_waitcnt lgkmcnt(2)
    v_mfma_f32_32x32x16_bf16 v[32:47], v[228:231], v[144:147], v[32:47]
    ds_read_b128 v[224:227], v242 offset:18432
    ds_read_b128 v[228:231], v242 offset:59392
    s_waitcnt vmcnt(16) lgkmcnt(3)
    v_mfma_f32_32x32x16_bf16 v[16:31], v[232:235], v[148:151], v[16:31]
    buffer_load_dwordx4 v[196:199], v2, s[8:11], s81 offen offset:1024 sc1
    s_waitcnt lgkmcnt(2)
    v_mfma_f32_32x32x16_bf16 v[32:47], v[236:239], v[148:151], v[32:47]
    ds_read_b128 v[232:235], v242 offset:19456
    ds_read_b128 v[236:239], v242 offset:60416
    s_waitcnt vmcnt(16) lgkmcnt(3)
    v_mfma_f32_32x32x16_bf16 v[16:31], v[224:227], v[152:155], v[16:31]
    buffer_load_dwordx4 v[200:203], v2, s[8:11], s81 offen offset:2048 sc1
    s_waitcnt lgkmcnt(2)
    v_mfma_f32_32x32x16_bf16 v[32:47], v[228:231], v[152:155], v[32:47]
    ds_read_b128 v[224:227], v242 offset:20480
    ds_read_b128 v[228:231], v242 offset:61440
    s_waitcnt vmcnt(16) lgkmcnt(3)
    v_mfma_f32_32x32x16_bf16 v[16:31], v[232:235], v[156:159], v[16:31]
    buffer_load_dwordx4 v[204:207], v2, s[8:11], s81 offen offset:3072 sc1
    s_waitcnt lgkmcnt(2)
    v_mfma_f32_32x32x16_bf16 v[32:47], v[236:239], v[156:159], v[32:47]
    ds_read_b128 v[232:235], v242 offset:21504
    ds_read_b128 v[236:239], v242 offset:62464
    s_waitcnt vmcnt(16) lgkmcnt(3)
    v_mfma_f32_32x32x16_bf16 v[16:31], v[224:227], v[160:163], v[16:31]
    s_add_u32 s81, s81, 4096
    buffer_load_dwordx4 v[208:211], v2, s[8:11], s81 offen offset:0 sc1
    v_lshlrev_b32 v59, 4, v1
    s_mov_b32 s70, 1024
    buffer_load_dwordx4 v[252:255], v59, s[8:11], s70 offen sc1
    s_and_b32 s32, s2, 7
    s_lshr_b32 s33, s2, 7
    s_lshl_b32 s33, s33, 7
    s_add_u32 s32, s32, s33
    s_lshl_b32 s32, s32, 2
    s_add_u32 s32, s32, 0
    v_and_b32 v61, 15, v1
    v_lshlrev_b32 v61, 5, v61
    buffer_load_dword v60, v61, s[8:11], s32 offen sc1
    s_waitcnt lgkmcnt(2)
    v_mfma_f32_32x32x16_bf16 v[32:47], v[228:231], v[160:163], v[32:47]
    ds_read_b128 v[224:227], v242 offset:22528
    ds_read_b128 v[228:231], v242 offset:63488
    s_waitcnt vmcnt(17) lgkmcnt(3)
    v_mfma_f32_32x32x16_bf16 v[16:31], v[232:235], v[164:167], v[16:31]
    buffer_load_dwordx4 v[212:215], v2, s[8:11], s81 offen offset:1024 sc1
    s_waitcnt lgkmcnt(2)
    v_mfma_f32_32x32x16_bf16 v[32:47], v[236:239], v[164:167], v[32:47]
    ds_read_b128 v[232:235], v242 offset:23552
    ds_read_b128 v[236:239], v242 offset:64512
    s_waitcnt vmcnt(17) lgkmcnt(3)
    v_mfma_f32_32x32x16_bf16 v[16:31], v[224:227], v[168:171], v[16:31]
    buffer_load_dwordx4 v[216:219], v2, s[8:11], s81 offen offset:2048 sc1
    s_waitcnt lgkmcnt(2)
    v_mfma_f32_32x32x16_bf16 v[32:47], v[228:231], v[168:171], v[32:47]
    ds_read_b128 v[224:227], v242 offset:24576
    ds_read_b128 v[228:231], v243 offset:0
    s_waitcnt vmcnt(16) lgkmcnt(3)
    v_mfma_f32_32x32x16_bf16 v[16:31], v[232:235], v[172:175], v[16:31]
    buffer_load_dwordx4 v[220:223], v2, s[8:11], s81 offen offset:3072 sc1
    s_waitcnt lgkmcnt(2)
    v_mfma_f32_32x32x16_bf16 v[32:47], v[236:239], v[172:175], v[32:47]
    ds_read_b128 v[232:235], v242 offset:25600
    ds_read_b128 v[236:239], v243 offset:1024
    s_waitcnt vmcnt(16) lgkmcnt(3)
    v_mfma_f32_32x32x16_bf16 v[16:31], v[224:227], v[176:179], v[16:31]
    s_sub_u32 s32, s24, 0
    s_mul_i32 s32, s32, 5120
    s_add_u32 s93, s32, s90
    s_add_u32 s93, s93, 102400
    s_add_u32 s94, s32, 0
    s_mov_b32 m0, s94
    s_waitcnt lgkmcnt(2)
    v_mfma_f32_32x32x16_bf16 v[32:47], v[228:231], v[176:179], v[32:47]
    ds_read_b128 v[224:227], v242 offset:26624
    ds_read_b128 v[228:231], v243 offset:2048
    s_waitcnt vmcnt(14) lgkmcnt(3)
    v_mfma_f32_32x32x16_bf16 v[16:31], v[232:235], v[180:183], v[16:31]
    buffer_load_dwordx4 v2, s[8:11], s93 offen offset:0 lds
    v_add_f32 v48, v50, v52
    v_add_f32 v49, v51, v53
    s_waitcnt lgkmcnt(2)
    v_mfma_f32_32x32x16_bf16 v[32:47], v[236:239], v[180:183], v[32:47]
    ds_read_b128 v[232:235], v242 offset:27648
    ds_read_b128 v[236:239], v243 offset:3072
    s_waitcnt vmcnt(14) lgkmcnt(3)
    v_mfma_f32_32x32x16_bf16 v[16:31], v[224:227], v[184:187], v[16:31]
    buffer_load_dwordx4 v2, s[8:11], s93 offen offset:1024 lds
    v_add_f32 v50, v54, v56
    v_add_f32 v51, v55, v57
    s_waitcnt lgkmcnt(2)
    v_mfma_f32_32x32x16_bf16 v[32:47], v[228:231], v[184:187], v[32:47]
    ds_read_b128 v[224:227], v242 offset:28672
    ds_read_b128 v[228:231], v243 offset:4096
    s_waitcnt vmcnt(13) lgkmcnt(3)
    v_mfma_f32_32x32x16_bf16 v[16:31], v[232:235], v[188:191], v[16:31]
    buffer_load_dwordx4 v2, s[8:11], s93 offen offset:2048 lds
    v_add_f32 v48, v48, v50
    v_add_f32 v49, v49, v51
    v_mov_b32 v50, v48
    s_waitcnt lgkmcnt(2)
    v_mfma_f32_32x32x16_bf16 v[32:47], v[236:239], v[188:191], v[32:47]
    ds_read_b128 v[232:235], v242 offset:29696
    ds_read_b128 v[236:239], v243 offset:5120
    s_waitcnt vmcnt(13) lgkmcnt(3)
    v_mfma_f32_32x32x16_bf16 v[16:31], v[224:227], v[192:195], v[16:31]
    buffer_load_dwordx4 v2, s[8:11], s93 offen offset:3072 lds
    v_mov_b32 v51, v49
    v_permlane32_swap_b32 v48, v50
    s_waitcnt lgkmcnt(2)
    v_mfma_f32_32x32x16_bf16 v[32:47], v[228:231], v[192:195], v[32:47]
    ds_read_b128 v[224:227], v242 offset:30720
    ds_read_b128 v[228:231], v243 offset:6144
    s_waitcnt vmcnt(12) lgkmcnt(3)
    v_mfma_f32_32x32x16_bf16 v[16:31], v[232:235], v[196:199], v[16:31]
    s_add_u32 s94, s94, 4096
    s_mov_b32 m0, s94
    s_add_u32 s93, s93, 4096
    buffer_load_dwordx4 v2, s[8:11], s93 offen offset:0 lds
    v_permlane32_swap_b32 v49, v51
    v_add_f32 v48, v48, v50
    v_add_f32 v49, v49, v51
    s_waitcnt lgkmcnt(2)
    v_mfma_f32_32x32x16_bf16 v[32:47], v[236:239], v[196:199], v[32:47]
    ds_read_b128 v[232:235], v242 offset:31744
    ds_read_b128 v[236:239], v243 offset:7168
    s_waitcnt vmcnt(12) lgkmcnt(3)
    v_mfma_f32_32x32x16_bf16 v[16:31], v[224:227], v[200:203], v[16:31]
    v_mul_f32 v48, 0x3acccccd, v48
    v_mul_f32 v49, 0x3acccccd, v49
    s_waitcnt lgkmcnt(2)
    v_mfma_f32_32x32x16_bf16 v[32:47], v[228:231], v[200:203], v[32:47]
    ds_read_b128 v[224:227], v242 offset:32768
    ds_read_b128 v[228:231], v243 offset:8192
    s_waitcnt vmcnt(11) lgkmcnt(3)
    v_mfma_f32_32x32x16_bf16 v[16:31], v[232:235], v[204:207], v[16:31]
    v_fma_f32 v49, -v48, v48, v49
    v_max_f32 v49, 0, v49
    v_add_f32 v50, 0x3727c5ac, v49
    s_waitcnt lgkmcnt(2)
    v_mfma_f32_32x32x16_bf16 v[32:47], v[236:239], v[204:207], v[32:47]
    ds_read_b128 v[232:235], v242 offset:33792
    ds_read_b128 v[236:239], v243 offset:9216
    s_waitcnt vmcnt(10) lgkmcnt(3)
    v_mfma_f32_32x32x16_bf16 v[16:31], v[224:227], v[208:211], v[16:31]
    v_rsq_f32 v240, v50
    v_mov_b32 v246, 0
    s_waitcnt lgkmcnt(2)
    v_mfma_f32_32x32x16_bf16 v[32:47], v[228:231], v[208:211], v[32:47]
    ds_read_b128 v[224:227], v242 offset:34816
    ds_read_b128 v[228:231], v243 offset:10240
    s_waitcnt vmcnt(7) lgkmcnt(3)
    v_mfma_f32_32x32x16_bf16 v[16:31], v[232:235], v[212:215], v[16:31]
    v_sub_f32 v48, 0, v48
    v_cvt_pk_bf16_f32 v244, v48, v48
    v_and_b32 v52, 0xffff0000, v244
    s_waitcnt lgkmcnt(2)
    v_mfma_f32_32x32x16_bf16 v[32:47], v[236:239], v[212:215], v[32:47]
    ds_read_b128 v[232:235], v242 offset:35840
    ds_read_b128 v[236:239], v243 offset:11264
    s_waitcnt vmcnt(6) lgkmcnt(3)
    v_mfma_f32_32x32x16_bf16 v[16:31], v[224:227], v[216:219], v[16:31]
    v_sub_f32 v52, v48, v52
    v_cvt_pk_bf16_f32 v245, v52, v52
    s_waitcnt lgkmcnt(2)
    v_mfma_f32_32x32x16_bf16 v[32:47], v[228:231], v[216:219], v[32:47]
    s_waitcnt vmcnt(5) lgkmcnt(1)
    v_mfma_f32_32x32x16_bf16 v[16:31], v[232:235], v[220:223], v[16:31]
    v_cndmask_b32 v244, 0, v244, s[66:67]
    v_cndmask_b32 v245, 0, v245, s[66:67]
    v_mov_b32 v247, 0
    s_waitcnt lgkmcnt(0)
    v_mfma_f32_32x32x16_bf16 v[32:47], v[236:239], v[220:223], v[32:47]
    s_add_u32 s71, s30, 1
    v_subrev_u32 v252, s71, v252
    v_subrev_u32 v253, s71, v253
    v_subrev_u32 v254, s71, v254
    v_subrev_u32 v255, s71, v255
    v_or_b32 v252, v252, v253
    v_or3_b32 v252, v252, v254, v255
    v_cmp_eq_u32 vcc, 0, v252
    s_nop 0
    s_cmp_eq_u64 vcc, exec
    s_cbranch_scc1 L_fb_async_ok
    s_mov_b32 s70, 1024
    s_cmp_lg_u32 s24, 0
    s_cbranch_scc1 L_po_fb_done
    s_mov_b64 s[64:65], exec
    v_mul_u32_u24 v255, 16, v1
    s_mov_b32 s33, 0
L_po_fb:
    buffer_load_dwordx4 v[248:251], v255, s[8:11], s70 offen sc1
    s_waitcnt vmcnt(0)
    v_subrev_u32 v248, s71, v248
    v_subrev_u32 v249, s71, v249
    v_subrev_u32 v250, s71, v250
    v_subrev_u32 v251, s71, v251
    v_max_u32 v254, v248, v249
    v_max3_u32 v254, v254, v250, v251
    v_cmp_gt_u32 vcc, 1, v254
    s_add_u32 s33, s33, 1
    s_cmp_eq_u64 vcc, exec
    s_cbranch_scc1 L_po_fb_ok
    s_sleep 2
    s_cmp_lt_u32 s33, 0x100000
    s_cbranch_scc1 L_po_fb
    v_mov_b32 v254, 40
    v_mov_b32 v255, s2
    v_add_u32 v255, 0x1000, v255
    buffer_store_dword v255, v254, s[20:23], 0 offen sc1
L_po_fb_ok:
    s_mov_b64 exec, s[64:65]
L_po_fb_done:
L_fb_async_ok:
    s_add_u32 s33, s30, 1
    s_add_u32 s33, s33, s62
    v_cmp_eq_u32 vcc, s33, v60
    s_nop 0
    s_cmp_eq_u64 vcc, exec
    s_cselect_b32 s84, 1, 0
    s_add_u32 s84, s84, 0
    v_accvgpr_read_b32 v224, a0
    v_accvgpr_read_b32 v225, a1
    v_accvgpr_read_b32 v226, a2
    v_accvgpr_read_b32 v227, a3
    v_accvgpr_read_b32 v228, a4
    v_accvgpr_read_b32 v229, a5
    v_accvgpr_read_b32 v230, a6
    v_accvgpr_read_b32 v231, a7
    v_add_f32 v224, v224, v225
    v_add_f32 v226, v226, v227
    v_add_f32 v228, v228, v229
    v_add_f32 v230, v230, v231
    v_add_f32 v224, v224, v226
    v_add_f32 v228, v228, v230
    v_add_f32 v224, v224, v228
    v_cvt_pk_bf16_f32 v225, v224, v224
    v_and_b32 v225, 0xffff0000, v225
    v_sub_f32 v225, v224, v225
    v_cvt_pk_bf16_f32 v248, v224, v225
    v_cndmask_b32 v248, 0, v248, s[66:67]
    v_accvgpr_read_b32 v224, a8
    v_accvgpr_read_b32 v225, a9
    v_accvgpr_read_b32 v226, a10
    v_accvgpr_read_b32 v227, a11
    v_accvgpr_read_b32 v228, a12
    v_accvgpr_read_b32 v229, a13
    v_accvgpr_read_b32 v230, a14
    v_accvgpr_read_b32 v231, a15
    v_add_f32 v224, v224, v225
    v_add_f32 v226, v226, v227
    v_add_f32 v228, v228, v229
    v_add_f32 v230, v230, v231
    v_add_f32 v224, v224, v226
    v_add_f32 v228, v228, v230
    v_add_f32 v224, v224, v228
    v_cvt_pk_bf16_f32 v225, v224, v224
    v_and_b32 v225, 0xffff0000, v225
    v_sub_f32 v225, v224, v225
    v_cvt_pk_bf16_f32 v249, v224, v225
    v_cndmask_b32 v249, 0, v249, s[66:67]
    v_accvgpr_read_b32 v224, a16
    v_accvgpr_read_b32 v225, a17
    v_accvgpr_read_b32 v226, a18
    v_accvgpr_read_b32 v227, a19
    v_accvgpr_read_b32 v228, a20
    v_accvgpr_read_b32 v229, a21
    v_accvgpr_read_b32 v230, a22
    v_accvgpr_read_b32 v231, a23
    v_add_f32 v224, v224, v225
    v_add_f32 v226, v226, v227
    v_add_f32 v228, v228, v229
    v_add_f32 v230, v230, v231
    v_add_f32 v224, v224, v226
    v_add_f32 v228, v228, v230
    v_add_f32 v224, v224, v228
    v_cvt_pk_bf16_f32 v225, v224, v224
    v_and_b32 v225, 0xffff0000, v225
    v_sub_f32 v225, v224, v225
    v_cvt_pk_bf16_f32 v250, v224, v225
    v_cndmask_b32 v250, 0, v250, s[66:67]
    v_accvgpr_read_b32 v224, a24
    v_accvgpr_read_b32 v225, a25
    v_accvgpr_read_b32 v226, a26
    v_accvgpr_read_b32 v227, a27
    v_accvgpr_read_b32 v228, a28
    v_accvgpr_read_b32 v229, a29
    v_accvgpr_read_b32 v230, a30
    v_accvgpr_read_b32 v231, a31
    v_add_f32 v224, v224, v225
    v_add_f32 v226, v226, v227
    v_add_f32 v228, v228, v229
    v_add_f32 v230, v230, v231
    v_add_f32 v224, v224, v226
    v_add_f32 v228, v228, v230
    v_add_f32 v224, v224, v228
    v_cvt_pk_bf16_f32 v225, v224, v224
    v_and_b32 v225, 0xffff0000, v225
    v_sub_f32 v225, v224, v225
    v_cvt_pk_bf16_f32 v251, v224, v225
    v_cndmask_b32 v251, 0, v251, s[66:67]
    buffer_store_dwordx4 v[248:251], v2, s[8:11], s92 offen sc1
    v_mov_b32 v252, v248
    v_mov_b32 v253, v248
    v_mov_b32 v254, 0
    v_mov_b32 v255, 0
    s_nop 1
    v_mfma_f32_32x32x16_bf16 v[16:31], v[252:255], v[244:247], v[16:31]
    v_mov_b32 v252, v249
    v_mov_b32 v253, v249
    v_mov_b32 v254, 0
    v_mov_b32 v255, 0
    s_nop 1
    v_mfma_f32_32x32x16_bf16 v[32:47], v[252:255], v[244:247], v[32:47]
    s_branch L_dl_p1head_j
L_dl_p1head_1:
    s_mov_b32 s72, 22020096
    s_mov_b32 s73, 24903680
    s_lshl_b32 s32, s25, 2
    s_add_u32 s32, s32, s24
    s_mul_i32 s81, s32, 40960
    s_add_u32 s81, s81, s72
    s_lshl_b32 s33, s32, 11
    s_add_u32 s95, s33, s73
    v_lshlrev_b32 v48, 3, v3
    v_lshlrev_b32 v49, 10, v4
    v_add_u32 v48, v48, v49
    v_add_u32 v242, 0x10000, v2
    v_add_u32 v243, 0x20000, v2
    v_mov_b32 v241, v2
    s_lshl_b32 s70, s25, 8
    s_add_u32 s70, s70, 4096
    s_add_u32 s71, s30, 4
    s_waitcnt vmcnt(0)
    s_cmp_lg_u32 s24, 0
    s_cbranch_scc1 L_po_x2_done
    s_mov_b64 s[64:65], exec
    s_mov_b64 exec, 0xffff
    v_mul_u32_u24 v255, 4, v1
    s_mov_b32 s33, 0
L_po_x2:
    buffer_load_dword v254, v255, s[8:11], s70 offen sc1
    s_waitcnt vmcnt(0)
    v_subrev_u32 v254, s71, v254
    v_cmp_gt_u32 vcc, 8, v254
    s_add_u32 s33, s33, 1
    s_cmp_eq_u64 vcc, exec
    s_cbranch_scc1 L_po_x2_ok
    s_cmp_lt_u32 s33, 0x100000
    s_cbranch_scc1 L_po_x2
    v_mov_b32 v254, 44
    v_mov_b32 v255, s2
    v_add_u32 v255, 0x1000, v255
    buffer_store_dword v255, v254, s[20:23], 0 offen sc1
L_po_x2_ok:
    s_mov_b64 exec, s[64:65]
L_po_x2_done:
    s_barrier
    buffer_load_dwordx4 v[64:67], v2, s[8:11], s81 offen offset:0 sc1
    buffer_load_dwordx4 v[68:71], v2, s[8:11], s81 offen offset:1024 sc1
    buffer_load_dwordx4 v[72:75], v2, s[8:11], s81 offen offset:2048 sc1
    buffer_load_dwordx4 v[76:79], v2, s[8:11], s81 offen offset:3072 sc1
    s_add_u32 s81, s81, 4096
    buffer_load_dwordx4 v[80:83], v2, s[8:11], s81 offen offset:0 sc1
    buffer_load_dwordx4 v[84:87], v2, s[8:11], s81 offen offset:1024 sc1
    buffer_load_dwordx4 v[88:91], v2, s[8:11], s81 offen offset:2048 sc1
    buffer_load_dwordx4 v[92:95], v2, s[8:11], s81 offen offset:3072 sc1
    s_add_u32 s81, s81, 4096
    buffer_load_dwordx4 v[96:99], v2, s[8:11], s81 offen offset:0 sc1
    buffer_load_dwordx4 v[100:103], v2, s[8:11], s81 offen offset:1024 sc1
    buffer_load_dwordx4 v[104:107], v2, s[8:11], s81 offen offset:2048 sc1
    buffer_load_dwordx4 v[108:111], v2, s[8:11], s81 offen offset:3072 sc1
    ds_read_b128 v[224:227], v241 offset:61440
    ds_read_b128 v[228:231], v242 offset:36864
    ds_read_b128 v[232:235], v241 offset:62464
    ds_read_b128 v[236:239], v242 offset:37888
    s_waitcnt vmcnt(11) lgkmcnt(3)
    v_mfma_f32_32x32x16_bf16 v[16:31], v[224:227], v[64:67], 0
    s_add_u32 s81, s81, 4096
    buffer_load_dwordx4 v[112:115], v2, s[8:11], s81 offen offset:0 sc1
    s_waitcnt lgkmcnt(2)
    v_mfma_f32_32x32x16_bf16 v[32:47], v[228:231], v[64:67], 0
    ds_read_b128 v[224:227], v241 offset:63488
    ds_read_b128 v[228:231], v242 offset:38912
    s_waitcnt vmcnt(11) lgkmcnt(3)
    v_mfma_f32_32x32x16_bf16 v[16:31], v[232:235], v[68:71], v[16:31]
    buffer_load_dwordx4 v[116:119], v2, s[8:11], s81 offen offset:1024 sc1
    s_waitcnt lgkmcnt(2)
    v_mfma_f32_32x32x16_bf16 v[32:47], v[236:239], v[68:71], v[32:47]
    ds_read_b128 v[232:235], v241 offset:64512
    ds_read_b128 v[236:239], v242 offset:39936
    s_waitcnt vmcnt(11) lgkmcnt(3)
    v_mfma_f32_32x32x16_bf16 v[16:31], v[224:227], v[72:75], v[16:31]
    buffer_load_dwordx4 v[120:123], v2, s[8:11], s81 offen offset:2048 sc1
    buffer_load_dwordx2 v[50:51], v48, s[8:11], s95 offen offset:0 sc1
    s_waitcnt lgkmcnt(2)
    v_mfma_f32_32x32x16_bf16 v[32:47], v[228:231], v[72:75], v[32:47]
    ds_read_b128 v[224:227], v242 offset:0
    ds_read_b128 v[228:231], v242 offset:40960
    s_waitcnt vmcnt(12) lgkmcnt(3)
    v_mfma_f32_32x32x16_bf16 v[16:31], v[232:235], v[76:79], v[16:31]
    buffer_load_dwordx4 v[124:127], v2, s[8:11], s81 offen offset:3072 sc1
    buffer_load_dwordx2 v[52:53], v48, s[8:11], s95 offen offset:256 sc1
    s_waitcnt lgkmcnt(2)
    v_mfma_f32_32x32x16_bf16 v[32:47], v[236:239], v[76:79], v[32:47]
    ds_read_b128 v[232:235], v242 offset:1024
    ds_read_b128 v[236:239], v242 offset:41984
    s_waitcnt vmcnt(13) lgkmcnt(3)
    v_mfma_f32_32x32x16_bf16 v[16:31], v[224:227], v[80:83], v[16:31]
    s_add_u32 s81, s81, 4096
    buffer_load_dwordx4 v[128:131], v2, s[8:11], s81 offen offset:0 sc1
    buffer_load_dwordx2 v[54:55], v48, s[8:11], s95 offen offset:512 sc1
    s_waitcnt lgkmcnt(2)
    v_mfma_f32_32x32x16_bf16 v[32:47], v[228:231], v[80:83], v[32:47]
    ds_read_b128 v[224:227], v242 offset:2048
    ds_read_b128 v[228:231], v242 offset:43008
    s_waitcnt vmcnt(14) lgkmcnt(3)
    v_mfma_f32_32x32x16_bf16 v[16:31], v[232:235], v[84:87], v[16:31]
    buffer_load_dwordx4 v[132:135], v2, s[8:11], s81 offen offset:1024 sc1
    buffer_load_dwordx2 v[56:57], v48, s[8:11], s95 offen offset:768 sc1
    s_waitcnt lgkmcnt(2)
    v_mfma_f32_32x32x16_bf16 v[32:47], v[236:239], v[84:87], v[32:47]
    ds_read_b128 v[232:235], v242 offset:3072
    ds_read_b128 v[236:239], v242 offset:44032
    s_waitcnt vmcnt(15) lgkmcnt(3)
    v_mfma_f32_32x32x16_bf16 v[16:31], v[224:227], v[88:91], v[16:31]
    buffer_load_dwordx4 v[136:139], v2, s[8:11], s81 offen offset:2048 sc1
    buffer_load_dwordx4 v[248:251], v2, s[8:11], s92 offen offset:0 sc1
    s_waitcnt lgkmcnt(2)
    v_mfma_f32_32x32x16_bf16 v[32:47], v[228:231], v[88:91], v[32:47]
    ds_read_b128 v[224:227], v242 offset:4096
    ds_read_b128 v[228:231], v242 offset:45056
    s_waitcnt vmcnt(16) lgkmcnt(3)
    v_mfma_f32_32x32x16_bf16 v[16:31], v[232:235], v[92:95], v[16:31]
    buffer_load_dwordx4 v[140:143], v2, s[8:11], s81 offen offset:3072 sc1
    s_waitcnt lgkmcnt(2)
    v_mfma_f32_32x32x16_bf16 v[32:47], v[236:239], v[92:95], v[32:47]
    ds_read_b128 v[232:235], v242 offset:5120
    ds_read_b128 v[236:239], v242 offset:46080
    s_waitcnt vmcnt(16) lgkmcnt(3)
    v_mfma_f32_32x32x16_bf16 v[16:31], v[224:227], v[96:99], v[16:31]
    s_add_u32 s81, s81, 4096
    buffer_load_dwordx4 v[144:147], v2, s[8:11], s81 offen offset:0 sc1
    s_waitcnt lgkmcnt(2)
    v_mfma_f32_32x32x16_bf16 v[32:47], v[228:231], v[96:99], v[32:47]
    ds_read_b128 v[224:227], v242 offset:6144
    ds_read_b128 v[228:231], v242 offset:47104
    s_waitcnt vmcnt(16) lgkmcnt(3)
    v_mfma_f32_32x32x16_bf16 v[16:31], v[232:235], v[100:103], v[16:31]
    buffer_load_dwordx4 v[148:151], v2, s[8:11], s81 offen offset:1024 sc1
    s_waitcnt lgkmcnt(2)
    v_mfma_f32_32x32x16_bf16 v[32:47], v[236:239], v[100:103], v[32:47]
    ds_read_b128 v[232:235], v242 offset:7168
    ds_read_b128 v[236:239], v242 offset:48128
    s_waitcnt vmcnt(16) lgkmcnt(3)
    v_mfma_f32_32x32x16_bf16 v[16:31], v[224:227], v[104:107], v[16:31]
    buffer_load_dwordx4 v[152:155], v2, s[8:11], s81 offen offset:2048 sc1
    s_waitcnt lgkmcnt(2)
    v_mfma_f32_32x32x16_bf16 v[32:47], v[228:231], v[104:107], v[32:47]
    ds_read_b128 v[224:227], v242 offset:8192
    ds_read_b128 v[228:231], v242 offset:49152
    s_waitcnt vmcnt(16) lgkmcnt(3)
    v_mfma_f32_32x32x16_bf16 v[16:31], v[232:235], v[108:111], v[16:31]
    buffer_load_dwordx4 v[156:159], v2, s[8:11], s81 offen offset:3072 sc1
    s_waitcnt lgkmcnt(2)
    v_mfma_f32_32x32x16_bf16 v[32:47], v[236:239], v[108:111], v[32:47]
    ds_read_b128 v[232:235], v242 offset:9216
    ds_read_b128 v[236:239], v242 offset:50176
    s_waitcnt vmcnt(16) lgkmcnt(3)
    v_mfma_f32_32x32x16_bf16 v[16:31], v[224:227], v[112:115], v[16:31]
    s_add_u32 s81, s81, 4096
    buffer_load_dwordx4 v[160:163], v2, s[8:11], s81 offen offset:0 sc1
    s_waitcnt lgkmcnt(2)
    v_mfma_f32_32x32x16_bf16 v[32:47], v[228:231], v[112:115], v[32:47]
    ds_read_b128 v[224:227], v242 offset:10240
    ds_read_b128 v[228:231], v242 offset:51200
    s_waitcnt vmcnt(16) lgkmcnt(3)
    v_mfma_f32_32x32x16_bf16 v[16:31], v[232:235], v[116:119], v[16:31]
    buffer_load_dwordx4 v[164:167], v2, s[8:11], s81 offen offset:1024 sc1
    s_waitcnt lgkmcnt(2)
    v_mfma_f32_32x32x16_bf16 v[32:47], v[236:239], v[116:119], v[32:47]
    ds_read_b128 v[232:235], v242 offset:11264
    ds_read_b128 v[236:239], v242 offset:52224
    s_waitcnt vmcnt(16) lgkmcnt(3)
    v_mfma_f32_32x32x16_bf16 v[16:31], v[224:227], v[120:123], v[16:31]
    buffer_load_dwordx4 v[168:171], v2, s[8:11], s81 offen offset:2048 sc1
    s_waitcnt lgkmcnt(2)
    v_mfma_f32_32x32x16_bf16 v[32:47], v[228:231], v[120:123], v[32:47]
    ds_read_b128 v[224:227], v242 offset:12288
    ds_read_b128 v[228:231], v242 offset:53248
    s_waitcnt vmcnt(15) lgkmcnt(3)
    v_mfma_f32_32x32x16_bf16 v[16:31], v[232:235], v[124:127], v[16:31]
    buffer_load_dwordx4 v[172:175], v2, s[8:11], s81 offen offset:3072 sc1
    s_waitcnt lgkmcnt(2)
    v_mfma_f32_32x32x16_bf16 v[32:47], v[236:239], v[124:127], v[32:47]
    ds_read_b128 v[232:235], v242 offset:13312
    ds_read_b128 v[236:239], v242 offset:54272
    s_waitcnt vmcnt(14) lgkmcnt(3)
    v_mfma_f32_32x32x16_bf16 v[16:31], v[224:227], v[128:131], v[16:31]
    s_add_u32 s81, s81, 4096
    buffer_load_dwordx4 v[176:179], v2, s[8:11], s81 offen offset:0 sc1
    s_waitcnt lgkmcnt(2)
    v_mfma_f32_32x32x16_bf16 v[32:47], v[228:231], v[128:131], v[32:47]
    ds_read_b128 v[224:227], v242 offset:14336
    ds_read_b128 v[228:231], v242 offset:55296
    s_waitcnt vmcnt(13) lgkmcnt(3)
    v_mfma_f32_32x32x16_bf16 v[16:31], v[232:235], v[132:135], v[16:31]
    buffer_load_dwordx4 v[180:183], v2, s[8:11], s81 offen offset:1024 sc1
    s_waitcnt lgkmcnt(2)
    v_mfma_f32_32x32x16_bf16 v[32:47], v[236:239], v[132:135], v[32:47]
    ds_read_b128 v[232:235], v242 offset:15360
    ds_read_b128 v[236:239], v242 offset:56320
    s_waitcnt vmcnt(12) lgkmcnt(3)
    v_mfma_f32_32x32x16_bf16 v[16:31], v[224:227], v[136:139], v[16:31]
    buffer_load_dwordx4 v[184:187], v2, s[8:11], s81 offen offset:2048 sc1
    s_waitcnt lgkmcnt(2)
    v_mfma_f32_32x32x16_bf16 v[32:47], v[228:231], v[136:139], v[32:47]
    ds_read_b128 v[224:227], v242 offset:16384
    ds_read_b128 v[228:231], v242 offset:57344
    s_waitcnt vmcnt(11) lgkmcnt(3)
    v_mfma_f32_32x32x16_bf16 v[16:31], v[232:235], v[140:143], v[16:31]
    buffer_load_dwordx4 v[188:191], v2, s[8:11], s81 offen offset:3072 sc1
    s_waitcnt lgkmcnt(2)
    v_mfma_f32_32x32x16_bf16 v[32:47], v[236:239], v[140:143], v[32:47]
    ds_read_b128 v[232:235], v242 offset:17408
    ds_read_b128 v[236:239], v242 offset:58368
    s_waitcnt vmcnt(11) lgkmcnt(3)
    v_mfma_f32_32x32x16_bf16 v[16:31], v[224:227], v[144:147], v[16:31]
    s_add_u32 s81, s81, 4096
    buffer_load_dwordx4 v[192:195], v2, s[8:11], s81 offen offset:0 sc1
    s_waitcnt lgkmcnt(2)
    v_mfma_f32_32x32x16_bf16 v[32:47], v[228:231], v[144:147], v[32:47]
    ds_read_b128 v[224:227], v242 offset:18432
    ds_read_b128 v[228:231], v242 offset:59392
    s_waitcnt vmcnt(11) lgkmcnt(3)
    v_mfma_f32_32x32x16_bf16 v[16:31], v[232:235], v[148:151], v[16:31]
    buffer_load_dwordx4 v[196:199], v2, s[8:11], s81 offen offset:1024 sc1
    s_waitcnt lgkmcnt(2)
    v_mfma_f32_32x32x16_bf16 v[32:47], v[236:239], v[148:151], v[32:47]
    ds_read_b128 v[232:235], v242 offset:19456
    ds_read_b128 v[236:239], v242 offset:60416
    s_waitcnt vmcnt(11) lgkmcnt(3)
    v_mfma_f32_32x32x16_bf16 v[16:31], v[224:227], v[152:155], v[16:31]
    buffer_load_dwordx4 v[200:203], v2, s[8:11], s81 offen offset:2048 sc1
    s_waitcnt lgkmcnt(2)
    v_mfma_f32_32x32x16_bf16 v[32:47], v[228:231], v[152:155], v[32:47]
    ds_read_b128 v[224:227], v242 offset:20480
    ds_read_b128 v[228:231], v242 offset:61440
    s_waitcnt vmcnt(11) lgkmcnt(3)
    v_mfma_f32_32x32x16_bf16 v[16:31], v[232:235], v[156:159], v[16:31]
    buffer_load_dwordx4 v[204:207], v2, s[8:11], s81 offen offset:3072 sc1
    s_waitcnt lgkmcnt(2)
    v_mfma_f32_32x32x16_bf16 v[32:47], v[236:239], v[156:159], v[32:47]
    ds_read_b128 v[232:235], v242 offset:21504
    ds_read_b128 v[236:239], v242 offset:62464
    s_waitcnt vmcnt(11) lgkmcnt(3)
    v_mfma_f32_32x32x16_bf16 v[16:31], v[224:227], v[160:163], v[16:31]
    s_add_u32 s81, s81, 4096
    buffer_load_dwordx4 v[208:211], v2, s[8:11], s81 offen offset:0 sc1
    s_waitcnt lgkmcnt(2)
    v_mfma_f32_32x32x16_bf16 v[32:47], v[228:231], v[160:163], v[32:47]
    ds_read_b128 v[224:227], v242 offset:22528
    ds_read_b128 v[228:231], v242 offset:63488
    s_waitcnt vmcnt(11) lgkmcnt(3)
    v_mfma_f32_32x32x16_bf16 v[16:31], v[232:235], v[164:167], v[16:31]
    buffer_load_dwordx4 v[212:215], v2, s[8:11], s81 offen offset:1024 sc1
    s_waitcnt lgkmcnt(2)
    v_mfma_f32_32x32x16_bf16 v[32:47], v[236:239], v[164:167], v[32:47]
    ds_read_b128 v[232:235], v242 offset:23552
    ds_read_b128 v[236:239], v242 offset:64512
    s_waitcnt vmcnt(11) lgkmcnt(3)
    v_mfma_f32_32x32x16_bf16 v[16:31], v[224:227], v[168:171], v[16:31]
    buffer_load_dwordx4 v[216:219], v2, s[8:11], s81 offen offset:2048 sc1
    s_waitcnt lgkmcnt(2)
    v_mfma_f32_32x32x16_bf16 v[32:47], v[228:231], v[168:171], v[32:47]
    ds_read_b128 v[224:227], v242 offset:24576
    ds_read_b128 v[228:231], v243 offset:0
    s_waitcnt vmcnt(11) lgkmcnt(3)
    v_mfma_f32_32x32x16_bf16 v[16:31], v[232:235], v[172:175], v[16:31]
    buffer_load_dwordx4 v[220:223], v2, s[8:11], s81 offen offset:3072 sc1
    s_waitcnt lgkmcnt(2)
    v_mfma_f32_32x32x16_bf16 v[32:47], v[236:239], v[172:175], v[32:47]
    ds_read_b128 v[232:235], v242 offset:25600
    ds_read_b128 v[236:239], v243 offset:1024
    s_waitcnt vmcnt(11) lgkmcnt(3)
    v_mfma_f32_32x32x16_bf16 v[16:31], v[224:227], v[176:179], v[16:31]
    s_sub_u32 s32, s24, 0
    s_mul_i32 s32, s32, 5120
    s_add_u32 s93, s32, s90
    s_add_u32 s93, s93, 102400
    s_add_u32 s94, s32, 0
    s_mov_b32 m0, s94
    s_waitcnt lgkmcnt(2)
    v_mfma_f32_32x32x16_bf16 v[32:47], v[228:231], v[176:179], v[32:47]
    ds_read_b128 v[224:227], v242 offset:26624
    ds_read_b128 v[228:231], v243 offset:2048
    s_waitcnt vmcnt(10) lgkmcnt(3)
    v_mfma_f32_32x32x16_bf16 v[16:31], v[232:235], v[180:183], v[16:31]
    buffer_load_dwordx4 v2, s[8:11], s93 offen offset:0 lds
    v_add_f32 v48, v50, v52
    v_add_f32 v49, v51, v53
    s_waitcnt lgkmcnt(2)
    v_mfma_f32_32x32x16_bf16 v[32:47], v[236:239], v[180:183], v[32:47]
    ds_read_b128 v[232:235], v242 offset:27648
    ds_read_b128 v[236:239], v243 offset:3072
    s_waitcnt vmcnt(10) lgkmcnt(3)
    v_mfma_f32_32x32x16_bf16 v[16:31], v[224:227], v[184:187], v[16:31]
    buffer_load_dwordx4 v2, s[8:11], s93 offen offset:1024 lds
    v_add_f32 v50, v54, v56
    v_add_f32 v51, v55, v57
    s_waitcnt lgkmcnt(2)
    v_mfma_f32_32x32x16_bf16 v[32:47], v[228:231], v[184:187], v[32:47]
    ds_read_b128 v[224:227], v242 offset:28672
    ds_read_b128 v[228:231], v243 offset:4096
    s_waitcnt vmcnt(10) lgkmcnt(3)
    v_mfma_f32_32x32x16_bf16 v[16:31], v[232:235], v[188:191], v[16:31]
    buffer_load_dwordx4 v2, s[8:11], s93 offen offset:2048 lds
    v_add_f32 v48, v48, v50
    v_add_f32 v49, v49, v51
    v_mov_b32 v50, v48
    s_waitcnt lgkmcnt(2)
    v_mfma_f32_32x32x16_bf16 v[32:47], v[236:239], v[188:191], v[32:47]
    ds_read_b128 v[232:235], v242 offset:29696
    ds_read_b128 v[236:239], v243 offset:5120
    s_waitcnt vmcnt(10) lgkmcnt(3)
    v_mfma_f32_32x32x16_bf16 v[16:31], v[224:227], v[192:195], v[16:31]
    buffer_load_dwordx4 v2, s[8:11], s93 offen offset:3072 lds
    v_mov_b32 v51, v49
    v_permlane32_swap_b32 v48, v50
    s_waitcnt lgkmcnt(2)
    v_mfma_f32_32x32x16_bf16 v[32:47], v[228:231], v[192:195], v[32:47]
    ds_read_b128 v[224:227], v242 offset:30720
    ds_read_b128 v[228:231], v243 offset:6144
    s_waitcnt vmcnt(10) lgkmcnt(3)
    v_mfma_f32_32x32x16_bf16 v[16:31], v[232:235], v[196:199], v[16:31]
    s_add_u32 s94, s94, 4096
    s_mov_b32 m0, s94
    s_add_u32 s93, s93, 4096
    buffer_load_dwordx4 v2, s[8:11], s93 offen offset:0 lds
    v_permlane32_swap_b32 v49, v51
    v_add_f32 v48, v48, v50
    v_add_f32 v49, v49, v51
    s_waitcnt lgkmcnt(2)
    v_mfma_f32_32x32x16_bf16 v[32:47], v[236:239], v[196:199], v[32:47]
    ds_read_b128 v[232:235], v242 offset:31744
    ds_read_b128 v[236:239], v243 offset:7168
    s_waitcnt vmcnt(10) lgkmcnt(3)
    v_mfma_f32_32x32x16_bf16 v[16:31], v[224:227], v[200:203], v[16:31]
    v_mul_f32 v48, 0x3acccccd, v48
    v_mul_f32 v49, 0x3acccccd, v49
    s_waitcnt lgkmcnt(2)
    v_mfma_f32_32x32x16_bf16 v[32:47], v[228:231], v[200:203], v[32:47]
    ds_read_b128 v[224:227], v242 offset:32768
    ds_read_b128 v[228:231], v243 offset:8192
    s_waitcnt vmcnt(9) lgkmcnt(3)
    v_mfma_f32_32x32x16_bf16 v[16:31], v[232:235], v[204:207], v[16:31]
    v_fma_f32 v49, -v48, v48, v49
    v_max_f32 v49, 0, v49
    v_add_f32 v50, 0x3727c5ac, v49
    s_waitcnt lgkmcnt(2)
    v_mfma_f32_32x32x16_bf16 v[32:47], v[236:239], v[204:207], v[32:47]
    ds_read_b128 v[232:235], v242 offset:33792
    ds_read_b128 v[236:239], v243 offset:9216
    s_waitcnt vmcnt(8) lgkmcnt(3)
    v_mfma_f32_32x32x16_bf16 v[16:31], v[224:227], v[208:211], v[16:31]
    v_rsq_f32 v240, v50
    v_mov_b32 v246, 0
    s_waitcnt lgkmcnt(2)
    v_mfma_f32_32x32x16_bf16 v[32:47], v[228:231], v[208:211], v[32:47]
    ds_read_b128 v[224:227], v242 offset:34816
    ds_read_b128 v[228:231], v243 offset:10240
    s_waitcnt vmcnt(7) lgkmcnt(3)
    v_mfma_f32_32x32x16_bf16 v[16:31], v[232:235], v[212:215], v[16:31]
    v_sub_f32 v48, 0, v48
    v_cvt_pk_bf16_f32 v244, v48, v48
    v_and_b32 v52, 0xffff0000, v244
    s_waitcnt lgkmcnt(2)
    v_mfma_f32_32x32x16_bf16 v[32:47], v[236:239], v[212:215], v[32:47]
    ds_read_b128 v[232:235], v242 offset:35840
    ds_read_b128 v[236:239], v243 offset:11264
    s_waitcnt vmcnt(6) lgkmcnt(3)
    v_mfma_f32_32x32x16_bf16 v[16:31], v[224:227], v[216:219], v[16:31]
    v_sub_f32 v52, v48, v52
    v_cvt_pk_bf16_f32 v245, v52, v52
    s_waitcnt lgkmcnt(2)
    v_mfma_f32_32x32x16_bf16 v[32:47], v[228:231], v[216:219], v[32:47]
    s_waitcnt vmcnt(5) lgkmcnt(1)
    v_mfma_f32_32x32x16_bf16 v[16:31], v[232:235], v[220:223], v[16:31]
    v_cndmask_b32 v244, 0, v244, s[66:67]
    v_cndmask_b32 v245, 0, v245, s[66:67]
    v_mov_b32 v247, 0
    s_waitcnt lgkmcnt(0)
    v_mfma_f32_32x32x16_bf16 v[32:47], v[236:239], v[220:223], v[32:47]
    v_mov_b32 v252, v248
    v_mov_b32 v253, v248
    v_mov_b32 v254, 0
    v_mov_b32 v255, 0
    s_nop 1
    v_mfma_f32_32x32x16_bf16 v[16:31], v[252:255], v[244:247], v[16:31]
    v_mov_b32 v252, v249
    v_mov_b32 v253, v249
    v_mov_b32 v254, 0
    v_mov_b32 v255, 0
    s_nop 1
    v_mfma_f32_32x32x16_bf16 v[32:47], v[252:255], v[244:247], v[32:47]
L_dl_p1head_j:
    s_barrier
    s_cmp_eq_u32 s29, 0
    s_cbranch_scc0 L_ol_w1c
    v_lshlrev_b32 v252, 5, v3
    s_mul_i32 s33, s26, 3
    s_add_u32 s33, s33, 64
    s_lshl_b32 s33, s33, 10
    s_add_u32 s33, s33, 10092544
    buffer_load_dwordx4 a[160:163], v252, s[8:11], s33 offen offset:0 sc1
    buffer_load_dwordx4 a[164:167], v252, s[8:11], s33 offen offset:16 sc1
    buffer_load_dwordx4 a[168:171], v252, s[8:11], s33 offen offset:1024 sc1
    buffer_load_dwordx4 a[172:175], v252, s[8:11], s33 offen offset:1040 sc1
    buffer_load_dwordx4 a[176:179], v252, s[8:11], s33 offen offset:2048 sc1
    buffer_load_dwordx4 a[180:183], v252, s[8:11], s33 offen offset:2064 sc1
    s_mov_b32 s12, s50
    s_and_b32 s13, s51, 0xffff
    s_mov_b32 s14, 3072
    s_mov_b32 s15, 0x00020000
    v_lshlrev_b32 v253, 1, v3
    s_mul_i32 s33, s26, 192
    buffer_load_ushort a184, v253, s[12:15], s33 offen offset:0
    buffer_load_ushort a185, v253, s[12:15], s33 offen offset:64
    buffer_load_ushort a186, v253, s[12:15], s33 offen offset:128
L_ol_w1c:
    s_sub_u32 s32, s24, 0
    s_mul_i32 s32, s32, 10240
    s_add_u32 s93, s32, s90
    s_add_u32 s93, s93, 122880
    s_add_u32 s94, s32, 20480
    s_mov_b32 m0, s94
    ds_read_b128 v[224:227], v243 offset:12288
    ds_read_b128 v[228:231], v243 offset:13312
    ds_read_b128 v[232:235], v243 offset:14336
    v_mov_b32 v252, v250
    v_mov_b32 v253, v250
    v_mov_b32 v254, 0
    v_mov_b32 v255, 0
    s_nop 1
    v_mfma_f32_32x32x16_bf16 v[48:63], v[252:255], v[244:247], 0
    s_waitcnt lgkmcnt(2)
    v_mfma_f32_32x32x16_bf16 v[48:63], v[224:227], v[64:67], v[48:63]
    buffer_load_dwordx4 v2, s[8:11], s93 offen offset:0 lds
    ds_read_b128 v[224:227], v243 offset:15360
    s_lshl_b32 s75, s24, 5
    v_add_u32 v5, s75, v3
    v_mul_u32_u24 v0, 80, v5
    v_mul_u32_u24 v5, 40, v4
    v_add_u32 v0, v0, v5
    v_add_u32 v0, 61440, v0
    s_waitcnt lgkmcnt(2)
    v_mfma_f32_32x32x16_bf16 v[48:63], v[228:231], v[68:71], v[48:63]
    ds_read_b128 v[228:231], v243 offset:16384
    v_mul_f32 v5, 0x3fb8aa3b, v240
    v_cvt_pk_bf16_f32 v16, v16, v17
    v_cvt_pk_bf16_f32 v17, v18, v19
    v_cvt_pk_bf16_f32 v18, v20, v21
    v_cvt_pk_bf16_f32 v19, v22, v23
    v_cvt_pk_bf16_f32 v20, v24, v25
    v_cvt_pk_bf16_f32 v21, v26, v27
    s_waitcnt lgkmcnt(2)
    v_mfma_f32_32x32x16_bf16 v[48:63], v[232:235], v[72:75], v[48:63]
    buffer_load_dwordx4 v2, s[8:11], s93 offen offset:1024 lds
    ds_read_b128 v[232:235], v243 offset:17408
    v_cvt_pk_bf16_f32 v22, v28, v29
    v_cvt_pk_bf16_f32 v23, v30, v31
    v_cvt_pk_bf16_f32 v24, v32, v33
    v_cvt_pk_bf16_f32 v25, v34, v35
    v_mul_f32 v36, v36, v240
    v_mul_f32 v37, v37, v240
    v_cvt_pk_bf16_f32 v26, v36, v37
    s_waitcnt lgkmcnt(2)
    v_mfma_f32_32x32x16_bf16 v[48:63], v[224:227], v[76:79], v[48:63]
    ds_read_b128 v[224:227], v243 offset:18432
    v_mul_f32 v38, v38, v240
    v_mul_f32 v39, v39, v240
    v_cvt_pk_bf16_f32 v27, v38, v39
    v_mul_f32 v40, v40, v240
    v_mul_f32 v41, v41, v240
    v_cvt_pk_bf16_f32 v28, v40, v41
    v_mul_f32 v42, v42, v240
    s_waitcnt lgkmcnt(2)
    v_mfma_f32_32x32x16_bf16 v[48:63], v[228:231], v[80:83], v[48:63]
    buffer_load_dwordx4 v2, s[8:11], s93 offen offset:2048 lds
    ds_read_b128 v[228:231], v243 offset:19456
    v_mul_f32 v43, v43, v240
    v_cvt_pk_bf16_f32 v29, v42, v43
    v_mul_f32 v44, v44, v240
    v_mul_f32 v45, v45, v240
    v_cvt_pk_bf16_f32 v30, v44, v45
    v_mul_f32 v46, v46, v240
    v_mul_f32 v47, v47, v240
    s_waitcnt lgkmcnt(2)
    v_mfma_f32_32x32x16_bf16 v[48:63], v[232:235], v[84:87], v[48:63]
    ds_read_b128 v[232:235], v243 offset:20480
    v_cvt_pk_bf16_f32 v31, v46, v47
    v_mfma_f32_32x32x16_bf16 v[32:47], a[240:243], v[16:19], 0
    v_mfma_f32_32x32x16_bf16 v[32:47], a[244:247], v[20:23], v[32:47]
    s_nop 11
    v_max3_f32 v252, v32, v33, v34
    v_min3_f32 v253, v32, v33, v34
    v_max3_f32 v252, v252, v35, v36
    v_min3_f32 v253, v253, v35, v36
    s_waitcnt lgkmcnt(2)
    v_mfma_f32_32x32x16_bf16 v[48:63], v[224:227], v[88:91], v[48:63]
    buffer_load_dwordx4 v2, s[8:11], s93 offen offset:3072 lds
    ds_read_b128 v[224:227], v243 offset:21504
    v_max3_f32 v252, v252, v37, v38
    v_min3_f32 v253, v253, v37, v38
    v_max3_f32 v252, v252, v39, v40
    v_min3_f32 v253, v253, v39, v40
    v_max_f32 v252, v252, v41
    v_min_f32 v253, v253, v41
    v_mov_b32 v254, v252
    s_waitcnt lgkmcnt(2)
    v_mfma_f32_32x32x16_bf16 v[48:63], v[228:231], v[92:95], v[48:63]
    ds_read_b128 v[228:231], v243 offset:22528
    v_mov_b32 v255, v253
    v_permlane32_swap_b32 v252, v254
    s_nop 0
    v_permlane32_swap_b32 v253, v255
    v_max_f32 v252, v252, v254
    v_min_f32 v253, v253, v255
    v_mul_f32 v252, v5, v252
    v_mul_f32 v253, v5, v253
    s_waitcnt lgkmcnt(2)
    v_mfma_f32_32x32x16_bf16 v[48:63], v[232:235], v[96:99], v[48:63]
    s_add_u32 s94, s94, 4096
    s_mov_b32 m0, s94
    s_add_u32 s93, s93, 4096
    buffer_load_dwordx4 v2, s[8:11], s93 offen offset:0 lds
    ds_read_b128 v[232:235], v243 offset:23552
    v_fma_f32 v42, -v32, v5, v253
    v_fma_f32 v32, v32, v5, -v252
    v_fma_f32 v43, -v33, v5, v253
    v_fma_f32 v33, v33, v5, -v252
    v_fma_f32 v44, -v34, v5, v253
    v_fma_f32 v34, v34, v5, -v252
    v_fma_f32 v45, -v35, v5, v253
    s_waitcnt lgkmcnt(2)
    v_mfma_f32_32x32x16_bf16 v[48:63], v[224:227], v[100:103], v[48:63]
    ds_read_b128 v[224:227], v243 offset:24576
    v_fma_f32 v35, v35, v5, -v252
    v_fma_f32 v46, -v36, v5, v253
    v_fma_f32 v36, v36, v5, -v252
    v_fma_f32 v47, -v37, v5, v253
    v_fma_f32 v37, v37, v5, -v252
    v_fma_f32 v236, -v38, v5, v253
    v_fma_f32 v38, v38, v5, -v252
    s_waitcnt lgkmcnt(2)
    v_mfma_f32_32x32x16_bf16 v[48:63], v[228:231], v[104:107], v[48:63]
    buffer_load_dwordx4 v2, s[8:11], s93 offen offset:1024 lds
    ds_read_b128 v[228:231], v243 offset:25600
    v_fma_f32 v237, -v39, v5, v253
    v_fma_f32 v39, v39, v5, -v252
    v_fma_f32 v238, -v40, v5, v253
    v_fma_f32 v40, v40, v5, -v252
    v_fma_f32 v239, -v41, v5, v253
    v_fma_f32 v41, v41, v5, -v252
    v_exp_f32 v42, v42
    s_waitcnt lgkmcnt(2)
    v_mfma_f32_32x32x16_bf16 v[48:63], v[232:235], v[108:111], v[48:63]
    ds_read_b128 v[232:235], v243 offset:26624
    v_exp_f32 v32, v32
    v_exp_f32 v43, v43
    v_exp_f32 v33, v33
    v_exp_f32 v44, v44
    v_exp_f32 v34, v34
    v_exp_f32 v45, v45
    v_exp_f32 v35, v35
    s_waitcnt lgkmcnt(2)
    v_mfma_f32_32x32x16_bf16 v[48:63], v[224:227], v[112:115], v[48:63]
    buffer_load_dwordx4 v2, s[8:11], s93 offen offset:2048 lds
    ds_read_b128 v[224:227], v243 offset:27648
    v_exp_f32 v46, v46
    v_exp_f32 v36, v36
    v_exp_f32 v47, v47
    v_exp_f32 v37, v37
    v_exp_f32 v236, v236
    v_exp_f32 v38, v38
    v_exp_f32 v237, v237
    s_waitcnt lgkmcnt(2)
    v_mfma_f32_32x32x16_bf16 v[48:63], v[228:231], v[116:119], v[48:63]
    ds_read_b128 v[228:231], v243 offset:28672
    v_exp_f32 v39, v39
    v_exp_f32 v238, v238
    v_exp_f32 v40, v40
    v_exp_f32 v239, v239
    v_exp_f32 v41, v41
    v_add_f32 v252, v32, v33
    s_waitcnt lgkmcnt(2)
    v_mfma_f32_32x32x16_bf16 v[48:63], v[232:235], v[120:123], v[48:63]
    buffer_load_dwordx4 v2, s[8:11], s93 offen offset:3072 lds
    ds_read_b128 v[232:235], v243 offset:29696
    v_add_f32 v253, v42, v43
    v_add_f32 v252, v252, v34
    v_add_f32 v253, v253, v44
    v_add_f32 v252, v252, v35
    v_add_f32 v253, v253, v45
    v_add_f32 v252, v252, v36
    v_add_f32 v253, v253, v46
    s_waitcnt lgkmcnt(2)
    v_mfma_f32_32x32x16_bf16 v[48:63], v[224:227], v[124:127], v[48:63]
    ds_read_b128 v[224:227], v243 offset:30720
    v_add_f32 v252, v252, v37
    v_add_f32 v253, v253, v47
    v_add_f32 v252, v252, v38
    v_add_f32 v253, v253, v236
    v_add_f32 v252, v252, v39
    v_add_f32 v253, v253, v237
    v_add_f32 v252, v252, v40
    s_waitcnt lgkmcnt(2)
    v_mfma_f32_32x32x16_bf16 v[48:63], v[228:231], v[128:131], v[48:63]
    s_waitcnt vmcnt(8)
    s_barrier
    s_add_u32 s94, s94, 4096
    s_mov_b32 m0, s94
    s_add_u32 s93, s93, 4096
    buffer_load_dwordx4 v2, s[8:11], s93 offen offset:0 lds
    ds_read_b128 v[228:231], v243 offset:31744
    v_add_f32 v253, v253, v238
    v_add_f32 v252, v252, v41
    v_add_f32 v253, v253, v239
    v_mov_b32 v254, v252
    v_mov_b32 v255, v253
    s_nop 0
    v_permlane32_swap_b32 v252, v254
    v_permlane32_swap_b32 v253, v255
    s_waitcnt lgkmcnt(2)
    v_mfma_f32_32x32x16_bf16 v[48:63], v[232:235], v[132:135], v[48:63]
    ds_read_b128 v[232:235], v241 offset:0
    v_add_f32 v252, v252, v254
    v_add_f32 v253, v253, v255
    v_rcp_f32 v252, v252
    v_rcp_f32 v253, v253
    v_mul_f32 v32, v32, v252
    v_mul_f32 v42, v42, v253
    v_mul_f32 v33, v33, v252
    s_waitcnt lgkmcnt(2)
    v_mfma_f32_32x32x16_bf16 v[48:63], v[224:227], v[136:139], v[48:63]
    buffer_load_dwordx4 v2, s[8:11], s93 offen offset:1024 lds
    ds_read_b128 v[224:227], v241 offset:1024
    v_mul_f32 v43, v43, v253
    v_mul_f32 v34, v34, v252
    v_mul_f32 v44, v44, v253
    v_mul_f32 v35, v35, v252
    v_mul_f32 v45, v45, v253
    v_mul_f32 v36, v36, v252
    v_mul_f32 v46, v46, v253
    s_waitcnt lgkmcnt(2)
    v_mfma_f32_32x32x16_bf16 v[48:63], v[228:231], v[140:143], v[48:63]
    s_sub_u32 s32, s24, 0
    s_mul_i32 s32, s32, 12288
    s_add_u32 s93, s32, s91
    s_add_u32 s93, s93, 32768
    s_add_u32 s94, s32, 94208
    s_mov_b32 m0, s94
    ds_read_b128 v[228:231], v241 offset:2048
    v_mul_f32 v37, v37, v252
    v_mul_f32 v47, v47, v253
    v_mul_f32 v38, v38, v252
    v_mul_f32 v236, v236, v253
    v_mul_f32 v39, v39, v252
    v_mul_f32 v237, v237, v253
    v_mul_f32 v40, v40, v252
    s_waitcnt lgkmcnt(2)
    v_mfma_f32_32x32x16_bf16 v[48:63], v[232:235], v[144:147], v[48:63]
    ds_read_b128 v[232:235], v241 offset:3072
    v_mul_f32 v238, v238, v253
    v_mul_f32 v41, v41, v252
    v_mul_f32 v239, v239, v253
    v_cvt_pk_bf16_f32 v32, v32, v33
    v_cvt_pk_bf16_f32 v33, v34, v35
    v_cvt_pk_bf16_f32 v34, v36, v37
    v_cvt_pk_bf16_f32 v35, v38, v39
    s_waitcnt lgkmcnt(2)
    v_mfma_f32_32x32x16_bf16 v[48:63], v[224:227], v[148:151], v[48:63]
    buffer_load_dwordx4 v2, s[8:11], s93 offen offset:0 lds
    ds_read_b128 v[224:227], v241 offset:4096
    v_cvt_pk_bf16_f32 v36, v40, v41
    v_cvt_pk_bf16_f32 v37, v42, v43
    v_cvt_pk_bf16_f32 v38, v44, v45
    v_cvt_pk_bf16_f32 v39, v46, v47
    v_cvt_pk_bf16_f32 v40, v236, v237
    v_cvt_pk_bf16_f32 v41, v238, v239
    ds_write_b64 v0, v[32:33] offset:0
    s_waitcnt lgkmcnt(3)
    v_mfma_f32_32x32x16_bf16 v[48:63], v[228:231], v[152:155], v[48:63]
    ds_read_b128 v[228:231], v241 offset:5120
    ds_write_b64 v0, v[34:35] offset:8
    ds_write_b64 v0, v[36:37] offset:16
    ds_write_b64 v0, v[38:39] offset:24
    ds_write_b64 v0, v[40:41] offset:32
    v_mfma_f32_32x32x16_bf16 v[32:47], a[248:251], v[20:23], 0
    v_mfma_f32_32x32x16_bf16 v[32:47], a[252:255], v[24:27], v[32:47]
    s_nop 11
    v_max3_f32 v252, v32, v33, v34
    s_waitcnt lgkmcnt(7)
    v_mfma_f32_32x32x16_bf16 v[48:63], v[232:235], v[156:159], v[48:63]
    buffer_load_dwordx4 v2, s[8:11], s93 offen offset:1024 lds
    ds_read_b128 v[232:235], v241 offset:6144
    v_min3_f32 v253, v32, v33, v34
    v_max3_f32 v252, v252, v35, v36
    v_min3_f32 v253, v253, v35, v36
    v_max3_f32 v252, v252, v37, v38
    v_min3_f32 v253, v253, v37, v38
    v_max3_f32 v252, v252, v39, v40
    v_min3_f32 v253, v253, v39, v40
    s_waitcnt lgkmcnt(7)
    v_mfma_f32_32x32x16_bf16 v[48:63], v[224:227], v[160:163], v[48:63]
    buffer_load_dwordx4 v2, s[8:11], s93 offen offset:2048 lds
    ds_read_b128 v[224:227], v241 offset:7168
    v_max_f32 v252, v252, v41
    v_min_f32 v253, v253, v41
    v_mov_b32 v254, v252
    v_mov_b32 v255, v253
    s_nop 0
    v_permlane32_swap_b32 v252, v254
    v_permlane32_swap_b32 v253, v255
    v_max_f32 v252, v252, v254
    s_waitcnt lgkmcnt(6)
    v_mfma_f32_32x32x16_bf16 v[48:63], v[228:231], v[164:167], v[48:63]
    ds_read_b128 v[228:231], v241 offset:8192
    v_min_f32 v253, v253, v255
    v_mul_f32 v252, v5, v252
    v_mul_f32 v253, v5, v253
    v_fma_f32 v42, -v32, v5, v253
    v_fma_f32 v32, v32, v5, -v252
    v_fma_f32 v43, -v33, v5, v253
    v_fma_f32 v33, v33, v5, -v252
    s_waitcnt lgkmcnt(2)
    v_mfma_f32_32x32x16_bf16 v[48:63], v[232:235], v[168:171], v[48:63]
    buffer_load_dwordx4 v2, s[8:11], s93 offen offset:3072 lds
    ds_read_b128 v[232:235], v241 offset:9216
    v_fma_f32 v44, -v34, v5, v253
    v_fma_f32 v34, v34, v5, -v252
    v_fma_f32 v45, -v35, v5, v253
    v_fma_f32 v35, v35, v5, -v252
    v_fma_f32 v46, -v36, v5, v253
    v_fma_f32 v36, v36, v5, -v252
    s_waitcnt lgkmcnt(2)
    v_mfma_f32_32x32x16_bf16 v[48:63], v[224:227], v[172:175], v[48:63]
    ds_read_b128 v[224:227], v241 offset:10240
    v_fma_f32 v47, -v37, v5, v253
    v_fma_f32 v37, v37, v5, -v252
    v_fma_f32 v236, -v38, v5, v253
    v_fma_f32 v38, v38, v5, -v252
    v_fma_f32 v237, -v39, v5, v253
    v_fma_f32 v39, v39, v5, -v252
    v_fma_f32 v238, -v40, v5, v253
    s_waitcnt lgkmcnt(2)
    v_mfma_f32_32x32x16_bf16 v[48:63], v[228:231], v[176:179], v[48:63]
    s_add_u32 s94, s94, 4096
    s_mov_b32 m0, s94
    s_add_u32 s93, s93, 4096
    buffer_load_dwordx4 v2, s[8:11], s93 offen offset:0 lds
    ds_read_b128 v[228:231], v241 offset:11264
    v_fma_f32 v40, v40, v5, -v252
    v_fma_f32 v239, -v41, v5, v253
    v_fma_f32 v41, v41, v5, -v252
    v_exp_f32 v42, v42
    v_exp_f32 v32, v32
    v_exp_f32 v43, v43
    v_exp_f32 v33, v33
    s_waitcnt lgkmcnt(2)
    v_mfma_f32_32x32x16_bf16 v[48:63], v[232:235], v[180:183], v[48:63]
    buffer_load_dwordx4 v2, s[8:11], s93 offen offset:1024 lds
    ds_read_b128 v[232:235], v241 offset:12288
    v_exp_f32 v44, v44
    v_exp_f32 v34, v34
    v_exp_f32 v45, v45
    v_exp_f32 v35, v35
    v_exp_f32 v46, v46
    v_exp_f32 v36, v36
    v_exp_f32 v47, v47
    s_waitcnt lgkmcnt(2)
    v_mfma_f32_32x32x16_bf16 v[48:63], v[224:227], v[184:187], v[48:63]
    ds_read_b128 v[224:227], v241 offset:13312
    v_exp_f32 v37, v37
    v_exp_f32 v236, v236
    v_exp_f32 v38, v38
    v_exp_f32 v237, v237
    v_exp_f32 v39, v39
    v_exp_f32 v238, v238
    v_exp_f32 v40, v40
    s_waitcnt lgkmcnt(2)
    v_mfma_f32_32x32x16_bf16 v[48:63], v[228:231], v[188:191], v[48:63]
    buffer_load_dwordx4 v2, s[8:11], s93 offen offset:2048 lds
    ds_read_b128 v[228:231], v241 offset:14336
    v_exp_f32 v239, v239
    v_exp_f32 v41, v41
    v_add_f32 v252, v32, v33
    v_add_f32 v253, v42, v43
    v_add_f32 v252, v252, v34
    v_add_f32 v253, v253, v44
    v_add_f32 v252, v252, v35
    s_waitcnt lgkmcnt(2)
    v_mfma_f32_32x32x16_bf16 v[48:63], v[232:235], v[192:195], v[48:63]
    ds_read_b128 v[232:235], v241 offset:15360
    v_add_f32 v253, v253, v45
    v_add_f32 v252, v252, v36
    v_add_f32 v253, v253, v46
    v_add_f32 v252, v252, v37
    v_add_f32 v253, v253, v47
    v_add_f32 v252, v252, v38
    v_add_f32 v253, v253, v236
    s_waitcnt lgkmcnt(2)
    v_mfma_f32_32x32x16_bf16 v[48:63], v[224:227], v[196:199], v[48:63]
    buffer_load_dwordx4 v2, s[8:11], s93 offen offset:3072 lds
    ds_read_b128 v[224:227], v241 offset:16384
    v_add_f32 v252, v252, v39
    v_add_f32 v253, v253, v237
    v_add_f32 v252, v252, v40
    v_add_f32 v253, v253, v238
    v_add_f32 v252, v252, v41
    v_add_f32 v253, v253, v239
    v_mov_b32 v254, v252
    s_waitcnt lgkmcnt(2)
    v_mfma_f32_32x32x16_bf16 v[48:63], v[228:231], v[200:203], v[48:63]
    s_add_u32 s94, s94, 4096
    s_mov_b32 m0, s94
    s_add_u32 s93, s93, 4096
    buffer_load_dwordx4 v2, s[8:11], s93 offen offset:0 lds
    ds_read_b128 v[228:231], v241 offset:17408
    v_mov_b32 v255, v253
    v_permlane32_swap_b32 v252, v254
    s_nop 0
    v_permlane32_swap_b32 v253, v255
    v_add_f32 v252, v252, v254
    v_add_f32 v253, v253, v255
    v_rcp_f32 v252, v252
    v_rcp_f32 v253, v253
    s_waitcnt lgkmcnt(2)
    v_mfma_f32_32x32x16_bf16 v[48:63], v[232:235], v[204:207], v[48:63]
    ds_read_b128 v[232:235], v241 offset:18432
    v_mul_f32 v32, v32, v252
    v_mul_f32 v42, v42, v253
    v_mul_f32 v33, v33, v252
    v_mul_f32 v43, v43, v253
    v_mul_f32 v34, v34, v252
    v_mul_f32 v44, v44, v253
    v_mul_f32 v35, v35, v252
    s_waitcnt lgkmcnt(2)
    v_mfma_f32_32x32x16_bf16 v[48:63], v[224:227], v[208:211], v[48:63]
    buffer_load_dwordx4 v2, s[8:11], s93 offen offset:1024 lds
    ds_read_b128 v[224:227], v241 offset:19456
    v_mul_f32 v45, v45, v253
    v_mul_f32 v36, v36, v252
    v_mul_f32 v46, v46, v253
    v_mul_f32 v37, v37, v252
    v_mul_f32 v47, v47, v253
    v_mul_f32 v38, v38, v252
    v_mul_f32 v236, v236, v253
    s_waitcnt lgkmcnt(2)
    v_mfma_f32_32x32x16_bf16 v[48:63], v[228:231], v[212:215], v[48:63]
    v_mul_f32 v39, v39, v252
    v_mul_f32 v237, v237, v253
    v_mul_f32 v40, v40, v252
    v_mul_f32 v238, v238, v253
    v_mul_f32 v41, v41, v252
    v_mul_f32 v239, v239, v253
    v_cvt_pk_bf16_f32 v32, v32, v33
    s_waitcnt lgkmcnt(1)
    v_mfma_f32_32x32x16_bf16 v[48:63], v[232:235], v[216:219], v[48:63]
    buffer_load_dwordx4 v2, s[8:11], s93 offen offset:2048 lds
    v_cvt_pk_bf16_f32 v33, v34, v35
    v_cvt_pk_bf16_f32 v34, v36, v37
    v_cvt_pk_bf16_f32 v35, v38, v39
    v_cvt_pk_bf16_f32 v36, v40, v41
    v_cvt_pk_bf16_f32 v37, v42, v43
    v_cvt_pk_bf16_f32 v38, v44, v45
    v_cvt_pk_bf16_f32 v39, v46, v47
    s_waitcnt lgkmcnt(0)
    v_mfma_f32_32x32x16_bf16 v[48:63], v[224:227], v[220:223], v[48:63]
    buffer_load_dwordx4 v2, s[8:11], s93 offen offset:3072 lds
    v_cvt_pk_bf16_f32 v40, v236, v237
    v_cvt_pk_bf16_f32 v41, v238, v239
    ds_write_b64 v0, v[32:33] offset:10240
    ds_write_b64 v0, v[34:35] offset:10248
    ds_write_b64 v0, v[36:37] offset:10256
    ds_write_b64 v0, v[38:39] offset:10264
    ds_write_b64 v0, v[40:41] offset:10272
    s_nop 3
    v_mul_f32 v48, v48, v240
    v_mul_f32 v49, v49, v240
    v_cvt_pk_bf16_f32 v48, v48, v49
    v_mul_f32 v50, v50, v240
    v_mul_f32 v51, v51, v240
    v_cvt_pk_bf16_f32 v49, v50, v51
    v_mul_f32 v52, v52, v240
    v_mul_f32 v53, v53, v240
    v_cvt_pk_bf16_f32 v50, v52, v53
    v_mul_f32 v54, v54, v240
    v_mul_f32 v55, v55, v240
    v_cvt_pk_bf16_f32 v51, v54, v55
    v_cvt_pk_bf16_f32 v52, v56, v57
    v_cvt_pk_bf16_f32 v53, v58, v59
    v_cvt_pk_bf16_f32 v54, v60, v61
    v_cvt_pk_bf16_f32 v55, v62, v63
    s_lshl_b32 s32, s24, 5
    v_add_u32 v224, s32, v3
    v_mul_u32_u24 v226, 48, v224
    v_add_u32 v227, 81960, v226
    v_mul_u32_u24 v228, 20, v4
    v_add_u32 v226, v226, v228
    v_add_u32 v226, 81920, v226
    ds_write_b32 v226, v26 offset:0
    ds_write_b32 v226, v27 offset:4
    ds_write_b32 v226, v28 offset:8
    ds_write_b32 v226, v29 offset:12
    ds_write_b32 v226, v30 offset:16
    ds_write_b32 v226, v31 offset:6144
    ds_write_b32 v226, v48 offset:6148
    ds_write_b32 v226, v49 offset:6152
    ds_write_b32 v226, v50 offset:6156
    ds_write_b32 v226, v51 offset:6160
    v_mov_b32 v228, 0x00003f80
    ds_write_b32 v227, v228
    ds_write_b32 v227, v228 offset:6144
    v_lshrrev_b32 v224, 4, v1
    v_and_b32 v225, 15, v1
    v_lshrrev_b32 v230, 2, v225
    v_lshlrev_b32 v231, 3, v4
    v_add_u32 v230, v230, v231
    v_and_b32 v231, 1, v224
    v_lshlrev_b32 v231, 4, v231
    v_and_b32 v232, 3, v225
    v_lshlrev_b32 v232, 2, v232
    v_add_u32 v231, v231, v232
    v_lshlrev_b32 v231, 1, v231
    v_mul_u32_u24 v232, 80, v230
    v_add_u32 v232, v232, v231
    s_lshr_b32 s76, s24, 1
    s_and_b32 s77, s24, 1
    s_mul_i32 s34, s76, 10240
    s_lshl_b32 s35, s77, 6
    s_add_u32 s34, s34, s35
    s_add_u32 s34, s34, 61440
    v_add_u32 v232, s34, v232
    v_mul_u32_u24 v233, 48, v230
    v_add_u32 v233, v233, v231
    s_mul_i32 s34, s76, 6144
    s_add_u32 s34, s34, 81920
    v_add_u32 v233, s34, v233
    s_lshl_b32 s78, s29, 8
    s_lshl_b32 s35, s26, 4
    s_add_u32 s78, s78, s35
    s_add_u32 s78, s78, s25
    s_mul_i32 s78, s78, 3584
    s_add_u32 s78, s78, 39845888
    s_mul_i32 s35, s76, 1680
    s_add_u32 s78, s78, s35
    s_mul_i32 s35, s77, 1344
    s_add_u32 s78, s78, s35
    v_lshlrev_b32 v234, 4, v3
    v_lshlrev_b32 v235, 3, v4
    v_add_u32 v234, v234, v235
    s_waitcnt vmcnt(12) lgkmcnt(0)
    s_barrier
    s_sub_u32 s32, s24, 0
    s_mul_i32 s32, s32, 5
    s_add_u32 s32, s32, 80
    s_lshl_b32 s33, s32, 10
    s_add_u32 s34, s33, s91
    s_add_u32 s35, s33, 61440
    s_sub_u32 s36, s33, 102400
    s_cmp_lt_u32 s32, 100
    s_cselect_b32 s35, s35, s36
    s_mov_b32 m0, s35
    s_nop 0
    buffer_load_dwordx4 v2, s[8:11], s34 offen offset:0 lds
    buffer_load_dwordx4 v2, s[8:11], s34 offen offset:1024 lds
    buffer_load_dwordx4 v2, s[8:11], s34 offen offset:2048 lds
    buffer_load_dwordx4 v2, s[8:11], s34 offen offset:3072 lds
    s_add_u32 s34, s34, 4096
    s_add_u32 s35, s35, 4096
    s_mov_b32 m0, s35
    s_nop 0
    buffer_load_dwordx4 v2, s[8:11], s34 offen offset:0 lds
    s_cmp_eq_u32 s29, 0
    s_cbranch_scc0 L_ol_w2c
    s_add_u32 s83, s82, 0
    buffer_load_dwordx4 a[0:3], v2, s[8:11], s83 offen
    s_add_u32 s83, s82, 1024
    buffer_load_dwordx4 a[4:7], v2, s[8:11], s83 offen
    s_add_u32 s83, s82, 2048
    buffer_load_dwordx4 a[8:11], v2, s[8:11], s83 offen
    s_add_u32 s83, s82, 3072
    buffer_load_dwordx4 a[12:15], v2, s[8:11], s83 offen
    s_add_u32 s83, s82, 4096
    buffer_load_dwordx4 a[16:19], v2, s[8:11], s83 offen
    s_add_u32 s83, s82, 5120
    buffer_load_dwordx4 a[20:23], v2, s[8:11], s83 offen
    s_add_u32 s83, s82, 6144
    buffer_load_dwordx4 a[24:27], v2, s[8:11], s83 offen
    s_add_u32 s83, s82, 7168
    buffer_load_dwordx4 a[28:31], v2, s[8:11], s83 offen
L_ol_w2c:
    ds_read_b64_tr_b16 v[16:17], v232 offset:0
    ds_read_b64_tr_b16 v[18:19], v232 offset:320
    ds_read_b64_tr_b16 v[20:21], v233 offset:0
    ds_read_b64_tr_b16 v[22:23], v233 offset:192
    ds_read_b64_tr_b16 v[24:25], v232 offset:1280
    ds_read_b64_tr_b16 v[26:27], v232 offset:1600
    ds_read_b64_tr_b16 v[28:29], v233 offset:768
    ds_read_b64_tr_b16 v[30:31], v233 offset:960
    ds_read_b64_tr_b16 v[224:225], v232 offset:2560
    ds_read_b64_tr_b16 v[226:227], v232 offset:2880
    ds_read_b64_tr_b16 v[228:229], v233 offset:1536
    ds_read_b64_tr_b16 v[230:231], v233 offset:1728
    s_waitcnt lgkmcnt(8)
    v_mfma_f32_32x32x16_bf16 v[32:47], v[16:19], v[20:23], 0
    ds_read_b64_tr_b16 v[16:17], v232 offset:3840
    ds_read_b64_tr_b16 v[18:19], v232 offset:4160
    ds_read_b64_tr_b16 v[20:21], v233 offset:2304
    ds_read_b64_tr_b16 v[22:23], v233 offset:2496
    s_waitcnt lgkmcnt(8)
    v_mfma_f32_32x32x16_bf16 v[32:47], v[24:27], v[28:31], v[32:47]
    ds_read_b64_tr_b16 v[24:25], v232 offset:5120
    ds_read_b64_tr_b16 v[26:27], v232 offset:5440
    ds_read_b64_tr_b16 v[28:29], v233 offset:3072
    ds_read_b64_tr_b16 v[30:31], v233 offset:3264
    s_waitcnt lgkmcnt(8)
    v_mfma_f32_32x32x16_bf16 v[32:47], v[224:227], v[228:231], v[32:47]
    ds_read_b64_tr_b16 v[224:225], v232 offset:6400
    ds_read_b64_tr_b16 v[226:227], v232 offset:6720
    ds_read_b64_tr_b16 v[228:229], v233 offset:3840
    ds_read_b64_tr_b16 v[230:231], v233 offset:4032
    s_waitcnt lgkmcnt(8)
    v_mfma_f32_32x32x16_bf16 v[32:47], v[16:19], v[20:23], v[32:47]
    ds_read_b64_tr_b16 v[16:17], v232 offset:7680
    ds_read_b64_tr_b16 v[18:19], v232 offset:8000
    ds_read_b64_tr_b16 v[20:21], v233 offset:4608
    ds_read_b64_tr_b16 v[22:23], v233 offset:4800
    s_waitcnt lgkmcnt(8)
    v_mfma_f32_32x32x16_bf16 v[32:47], v[24:27], v[28:31], v[32:47]
    ds_read_b64_tr_b16 v[24:25], v232 offset:8960
    ds_read_b64_tr_b16 v[26:27], v232 offset:9280
    ds_read_b64_tr_b16 v[28:29], v233 offset:5376
    ds_read_b64_tr_b16 v[30:31], v233 offset:5568
    s_waitcnt lgkmcnt(8)
    v_mfma_f32_32x32x16_bf16 v[32:47], v[224:227], v[228:231], v[32:47]
    s_waitcnt lgkmcnt(4)
    v_mfma_f32_32x32x16_bf16 v[32:47], v[16:19], v[20:23], v[32:47]
    s_waitcnt lgkmcnt(0)
    v_mfma_f32_32x32x16_bf16 v[32:47], v[24:27], v[28:31], v[32:47]
    s_nop 11
    v_cvt_pk_bf16_f32 v32, v32, v33
    v_cvt_pk_bf16_f32 v33, v34, v35
    v_cvt_pk_bf16_f32 v34, v36, v37
    v_cvt_pk_bf16_f32 v35, v38, v39
    v_cvt_pk_bf16_f32 v36, v40, v41
    v_cvt_pk_bf16_f32 v37, v42, v43
    v_cvt_pk_bf16_f32 v38, v44, v45
    v_cvt_pk_bf16_f32 v39, v46, v47
    v_cmp_gt_u32 vcc, 21, v3
    s_nop 0
    s_and_saveexec_b64 s[64:65], vcc
    buffer_store_dwordx2 v[32:33], v234, s[8:11], s78 offen sc1
    s_cmp_eq_u32 s77, 0
    s_cbranch_scc0 L_p1_norb
    buffer_store_dwordx2 v[34:35], v234, s[8:11], s78 offen offset:336 sc1
    buffer_store_dwordx2 v[36:37], v234, s[8:11], s78 offen offset:672 sc1
    buffer_store_dwordx2 v[38:39], v234, s[8:11], s78 offen offset:1008 sc1
L_p1_norb:
    s_mov_b64 exec, s[64:65]
    s_cmp_eq_u32 s29, 0
    s_cbranch_scc0 L_ol_w1cf
    v_accvgpr_read_b32 v32, a160
    v_accvgpr_read_b32 v33, a161
    v_accvgpr_read_b32 v34, a162
    v_accvgpr_read_b32 v35, a163
    v_accvgpr_read_b32 v36, a164
    v_accvgpr_read_b32 v37, a165
    v_accvgpr_read_b32 v38, a166
    v_accvgpr_read_b32 v39, a167
    v_add_f32 v32, v32, v33
    v_add_f32 v34, v34, v35
    v_add_f32 v36, v36, v37
    v_add_f32 v38, v38, v39
    v_add_f32 v32, v32, v34
    v_add_f32 v36, v36, v38
    v_add_f32 v32, v32, v36
    v_cvt_pk_bf16_f32 v33, v32, v32
    v_and_b32 v33, 0xffff0000, v33
    v_sub_f32 v33, v32, v33
    v_cvt_pk_bf16_f32 v40, v32, v33
    v_cndmask_b32 v40, 0, v40, s[66:67]
    v_accvgpr_read_b32 v32, a168
    v_accvgpr_read_b32 v33, a169
    v_accvgpr_read_b32 v34, a170
    v_accvgpr_read_b32 v35, a171
    v_accvgpr_read_b32 v36, a172
    v_accvgpr_read_b32 v37, a173
    v_accvgpr_read_b32 v38, a174
    v_accvgpr_read_b32 v39, a175
    v_add_f32 v32, v32, v33
    v_add_f32 v34, v34, v35
    v_add_f32 v36, v36, v37
    v_add_f32 v38, v38, v39
    v_add_f32 v32, v32, v34
    v_add_f32 v36, v36, v38
    v_add_f32 v32, v32, v36
    v_cvt_pk_bf16_f32 v33, v32, v32
    v_and_b32 v33, 0xffff0000, v33
    v_sub_f32 v33, v32, v33
    v_cvt_pk_bf16_f32 v41, v32, v33
    v_cndmask_b32 v41, 0, v41, s[66:67]
    v_accvgpr_read_b32 v32, a176
    v_accvgpr_read_b32 v33, a177
    v_accvgpr_read_b32 v34, a178
    v_accvgpr_read_b32 v35, a179
    v_accvgpr_read_b32 v36, a180
    v_accvgpr_read_b32 v37, a181
    v_accvgpr_read_b32 v38, a182
    v_accvgpr_read_b32 v39, a183
    v_add_f32 v32, v32, v33
    v_add_f32 v34, v34, v35
    v_add_f32 v36, v36, v37
    v_add_f32 v38, v38, v39
    v_add_f32 v32, v32, v34
    v_add_f32 v36, v36, v38
    v_add_f32 v32, v32, v36
    v_cvt_pk_bf16_f32 v33, v32, v32
    v_and_b32 v33, 0xffff0000, v33
    v_sub_f32 v33, v32, v33
    v_cvt_pk_bf16_f32 v42, v32, v33
    v_cndmask_b32 v42, 0, v42, s[66:67]
    v_accvgpr_read_b32 v44, a184
    v_lshl_or_b32 v44, v44, 16, v44
    v_cndmask_b32 v44, 0, v44, s[66:67]
    v_accvgpr_read_b32 v45, a185
    v_lshl_or_b32 v45, v45, 16, v45
    v_cndmask_b32 v45, 0, v45, s[66:67]
    v_accvgpr_read_b32 v43, a186
    v_lshl_or_b32 v43, v43, 16, v43
    v_cndmask_b32 v43, 0, v43, s[66:67]
    v_mov_b32 v46, 0
    v_mov_b32 v47, 0
    buffer_store_dwordx4 v[40:43], v2, s[8:11], s92 offen offset:1024 sc1
    buffer_store_dwordx4 v[44:47], v2, s[8:11], s92 offen offset:2048 sc1
L_ol_w1cf:
    ds_read_b128 v[224:227], v241 offset:20480
    ds_read_b128 v[228:231], v241 offset:21504
    ds_read_b128 v[232:235], v241 offset:22528
    ds_read_b128 v[236:239], v241 offset:23552
    v_mov_b32 v252, v251
    v_mov_b32 v253, v251
    v_mov_b32 v254, 0
    v_mov_b32 v255, 0
    s_nop 1
    v_mfma_f32_32x32x16_bf16 v[16:31], v[252:255], v[244:247], 0
    s_waitcnt lgkmcnt(3)
    v_mfma_f32_32x32x16_bf16 v[16:31], v[224:227], v[64:67], v[16:31]
    ds_read_b128 v[224:227], v241 offset:24576
    s_waitcnt lgkmcnt(3)
    v_mfma_f32_32x32x16_bf16 v[16:31], v[228:231], v[68:71], v[16:31]
    ds_read_b128 v[228:231], v241 offset:25600
    s_waitcnt lgkmcnt(3)
    v_mfma_f32_32x32x16_bf16 v[16:31], v[232:235], v[72:75], v[16:31]
    ds_read_b128 v[232:235], v241 offset:26624
    s_waitcnt lgkmcnt(3)
    v_mfma_f32_32x32x16_bf16 v[16:31], v[236:239], v[76:79], v[16:31]
    ds_read_b128 v[236:239], v241 offset:27648
    s_waitcnt lgkmcnt(3)
    v_mfma_f32_32x32x16_bf16 v[16:31], v[224:227], v[80:83], v[16:31]
    ds_read_b128 v[224:227], v241 offset:28672
    s_waitcnt lgkmcnt(3)
    v_mfma_f32_32x32x16_bf16 v[16:31], v[228:231], v[84:87], v[16:31]
    ds_read_b128 v[228:231], v241 offset:29696
    s_waitcnt lgkmcnt(3)
    v_mfma_f32_32x32x16_bf16 v[16:31], v[232:235], v[88:91], v[16:31]
    ds_read_b128 v[232:235], v241 offset:30720
    s_waitcnt lgkmcnt(3)
    v_mfma_f32_32x32x16_bf16 v[16:31], v[236:239], v[92:95], v[16:31]
    ds_read_b128 v[236:239], v241 offset:31744
    s_waitcnt lgkmcnt(3)
    v_mfma_f32_32x32x16_bf16 v[16:31], v[224:227], v[96:99], v[16:31]
    ds_read_b128 v[224:227], v241 offset:32768
    s_waitcnt lgkmcnt(3)
    v_mfma_f32_32x32x16_bf16 v[16:31], v[228:231], v[100:103], v[16:31]
    ds_read_b128 v[228:231], v241 offset:33792
    s_waitcnt lgkmcnt(3)
    v_mfma_f32_32x32x16_bf16 v[16:31], v[232:235], v[104:107], v[16:31]
    ds_read_b128 v[232:235], v241 offset:34816
    s_waitcnt lgkmcnt(3)
    v_mfma_f32_32x32x16_bf16 v[16:31], v[236:239], v[108:111], v[16:31]
    ds_read_b128 v[236:239], v241 offset:35840
    s_waitcnt lgkmcnt(3)
    v_mfma_f32_32x32x16_bf16 v[16:31], v[224:227], v[112:115], v[16:31]
    ds_read_b128 v[224:227], v241 offset:36864
    s_waitcnt lgkmcnt(3)
    v_mfma_f32_32x32x16_bf16 v[16:31], v[228:231], v[116:119], v[16:31]
    ds_read_b128 v[228:231], v241 offset:37888
    s_waitcnt lgkmcnt(3)
    v_mfma_f32_32x32x16_bf16 v[16:31], v[232:235], v[120:123], v[16:31]
    ds_read_b128 v[232:235], v241 offset:38912
    s_waitcnt lgkmcnt(3)
    v_mfma_f32_32x32x16_bf16 v[16:31], v[236:239], v[124:127], v[16:31]
    ds_read_b128 v[236:239], v241 offset:39936
    s_waitcnt lgkmcnt(3)
    v_mfma_f32_32x32x16_bf16 v[16:31], v[224:227], v[128:131], v[16:31]
    ds_read_b128 v[224:227], v241 offset:40960
    s_waitcnt lgkmcnt(3)
    v_mfma_f32_32x32x16_bf16 v[16:31], v[228:231], v[132:135], v[16:31]
    ds_read_b128 v[228:231], v241 offset:41984
    s_waitcnt lgkmcnt(3)
    v_mfma_f32_32x32x16_bf16 v[16:31], v[232:235], v[136:139], v[16:31]
    ds_read_b128 v[232:235], v241 offset:43008
    s_waitcnt lgkmcnt(3)
    v_mfma_f32_32x32x16_bf16 v[16:31], v[236:239], v[140:143], v[16:31]
    ds_read_b128 v[236:239], v241 offset:44032
    s_waitcnt lgkmcnt(3)
    v_mfma_f32_32x32x16_bf16 v[16:31], v[224:227], v[144:147], v[16:31]
    ds_read_b128 v[224:227], v241 offset:45056
    s_waitcnt lgkmcnt(3)
    v_mfma_f32_32x32x16_bf16 v[16:31], v[228:231], v[148:151], v[16:31]
    ds_read_b128 v[228:231], v241 offset:46080
    s_waitcnt lgkmcnt(3)
    v_mfma_f32_32x32x16_bf16 v[16:31], v[232:235], v[152:155], v[16:31]
    s_lshl_b32 s35, s26, 4
    s_add_u32 s35, s35, s25
    s_add_u32 s36, s30, 1
    s_add_u32 s36, s36, s29
    s_waitcnt vmcnt(0)
    s_barrier
    s_cmp_lg_u32 s24, 0
    s_cbranch_scc1 L_fl_col
    s_lshl_b32 s32, s35, 2
    s_add_u32 s32, s32, 2048
    v_mov_b32 v254, s36
    v_mov_b32 v255, 0
    s_mov_b64 s[64:65], exec
    s_mov_b64 exec, 1
    buffer_store_dword v254, v255, s[8:11], s32 offen sc1
    s_mov_b64 exec, s[64:65]
L_fl_col:
    s_sub_u32 s32, s24, 0
    s_mul_i32 s32, s32, 8192
    s_add_u32 s93, s32, s91
    s_add_u32 s93, s93, 0
    s_add_u32 s94, s32, 61440
    s_mov_b32 m0, s94
    ds_read_b128 v[232:235], v241 offset:47104
    s_waitcnt lgkmcnt(3)
    v_mfma_f32_32x32x16_bf16 v[16:31], v[236:239], v[156:159], v[16:31]
    buffer_load_dwordx4 v2, s[8:11], s93 offen offset:0 lds
    ds_read_b128 v[236:239], v241 offset:48128
    s_waitcnt lgkmcnt(3)
    v_mfma_f32_32x32x16_bf16 v[16:31], v[224:227], v[160:163], v[16:31]
    ds_read_b128 v[224:227], v241 offset:49152
    s_waitcnt lgkmcnt(3)
    v_mfma_f32_32x32x16_bf16 v[16:31], v[228:231], v[164:167], v[16:31]
    buffer_load_dwordx4 v2, s[8:11], s93 offen offset:1024 lds
    ds_read_b128 v[228:231], v241 offset:50176
    s_waitcnt lgkmcnt(3)
    v_mfma_f32_32x32x16_bf16 v[16:31], v[232:235], v[168:171], v[16:31]
    ds_read_b128 v[232:235], v241 offset:51200
    s_waitcnt lgkmcnt(3)
    v_mfma_f32_32x32x16_bf16 v[16:31], v[236:239], v[172:175], v[16:31]
    buffer_load_dwordx4 v2, s[8:11], s93 offen offset:2048 lds
    ds_read_b128 v[236:239], v241 offset:52224
    s_waitcnt lgkmcnt(3)
    v_mfma_f32_32x32x16_bf16 v[16:31], v[224:227], v[176:179], v[16:31]
    ds_read_b128 v[224:227], v241 offset:53248
    s_waitcnt lgkmcnt(3)
    v_mfma_f32_32x32x16_bf16 v[16:31], v[228:231], v[180:183], v[16:31]
    buffer_load_dwordx4 v2, s[8:11], s93 offen offset:3072 lds
    ds_read_b128 v[228:231], v241 offset:54272
    s_waitcnt lgkmcnt(3)
    v_mfma_f32_32x32x16_bf16 v[16:31], v[232:235], v[184:187], v[16:31]
    ds_read_b128 v[232:235], v241 offset:55296
    s_waitcnt lgkmcnt(3)
    v_mfma_f32_32x32x16_bf16 v[16:31], v[236:239], v[188:191], v[16:31]
    s_add_u32 s94, s94, 4096
    s_mov_b32 m0, s94
    s_add_u32 s93, s93, 4096
    buffer_load_dwordx4 v2, s[8:11], s93 offen offset:0 lds
    ds_read_b128 v[236:239], v241 offset:56320
    s_waitcnt lgkmcnt(3)
    v_mfma_f32_32x32x16_bf16 v[16:31], v[224:227], v[192:195], v[16:31]
    ds_read_b128 v[224:227], v241 offset:57344
    s_waitcnt lgkmcnt(3)
    v_mfma_f32_32x32x16_bf16 v[16:31], v[228:231], v[196:199], v[16:31]
    buffer_load_dwordx4 v2, s[8:11], s93 offen offset:1024 lds
    ds_read_b128 v[228:231], v241 offset:58368
    s_waitcnt lgkmcnt(3)
    v_mfma_f32_32x32x16_bf16 v[16:31], v[232:235], v[200:203], v[16:31]
    ds_read_b128 v[232:235], v241 offset:59392
    s_waitcnt lgkmcnt(3)
    v_mfma_f32_32x32x16_bf16 v[16:31], v[236:239], v[204:207], v[16:31]
    buffer_load_dwordx4 v2, s[8:11], s93 offen offset:2048 lds
    ds_read_b128 v[236:239], v241 offset:60416
    s_waitcnt lgkmcnt(3)
    v_mfma_f32_32x32x16_bf16 v[16:31], v[224:227], v[208:211], v[16:31]
    s_waitcnt lgkmcnt(2)
    v_mfma_f32_32x32x16_bf16 v[16:31], v[228:231], v[212:215], v[16:31]
    buffer_load_dwordx4 v2, s[8:11], s93 offen offset:3072 lds
    s_waitcnt lgkmcnt(1)
    v_mfma_f32_32x32x16_bf16 v[16:31], v[232:235], v[216:219], v[16:31]
    s_waitcnt lgkmcnt(0)
    v_mfma_f32_32x32x16_bf16 v[16:31], v[236:239], v[220:223], v[16:31]
    s_nop 11
    v_cvt_pk_bf16_f32 v56, v16, v17
    v_cvt_pk_bf16_f32 v57, v18, v19
    v_cvt_pk_bf16_f32 v58, v20, v21
    v_cvt_pk_bf16_f32 v59, v22, v23
    v_cvt_pk_bf16_f32 v60, v24, v25
    v_cvt_pk_bf16_f32 v61, v26, v27
    v_cvt_pk_bf16_f32 v62, v28, v29
    v_cvt_pk_bf16_f32 v63, v30, v31
    s_cmp_eq_u32 s29, 0
    s_cbranch_scc0 L_dl_q0_1
    v_mfma_f32_32x32x16_bf16 v[16:31], a[240:243], v[52:55], 0
    v_mfma_f32_32x32x16_bf16 v[16:31], a[244:247], v[56:59], v[16:31]
    s_nop 11
    v_max3_f32 v232, v16, v17, v18
    v_min3_f32 v233, v16, v17, v18
    v_max3_f32 v232, v232, v19, v20
    v_min3_f32 v233, v233, v19, v20
    v_max3_f32 v232, v232, v21, v22
    v_min3_f32 v233, v233, v21, v22
    v_max3_f32 v232, v232, v23, v24
    s_add_u32 s83, s82, 8192
    buffer_load_dwordx4 a[32:35], v2, s[8:11], s83 offen
    v_min3_f32 v233, v233, v23, v24
    v_max_f32 v232, v232, v25
    v_min_f32 v233, v233, v25
    v_mov_b32 v234, v232
    v_mov_b32 v235, v233
    s_nop 0
    v_permlane32_swap_b32 v232, v234
    v_permlane32_swap_b32 v233, v235
    v_max_f32 v232, v232, v234
    v_min_f32 v233, v233, v235
    s_add_u32 s83, s82, 9216
    buffer_load_dwordx4 a[36:39], v2, s[8:11], s83 offen
    v_mul_f32 v235, v5, v233
    v_mul_f32 v234, v5, v232
    v_sub_f32 v234, 0, v234
    v_mov_b32 v236, v5
    v_sub_f32 v237, 0, v5
    v_pk_fma_f32 v[32:33], v[16:17], v[236:237], v[234:235] op_sel:[0,1,1] op_sel_hi:[1,1,1]
    v_pk_fma_f32 v[16:17], v[16:17], v[236:237], v[234:235] op_sel:[0,0,0] op_sel_hi:[1,0,0]
    v_pk_fma_f32 v[34:35], v[18:19], v[236:237], v[234:235] op_sel:[0,1,1] op_sel_hi:[1,1,1]
    v_pk_fma_f32 v[18:19], v[18:19], v[236:237], v[234:235] op_sel:[0,0,0] op_sel_hi:[1,0,0]
    s_add_u32 s83, s82, 10240
    buffer_load_dwordx4 a[40:43], v2, s[8:11], s83 offen
    v_pk_fma_f32 v[36:37], v[20:21], v[236:237], v[234:235] op_sel:[0,1,1] op_sel_hi:[1,1,1]
    v_pk_fma_f32 v[20:21], v[20:21], v[236:237], v[234:235] op_sel:[0,0,0] op_sel_hi:[1,0,0]
    v_pk_fma_f32 v[38:39], v[22:23], v[236:237], v[234:235] op_sel:[0,1,1] op_sel_hi:[1,1,1]
    v_pk_fma_f32 v[22:23], v[22:23], v[236:237], v[234:235] op_sel:[0,0,0] op_sel_hi:[1,0,0]
    v_pk_fma_f32 v[40:41], v[24:25], v[236:237], v[234:235] op_sel:[0,1,1] op_sel_hi:[1,1,1]
    v_pk_fma_f32 v[24:25], v[24:25], v[236:237], v[234:235] op_sel:[0,0,0] op_sel_hi:[1,0,0]
    v_exp_f32 v32, v32
    v_exp_f32 v16, v16
    v_exp_f32 v33, v33
    s_add_u32 s83, s82, 11264
    buffer_load_dwordx4 a[44:47], v2, s[8:11], s83 offen
    v_exp_f32 v17, v17
    v_exp_f32 v34, v34
    v_exp_f32 v18, v18
    v_exp_f32 v35, v35
    v_exp_f32 v19, v19
    v_exp_f32 v36, v36
    v_exp_f32 v20, v20
    v_exp_f32 v37, v37
    v_exp_f32 v21, v21
    s_add_u32 s83, s82, 12288
    buffer_load_dwordx4 a[48:51], v2, s[8:11], s83 offen
    v_exp_f32 v38, v38
    v_exp_f32 v22, v22
    v_exp_f32 v39, v39
    v_exp_f32 v23, v23
    v_exp_f32 v40, v40
    v_exp_f32 v24, v24
    v_exp_f32 v41, v41
    v_exp_f32 v25, v25
    v_pk_add_f32 v[232:233], v[16:17], v[18:19]
    s_add_u32 s83, s82, 13312
    buffer_load_dwordx4 a[52:55], v2, s[8:11], s83 offen
    v_pk_add_f32 v[234:235], v[32:33], v[34:35]
    v_pk_add_f32 v[232:233], v[232:233], v[20:21]
    v_pk_add_f32 v[234:235], v[234:235], v[36:37]
    v_pk_add_f32 v[232:233], v[232:233], v[22:23]
    v_pk_add_f32 v[234:235], v[234:235], v[38:39]
    v_pk_add_f32 v[232:233], v[232:233], v[24:25]
    v_pk_add_f32 v[234:235], v[234:235], v[40:41]
    v_add_f32 v232, v232, v233
    v_add_f32 v233, v234, v235
    s_add_u32 s83, s82, 14336
    buffer_load_dwordx4 a[56:59], v2, s[8:11], s83 offen
    v_mov_b32 v234, v232
    v_mov_b32 v235, v233
    s_nop 0
    v_permlane32_swap_b32 v232, v234
    v_permlane32_swap_b32 v233, v235
    v_pk_add_f32 v[232:233], v[232:233], v[234:235]
    v_rcp_f32 v232, v232
    v_rcp_f32 v233, v233
    s_nop 0
    v_pk_mul_f32 v[16:17], v[16:17], v[232:233] op_sel:[0,0] op_sel_hi:[1,0]
    v_pk_mul_f32 v[32:33], v[32:33], v[232:233] op_sel:[0,1] op_sel_hi:[1,1]
    s_add_u32 s83, s82, 15360
    buffer_load_dwordx4 a[60:63], v2, s[8:11], s83 offen
    v_pk_mul_f32 v[18:19], v[18:19], v[232:233] op_sel:[0,0] op_sel_hi:[1,0]
    v_pk_mul_f32 v[34:35], v[34:35], v[232:233] op_sel:[0,1] op_sel_hi:[1,1]
    v_pk_mul_f32 v[20:21], v[20:21], v[232:233] op_sel:[0,0] op_sel_hi:[1,0]
    v_pk_mul_f32 v[36:37], v[36:37], v[232:233] op_sel:[0,1] op_sel_hi:[1,1]
    v_pk_mul_f32 v[22:23], v[22:23], v[232:233] op_sel:[0,0] op_sel_hi:[1,0]
    v_pk_mul_f32 v[38:39], v[38:39], v[232:233] op_sel:[0,1] op_sel_hi:[1,1]
    v_pk_mul_f32 v[24:25], v[24:25], v[232:233] op_sel:[0,0] op_sel_hi:[1,0]
    v_pk_mul_f32 v[40:41], v[40:41], v[232:233] op_sel:[0,1] op_sel_hi:[1,1]
    v_cvt_pk_bf16_f32 v200, v16, v17
    s_add_u32 s83, s82, 16384
    buffer_load_dwordx4 a[64:67], v2, s[8:11], s83 offen
    v_cvt_pk_bf16_f32 v201, v18, v19
    v_cvt_pk_bf16_f32 v202, v20, v21
    v_cvt_pk_bf16_f32 v203, v22, v23
    v_cvt_pk_bf16_f32 v204, v24, v25
    v_cvt_pk_bf16_f32 v205, v32, v33
    v_cvt_pk_bf16_f32 v206, v34, v35
    v_cvt_pk_bf16_f32 v207, v36, v37
    v_cvt_pk_bf16_f32 v208, v38, v39
    v_cvt_pk_bf16_f32 v209, v40, v41
    s_add_u32 s83, s82, 17408
    buffer_load_dwordx4 a[68:71], v2, s[8:11], s83 offen
    v_mov_b32 v210, 0
    v_mov_b32 v211, 0
    s_add_u32 s83, s82, 18432
    buffer_load_dwordx4 a[72:75], v2, s[8:11], s83 offen
    s_add_u32 s83, s82, 19456
    buffer_load_dwordx4 a[76:79], v2, s[8:11], s83 offen
    s_branch L_dl_q0_j
L_dl_q0_1:
    v_mfma_f32_32x32x16_bf16 v[16:31], a[240:243], v[52:55], 0
    v_mfma_f32_32x32x16_bf16 v[16:31], a[244:247], v[56:59], v[16:31]
    s_nop 11
    v_max3_f32 v232, v16, v17, v18
    v_min3_f32 v233, v16, v17, v18
    v_max3_f32 v232, v232, v19, v20
    v_min3_f32 v233, v233, v19, v20
    v_max3_f32 v232, v232, v21, v22
    v_min3_f32 v233, v233, v21, v22
    v_max3_f32 v232, v232, v23, v24
    v_min3_f32 v233, v233, v23, v24
    v_max_f32 v232, v232, v25
    v_min_f32 v233, v233, v25
    v_mov_b32 v234, v232
    v_mov_b32 v235, v233
    s_nop 0
    v_permlane32_swap_b32 v232, v234
    v_permlane32_swap_b32 v233, v235
    v_max_f32 v232, v232, v234
    v_min_f32 v233, v233, v235
    v_mul_f32 v235, v5, v233
    v_mul_f32 v234, v5, v232
    v_sub_f32 v234, 0, v234
    v_mov_b32 v236, v5
    v_sub_f32 v237, 0, v5
    v_pk_fma_f32 v[32:33], v[16:17], v[236:237], v[234:235] op_sel:[0,1,1] op_sel_hi:[1,1,1]
    v_pk_fma_f32 v[16:17], v[16:17], v[236:237], v[234:235] op_sel:[0,0,0] op_sel_hi:[1,0,0]
    v_pk_fma_f32 v[34:35], v[18:19], v[236:237], v[234:235] op_sel:[0,1,1] op_sel_hi:[1,1,1]
    v_pk_fma_f32 v[18:19], v[18:19], v[236:237], v[234:235] op_sel:[0,0,0] op_sel_hi:[1,0,0]
    v_pk_fma_f32 v[36:37], v[20:21], v[236:237], v[234:235] op_sel:[0,1,1] op_sel_hi:[1,1,1]
    v_pk_fma_f32 v[20:21], v[20:21], v[236:237], v[234:235] op_sel:[0,0,0] op_sel_hi:[1,0,0]
    v_pk_fma_f32 v[38:39], v[22:23], v[236:237], v[234:235] op_sel:[0,1,1] op_sel_hi:[1,1,1]
    v_pk_fma_f32 v[22:23], v[22:23], v[236:237], v[234:235] op_sel:[0,0,0] op_sel_hi:[1,0,0]
    v_pk_fma_f32 v[40:41], v[24:25], v[236:237], v[234:235] op_sel:[0,1,1] op_sel_hi:[1,1,1]
    v_pk_fma_f32 v[24:25], v[24:25], v[236:237], v[234:235] op_sel:[0,0,0] op_sel_hi:[1,0,0]
    v_exp_f32 v32, v32
    v_exp_f32 v16, v16
    v_exp_f32 v33, v33
    v_exp_f32 v17, v17
    v_exp_f32 v34, v34
    v_exp_f32 v18, v18
    v_exp_f32 v35, v35
    v_exp_f32 v19, v19
    v_exp_f32 v36, v36
    v_exp_f32 v20, v20
    v_exp_f32 v37, v37
    v_exp_f32 v21, v21
    v_exp_f32 v38, v38
    v_exp_f32 v22, v22
    v_exp_f32 v39, v39
    v_exp_f32 v23, v23
    v_exp_f32 v40, v40
    v_exp_f32 v24, v24
    v_exp_f32 v41, v41
    v_exp_f32 v25, v25
    v_pk_add_f32 v[232:233], v[16:17], v[18:19]
    v_pk_add_f32 v[234:235], v[32:33], v[34:35]
    v_pk_add_f32 v[232:233], v[232:233], v[20:21]
    v_pk_add_f32 v[234:235], v[234:235], v[36:37]
    v_pk_add_f32 v[232:233], v[232:233], v[22:23]
    v_pk_add_f32 v[234:235], v[234:235], v[38:39]
    v_pk_add_f32 v[232:233], v[232:233], v[24:25]
    v_pk_add_f32 v[234:235], v[234:235], v[40:41]
    v_add_f32 v232, v232, v233
    v_add_f32 v233, v234, v235
    v_mov_b32 v234, v232
    v_mov_b32 v235, v233
    s_nop 0
    v_permlane32_swap_b32 v232, v234
    v_permlane32_swap_b32 v233, v235
    v_pk_add_f32 v[232:233], v[232:233], v[234:235]
    v_rcp_f32 v232, v232
    v_rcp_f32 v233, v233
    s_nop 0
    v_pk_mul_f32 v[16:17], v[16:17], v[232:233] op_sel:[0,0] op_sel_hi:[1,0]
    v_pk_mul_f32 v[32:33], v[32:33], v[232:233] op_sel:[0,1] op_sel_hi:[1,1]
    v_pk_mul_f32 v[18:19], v[18:19], v[232:233] op_sel:[0,0] op_sel_hi:[1,0]
    v_pk_mul_f32 v[34:35], v[34:35], v[232:233] op_sel:[0,1] op_sel_hi:[1,1]
    v_pk_mul_f32 v[20:21], v[20:21], v[232:233] op_sel:[0,0] op_sel_hi:[1,0]
    v_pk_mul_f32 v[36:37], v[36:37], v[232:233] op_sel:[0,1] op_sel_hi:[1,1]
    v_pk_mul_f32 v[22:23], v[22:23], v[232:233] op_sel:[0,0] op_sel_hi:[1,0]
    v_pk_mul_f32 v[38:39], v[38:39], v[232:233] op_sel:[0,1] op_sel_hi:[1,1]
    v_pk_mul_f32 v[24:25], v[24:25], v[232:233] op_sel:[0,0] op_sel_hi:[1,0]
    v_pk_mul_f32 v[40:41], v[40:41], v[232:233] op_sel:[0,1] op_sel_hi:[1,1]
    v_cvt_pk_bf16_f32 v200, v16, v17
    v_cvt_pk_bf16_f32 v201, v18, v19
    v_cvt_pk_bf16_f32 v202, v20, v21
    v_cvt_pk_bf16_f32 v203, v22, v23
    v_cvt_pk_bf16_f32 v204, v24, v25
    v_cvt_pk_bf16_f32 v205, v32, v33
    v_cvt_pk_bf16_f32 v206, v34, v35
    v_cvt_pk_bf16_f32 v207, v36, v37
    v_cvt_pk_bf16_f32 v208, v38, v39
    v_cvt_pk_bf16_f32 v209, v40, v41
    v_mov_b32 v210, 0
    v_mov_b32 v211, 0
L_dl_q0_j:
    s_mul_i32 s32, s24, 53
    v_add_u32 v224, s32, v1
    v_lshlrev_b32 v225, 4, v224
    v_mov_b32 v227, 1073741824
    v_cmp_gt_u32 vcc, 53, v1
    s_nop 1
    v_cndmask_b32 v225, v227, v225, vcc
    v_cmp_gt_u32 vcc, 210, v224
    s_nop 1
    v_cndmask_b32 v225, v227, v225, vcc
    v_cmp_lt_u32 vcc, 104, v224
    s_nop 1
    v_cndmask_b32 v228, 0, 1, vcc
    v_mul_u32_u24 v229, 105, v228
    v_sub_u32 v229, v224, v229
    v_mul_u32_u24 v230, 3121, v229
    v_lshrrev_b32 v230, 16, v230
    v_mul_u32_u24 v231, 21, v230
    v_sub_u32 v229, v229, v231
    v_mul_u32_u24 v229, 80, v229
    v_lshlrev_b32 v230, 4, v230
    v_mul_u32_u24 v228, 1680, v228
    v_add3_u32 v229, v229, v228, v230
    s_lshl_b32 s80, s29, 8
    s_lshl_b32 s35, s26, 4
    s_add_u32 s80, s80, s35
    s_mul_i32 s80, s80, 3584
    s_add_u32 s80, s80, 39845888
    v_lshrrev_b32 v224, 3, v3
    v_lshlrev_b32 v224, 2, v224
    v_and_b32 v227, 3, v3
    v_add_u32 v224, v224, v227
    v_bfe_u32 v227, v3, 2, 1
    v_mul_u32_u24 v226, 12, v227
    v_add_u32 v226, v226, v224
    v_mov_b32 v227, 20
    v_cmp_eq_u32 vcc, 12, v224
    s_nop 1
    v_cndmask_b32 v226, v226, v227, vcc
    v_min_u32 v226, 20, v226
    v_mul_u32_u24 v226, 80, v226
    v_mul_u32_u24 v227, 40, v4
    v_add_u32 v226, v226, v227
    s_lshl_b32 s32, s25, 2
    s_add_u32 s32, s32, s24
    s_lshl_b32 s32, s32, 1
    s_mul_i32 s32, s32, 20480
    s_mul_i32 s33, s29, 0
    s_add_u32 s32, s32, s33
    s_add_u32 s32, s32, 11534336
    s_mul_i32 s33, s26, 1280
    s_add_u32 s79, s32, s33
    v_lshrrev_b32 v224, 4, v3
    v_mul_u32_u24 v224, 20480, v224
    v_and_b32 v227, 15, v3
    v_lshlrev_b32 v227, 4, v227
    v_add_u32 v224, v224, v227
    v_mul_u32_u24 v227, 768, v4
    v_add_u32 v227, v227, v224
    s_mul_i32 s81, s28, 20
    s_mul_i32 s33, s24, 5
    s_add_u32 s81, s81, s33
    s_mul_i32 s81, s81, 5120
    s_add_u32 s81, s81, 9240576
    s_lshl_b32 s70, s26, 6
    s_add_u32 s70, s70, 2048
    s_add_u32 s71, s30, 1
    s_add_u32 s71, s71, s29
    s_cmp_lg_u32 s24, 0
    s_cbranch_scc1 L_po_col_done
    s_mov_b64 s[64:65], exec
    s_mov_b64 exec, 0xffff
    v_mul_u32_u24 v255, 4, v1
    s_mov_b32 s33, 0
L_po_col:
    buffer_load_dword v254, v255, s[8:11], s70 offen sc1
    s_waitcnt vmcnt(0)
    v_subrev_u32 v254, s71, v254
    v_cmp_gt_u32 vcc, 2, v254
    s_add_u32 s33, s33, 1
    s_cmp_eq_u64 vcc, exec
    s_cbranch_scc1 L_po_col_ok
    s_cmp_lt_u32 s33, 0x100000
    s_cbranch_scc1 L_po_col
    v_mov_b32 v254, 48
    v_mov_b32 v255, s2
    v_add_u32 v255, 0x1000, v255
    buffer_store_dword v255, v254, s[20:23], 0 offen sc1
L_po_col_ok:
    s_mov_b64 exec, s[64:65]
L_po_col_done:
    s_barrier
    buffer_load_dwordx4 v[128:131], v225, s[8:11], s80 offen sc1
    s_add_u32 s80, s80, 3584
    buffer_load_dwordx4 v[132:135], v225, s[8:11], s80 offen sc1
    s_add_u32 s80, s80, 3584
    buffer_load_dwordx4 v[136:139], v225, s[8:11], s80 offen sc1
    s_add_u32 s80, s80, 3584
    buffer_load_dwordx4 v[140:143], v225, s[8:11], s80 offen sc1
    s_add_u32 s80, s80, 3584
    buffer_load_dwordx4 v[144:147], v225, s[8:11], s80 offen sc1
    s_add_u32 s80, s80, 3584
    buffer_load_dwordx4 v[148:151], v225, s[8:11], s80 offen sc1
    s_add_u32 s80, s80, 3584
    buffer_load_dwordx4 v[152:155], v225, s[8:11], s80 offen sc1
    s_add_u32 s80, s80, 3584
    buffer_load_dwordx4 v[156:159], v225, s[8:11], s80 offen sc1
    s_add_u32 s80, s80, 3584
    buffer_load_dwordx4 v[160:163], v225, s[8:11], s80 offen sc1
    s_add_u32 s80, s80, 3584
    buffer_load_dwordx4 v[164:167], v225, s[8:11], s80 offen sc1
    s_add_u32 s80, s80, 3584
    v_mfma_f32_32x32x16_bf16 v[16:31], a[248:251], v[56:59], 0
    v_mfma_f32_32x32x16_bf16 v[16:31], a[252:255], v[60:63], v[16:31]
    s_nop 11
    v_max3_f32 v232, v16, v17, v18
    v_min3_f32 v233, v16, v17, v18
    v_max3_f32 v232, v232, v19, v20
    v_min3_f32 v233, v233, v19, v20
    v_max3_f32 v232, v232, v21, v22
    v_min3_f32 v233, v233, v21, v22
    v_max3_f32 v232, v232, v23, v24
    v_min3_f32 v233, v233, v23, v24
    v_max_f32 v232, v232, v25
    v_min_f32 v233, v233, v25
    v_mov_b32 v234, v232
    v_mov_b32 v235, v233
    s_nop 0
    v_permlane32_swap_b32 v232, v234
    v_permlane32_swap_b32 v233, v235
    v_max_f32 v232, v232, v234
    v_min_f32 v233, v233, v235
    v_mul_f32 v235, v5, v233
    v_mul_f32 v234, v5, v232
    v_sub_f32 v234, 0, v234
    v_mov_b32 v236, v5
    v_sub_f32 v237, 0, v5
    v_pk_fma_f32 v[32:33], v[16:17], v[236:237], v[234:235] op_sel:[0,1,1] op_sel_hi:[1,1,1]
    v_pk_fma_f32 v[16:17], v[16:17], v[236:237], v[234:235] op_sel:[0,0,0] op_sel_hi:[1,0,0]
    v_pk_fma_f32 v[34:35], v[18:19], v[236:237], v[234:235] op_sel:[0,1,1] op_sel_hi:[1,1,1]
    v_pk_fma_f32 v[18:19], v[18:19], v[236:237], v[234:235] op_sel:[0,0,0] op_sel_hi:[1,0,0]
    v_pk_fma_f32 v[36:37], v[20:21], v[236:237], v[234:235] op_sel:[0,1,1] op_sel_hi:[1,1,1]
    v_pk_fma_f32 v[20:21], v[20:21], v[236:237], v[234:235] op_sel:[0,0,0] op_sel_hi:[1,0,0]
    v_pk_fma_f32 v[38:39], v[22:23], v[236:237], v[234:235] op_sel:[0,1,1] op_sel_hi:[1,1,1]
    v_pk_fma_f32 v[22:23], v[22:23], v[236:237], v[234:235] op_sel:[0,0,0] op_sel_hi:[1,0,0]
    v_pk_fma_f32 v[40:41], v[24:25], v[236:237], v[234:235] op_sel:[0,1,1] op_sel_hi:[1,1,1]
    v_pk_fma_f32 v[24:25], v[24:25], v[236:237], v[234:235] op_sel:[0,0,0] op_sel_hi:[1,0,0]
    v_exp_f32 v32, v32
    v_exp_f32 v16, v16
    v_exp_f32 v33, v33
    v_exp_f32 v17, v17
    v_exp_f32 v34, v34
    buffer_load_dwordx4 v[168:171], v225, s[8:11], s80 offen sc1
    s_add_u32 s80, s80, 3584
    v_exp_f32 v18, v18
    v_exp_f32 v35, v35
    v_exp_f32 v19, v19
    v_exp_f32 v36, v36
    v_exp_f32 v20, v20
    v_exp_f32 v37, v37
    v_exp_f32 v21, v21
    v_exp_f32 v38, v38
    v_exp_f32 v22, v22
    v_exp_f32 v39, v39
    v_exp_f32 v23, v23
    v_exp_f32 v40, v40
    v_exp_f32 v24, v24
    v_exp_f32 v41, v41
    v_exp_f32 v25, v25
    v_pk_add_f32 v[232:233], v[16:17], v[18:19]
    v_pk_add_f32 v[234:235], v[32:33], v[34:35]
    v_pk_add_f32 v[232:233], v[232:233], v[20:21]
    buffer_load_dwordx4 v[172:175], v225, s[8:11], s80 offen sc1
    s_add_u32 s80, s80, 3584
    v_pk_add_f32 v[234:235], v[234:235], v[36:37]
    v_pk_add_f32 v[232:233], v[232:233], v[22:23]
    v_pk_add_f32 v[234:235], v[234:235], v[38:39]
    v_pk_add_f32 v[232:233], v[232:233], v[24:25]
    v_pk_add_f32 v[234:235], v[234:235], v[40:41]
    v_add_f32 v232, v232, v233
    v_add_f32 v233, v234, v235
    v_mov_b32 v234, v232
    v_mov_b32 v235, v233
    s_nop 0
    v_permlane32_swap_b32 v232, v234
    v_permlane32_swap_b32 v233, v235
    v_pk_add_f32 v[232:233], v[232:233], v[234:235]
    v_rcp_f32 v232, v232
    v_rcp_f32 v233, v233
    s_nop 0
    v_pk_mul_f32 v[16:17], v[16:17], v[232:233] op_sel:[0,0] op_sel_hi:[1,0]
    v_pk_mul_f32 v[32:33], v[32:33], v[232:233] op_sel:[0,1] op_sel_hi:[1,1]
    v_pk_mul_f32 v[18:19], v[18:19], v[232:233] op_sel:[0,0] op_sel_hi:[1,0]
    v_pk_mul_f32 v[34:35], v[34:35], v[232:233] op_sel:[0,1] op_sel_hi:[1,1]
    buffer_load_dwordx4 v[176:179], v225, s[8:11], s80 offen sc1
    s_add_u32 s80, s80, 3584
    v_pk_mul_f32 v[20:21], v[20:21], v[232:233] op_sel:[0,0] op_sel_hi:[1,0]
    v_pk_mul_f32 v[36:37], v[36:37], v[232:233] op_sel:[0,1] op_sel_hi:[1,1]
    v_pk_mul_f32 v[22:23], v[22:23], v[232:233] op_sel:[0,0] op_sel_hi:[1,0]
    v_pk_mul_f32 v[38:39], v[38:39], v[232:233] op_sel:[0,1] op_sel_hi:[1,1]
    v_pk_mul_f32 v[24:25], v[24:25], v[232:233] op_sel:[0,0] op_sel_hi:[1,0]
    v_pk_mul_f32 v[40:41], v[40:41], v[232:233] op_sel:[0,1] op_sel_hi:[1,1]
    v_cvt_pk_bf16_f32 v212, v16, v17
    v_cvt_pk_bf16_f32 v213, v18, v19
    v_cvt_pk_bf16_f32 v214, v20, v21
    v_cvt_pk_bf16_f32 v215, v22, v23
    v_cvt_pk_bf16_f32 v216, v24, v25
    v_cvt_pk_bf16_f32 v217, v32, v33
    v_cvt_pk_bf16_f32 v218, v34, v35
    v_cvt_pk_bf16_f32 v219, v36, v37
    v_cvt_pk_bf16_f32 v220, v38, v39
    v_cvt_pk_bf16_f32 v221, v40, v41
    v_mov_b32 v222, 0
    v_mov_b32 v223, 0
    buffer_load_dwordx4 v[180:183], v225, s[8:11], s80 offen sc1
    s_add_u32 s80, s80, 3584
    buffer_load_dwordx4 v[184:187], v225, s[8:11], s80 offen sc1
    s_add_u32 s80, s80, 3584
    buffer_load_dwordx4 v[188:191], v225, s[8:11], s80 offen sc1
    s_mov_b32 s32, 0x00003f80
    s_mov_b32 s33, 0x3f800000
    s_waitcnt vmcnt(15)
    v_dot2_f32_bf16 v192, v128, s32, 0
    v_dot2_f32_bf16 v193, v128, s33, 0
    v_dot2_f32_bf16 v194, v129, s32, 0
    v_dot2_f32_bf16 v195, v129, s33, 0
    v_dot2_f32_bf16 v196, v130, s32, 0
    v_dot2_f32_bf16 v197, v130, s33, 0
    v_dot2_f32_bf16 v198, v131, s32, 0
    v_dot2_f32_bf16 v199, v131, s33, 0
    buffer_load_dwordx4 v[16:19], v2, s[8:11], s81 offen offset:0
    s_waitcnt vmcnt(15)
    v_dot2_f32_bf16 v192, v132, s32, v192
    v_dot2_f32_bf16 v193, v132, s33, v193
    v_dot2_f32_bf16 v194, v133, s32, v194
    v_dot2_f32_bf16 v195, v133, s33, v195
    v_dot2_f32_bf16 v196, v134, s32, v196
    v_dot2_f32_bf16 v197, v134, s33, v197
    v_dot2_f32_bf16 v198, v135, s32, v198
    v_dot2_f32_bf16 v199, v135, s33, v199
    buffer_load_dwordx4 v[20:23], v2, s[8:11], s81 offen offset:1024
    s_waitcnt vmcnt(15)
    v_dot2_f32_bf16 v192, v136, s32, v192
    v_dot2_f32_bf16 v193, v136, s33, v193
    v_dot2_f32_bf16 v194, v137, s32, v194
    v_dot2_f32_bf16 v195, v137, s33, v195
    v_dot2_f32_bf16 v196, v138, s32, v196
    v_dot2_f32_bf16 v197, v138, s33, v197
    v_dot2_f32_bf16 v198, v139, s32, v198
    v_dot2_f32_bf16 v199, v139, s33, v199
    buffer_load_dwordx4 v[24:27], v2, s[8:11], s81 offen offset:2048
    s_waitcnt vmcnt(15)
    v_dot2_f32_bf16 v192, v140, s32, v192
    v_dot2_f32_bf16 v193, v140, s33, v193
    v_dot2_f32_bf16 v194, v141, s32, v194
    v_dot2_f32_bf16 v195, v141, s33, v195
    v_dot2_f32_bf16 v196, v142, s32, v196
    v_dot2_f32_bf16 v197, v142, s33, v197
    v_dot2_f32_bf16 v198, v143, s32, v198
    v_dot2_f32_bf16 v199, v143, s33, v199
    buffer_load_dwordx4 v[28:31], v2, s[8:11], s81 offen offset:3072
    s_waitcnt vmcnt(15)
    v_dot2_f32_bf16 v192, v144, s32, v192
    v_dot2_f32_bf16 v193, v144, s33, v193
    v_dot2_f32_bf16 v194, v145, s32, v194
    v_dot2_f32_bf16 v195, v145, s33, v195
    v_dot2_f32_bf16 v196, v146, s32, v196
    v_dot2_f32_bf16 v197, v146, s33, v197
    v_dot2_f32_bf16 v198, v147, s32, v198
    v_dot2_f32_bf16 v199, v147, s33, v199
    s_add_u32 s81, s81, 4096
    buffer_load_dwordx4 v[32:35], v2, s[8:11], s81 offen offset:0
    s_waitcnt vmcnt(15)
    v_dot2_f32_bf16 v192, v148, s32, v192
    v_dot2_f32_bf16 v193, v148, s33, v193
    v_dot2_f32_bf16 v194, v149, s32, v194
    v_dot2_f32_bf16 v195, v149, s33, v195
    v_dot2_f32_bf16 v196, v150, s32, v196
    v_dot2_f32_bf16 v197, v150, s33, v197
    v_dot2_f32_bf16 v198, v151, s32, v198
    v_dot2_f32_bf16 v199, v151, s33, v199
    buffer_load_dwordx4 v[36:39], v2, s[8:11], s81 offen offset:1024
    s_waitcnt vmcnt(15)
    v_dot2_f32_bf16 v192, v152, s32, v192
    v_dot2_f32_bf16 v193, v152, s33, v193
    v_dot2_f32_bf16 v194, v153, s32, v194
    v_dot2_f32_bf16 v195, v153, s33, v195
    v_dot2_f32_bf16 v196, v154, s32, v196
    v_dot2_f32_bf16 v197, v154, s33, v197
    v_dot2_f32_bf16 v198, v155, s32, v198
    v_dot2_f32_bf16 v199, v155, s33, v199
    buffer_load_dwordx4 v[40:43], v2, s[8:11], s81 offen offset:2048
    s_waitcnt vmcnt(15)
    v_dot2_f32_bf16 v192, v156, s32, v192
    v_dot2_f32_bf16 v193, v156, s33, v193
    v_dot2_f32_bf16 v194, v157, s32, v194
    v_dot2_f32_bf16 v195, v157, s33, v195
    v_dot2_f32_bf16 v196, v158, s32, v196
    v_dot2_f32_bf16 v197, v158, s33, v197
    v_dot2_f32_bf16 v198, v159, s32, v198
    v_dot2_f32_bf16 v199, v159, s33, v199
    buffer_load_dwordx4 v[44:47], v2, s[8:11], s81 offen offset:3072
    s_waitcnt vmcnt(15)
    v_dot2_f32_bf16 v192, v160, s32, v192
    v_dot2_f32_bf16 v193, v160, s33, v193
    v_dot2_f32_bf16 v194, v161, s32, v194
    v_dot2_f32_bf16 v195, v161, s33, v195
    v_dot2_f32_bf16 v196, v162, s32, v196
    v_dot2_f32_bf16 v197, v162, s33, v197
    v_dot2_f32_bf16 v198, v163, s32, v198
    v_dot2_f32_bf16 v199, v163, s33, v199
    s_add_u32 s81, s81, 4096
    buffer_load_dwordx4 v[48:51], v2, s[8:11], s81 offen offset:0
    s_waitcnt vmcnt(15)
    v_dot2_f32_bf16 v192, v164, s32, v192
    v_dot2_f32_bf16 v193, v164, s33, v193
    v_dot2_f32_bf16 v194, v165, s32, v194
    v_dot2_f32_bf16 v195, v165, s33, v195
    v_dot2_f32_bf16 v196, v166, s32, v196
    v_dot2_f32_bf16 v197, v166, s33, v197
    v_dot2_f32_bf16 v198, v167, s32, v198
    v_dot2_f32_bf16 v199, v167, s33, v199
    buffer_load_dwordx4 v[52:55], v2, s[8:11], s81 offen offset:1024
    s_waitcnt vmcnt(15)
    v_dot2_f32_bf16 v192, v168, s32, v192
    v_dot2_f32_bf16 v193, v168, s33, v193
    v_dot2_f32_bf16 v194, v169, s32, v194
    v_dot2_f32_bf16 v195, v169, s33, v195
    v_dot2_f32_bf16 v196, v170, s32, v196
    v_dot2_f32_bf16 v197, v170, s33, v197
    v_dot2_f32_bf16 v198, v171, s32, v198
    v_dot2_f32_bf16 v199, v171, s33, v199
    buffer_load_dwordx4 v[56:59], v2, s[8:11], s81 offen offset:2048
    s_waitcnt vmcnt(15)
    v_dot2_f32_bf16 v192, v172, s32, v192
    v_dot2_f32_bf16 v193, v172, s33, v193
    v_dot2_f32_bf16 v194, v173, s32, v194
    v_dot2_f32_bf16 v195, v173, s33, v195
    v_dot2_f32_bf16 v196, v174, s32, v196
    v_dot2_f32_bf16 v197, v174, s33, v197
    v_dot2_f32_bf16 v198, v175, s32, v198
    v_dot2_f32_bf16 v199, v175, s33, v199
    buffer_load_dwordx4 v[60:63], v2, s[8:11], s81 offen offset:3072
    s_waitcnt vmcnt(15)
    v_dot2_f32_bf16 v192, v176, s32, v192
    v_dot2_f32_bf16 v193, v176, s33, v193
    v_dot2_f32_bf16 v194, v177, s32, v194
    v_dot2_f32_bf16 v195, v177, s33, v195
    v_dot2_f32_bf16 v196, v178, s32, v196
    v_dot2_f32_bf16 v197, v178, s33, v197
    v_dot2_f32_bf16 v198, v179, s32, v198
    v_dot2_f32_bf16 v199, v179, s33, v199
    s_add_u32 s81, s81, 4096
    buffer_load_dwordx4 v[64:67], v2, s[8:11], s81 offen offset:0
    s_waitcnt vmcnt(15)
    v_dot2_f32_bf16 v192, v180, s32, v192
    v_dot2_f32_bf16 v193, v180, s33, v193
    v_dot2_f32_bf16 v194, v181, s32, v194
    v_dot2_f32_bf16 v195, v181, s33, v195
    v_dot2_f32_bf16 v196, v182, s32, v196
    v_dot2_f32_bf16 v197, v182, s33, v197
    v_dot2_f32_bf16 v198, v183, s32, v198
    v_dot2_f32_bf16 v199, v183, s33, v199
    buffer_load_dwordx4 v[68:71], v2, s[8:11], s81 offen offset:1024
    s_waitcnt vmcnt(15)
    v_dot2_f32_bf16 v192, v184, s32, v192
    v_dot2_f32_bf16 v193, v184, s33, v193
    v_dot2_f32_bf16 v194, v185, s32, v194
    v_dot2_f32_bf16 v195, v185, s33, v195
    v_dot2_f32_bf16 v196, v186, s32, v196
    v_dot2_f32_bf16 v197, v186, s33, v197
    v_dot2_f32_bf16 v198, v187, s32, v198
    v_dot2_f32_bf16 v199, v187, s33, v199
    buffer_load_dwordx4 v[72:75], v2, s[8:11], s81 offen offset:2048
    s_waitcnt vmcnt(15)
    v_dot2_f32_bf16 v192, v188, s32, v192
    v_dot2_f32_bf16 v193, v188, s33, v193
    v_dot2_f32_bf16 v194, v189, s32, v194
    v_dot2_f32_bf16 v195, v189, s33, v195
    v_dot2_f32_bf16 v196, v190, s32, v196
    v_dot2_f32_bf16 v197, v190, s33, v197
    v_dot2_f32_bf16 v198, v191, s32, v198
    v_dot2_f32_bf16 v199, v191, s33, v199
    buffer_load_dwordx4 v[76:79], v2, s[8:11], s81 offen offset:3072
    v_cvt_pk_bf16_f32 v128, v192, v193
    v_cvt_pk_bf16_f32 v129, v194, v195
    v_cvt_pk_bf16_f32 v130, v196, v197
    v_cvt_pk_bf16_f32 v131, v198, v199
    v_cmp_ne_u32 vcc, 1073741824, v225
    s_nop 0
    s_and_saveexec_b64 s[64:65], vcc
    ds_write_b64 v229, v[128:129]
    ds_write_b64 v229, v[130:131] offset:8
    s_mov_b64 exec, s[64:65]
    s_add_u32 s81, s81, 4096
    buffer_load_dwordx4 v[80:83], v2, s[8:11], s81 offen offset:0
    buffer_load_dwordx4 v[84:87], v2, s[8:11], s81 offen offset:1024
    s_waitcnt lgkmcnt(0)
    s_barrier
    ds_read_b64 v[128:129], v226 offset:0
    ds_read_b64 v[130:131], v226 offset:8
    ds_read_b64 v[132:133], v226 offset:16
    ds_read_b64 v[134:135], v226 offset:24
    ds_read_b64 v[136:137], v226 offset:32
    v_mov_b32 v138, 0
    v_mov_b32 v139, 0
    ds_read_b64 v[140:141], v226 offset:1680
    ds_read_b64 v[142:143], v226 offset:1688
    ds_read_b64 v[144:145], v226 offset:1696
    ds_read_b64 v[146:147], v226 offset:1704
    ds_read_b64 v[148:149], v226 offset:1712
    v_mov_b32 v150, 0
    v_mov_b32 v151, 0
    s_waitcnt lgkmcnt(8)
    v_mfma_f32_32x32x16_bf16 v[152:167], v[128:131], v[200:203], 0
    s_waitcnt lgkmcnt(3)
    v_mfma_f32_32x32x16_bf16 v[168:183], v[140:143], v[212:215], 0
    v_mfma_f32_32x32x16_bf16 v[152:167], v[132:135], v[204:207], v[152:167]
    s_waitcnt lgkmcnt(1)
    v_mfma_f32_32x32x16_bf16 v[168:183], v[144:147], v[216:219], v[168:183]
    v_mfma_f32_32x32x16_bf16 v[152:167], v[136:139], v[208:211], v[152:167]
    s_waitcnt lgkmcnt(0)
    v_mfma_f32_32x32x16_bf16 v[168:183], v[148:151], v[220:223], v[168:183]
    s_nop 9
    v_add_f32 v164, 0x358637bd, v164
    s_nop 0
    v_add_f32 v180, 0x358637bd, v180
    v_rcp_f32 v164, v164
    v_rcp_f32 v180, v180
    v_pk_mul_f32 v[152:153], v[152:153], v[164:165] op_sel_hi:[1,0]
    v_pk_mul_f32 v[154:155], v[154:155], v[164:165] op_sel_hi:[1,0]
    v_pk_mul_f32 v[156:157], v[156:157], v[164:165] op_sel_hi:[1,0]
    v_pk_mul_f32 v[158:159], v[158:159], v[164:165] op_sel_hi:[1,0]
    v_pk_mul_f32 v[160:161], v[160:161], v[164:165] op_sel_hi:[1,0]
    v_pk_mul_f32 v[162:163], v[162:163], v[164:165] op_sel_hi:[1,0]
    v_cvt_pk_bf16_f32 v184, v152, v153
    v_cvt_pk_bf16_f32 v185, v154, v155
    v_cvt_pk_bf16_f32 v186, v156, v157
    v_cvt_pk_bf16_f32 v187, v158, v159
    v_cvt_pk_bf16_f32 v188, v160, v161
    v_cvt_pk_bf16_f32 v189, v162, v163
    v_pk_mul_f32 v[168:169], v[168:169], v[180:181] op_sel_hi:[1,0]
    v_pk_mul_f32 v[170:171], v[170:171], v[180:181] op_sel_hi:[1,0]
    v_pk_mul_f32 v[172:173], v[172:173], v[180:181] op_sel_hi:[1,0]
    v_pk_mul_f32 v[174:175], v[174:175], v[180:181] op_sel_hi:[1,0]
    v_pk_mul_f32 v[176:177], v[176:177], v[180:181] op_sel_hi:[1,0]
    v_pk_mul_f32 v[178:179], v[178:179], v[180:181] op_sel_hi:[1,0]
    v_cvt_pk_bf16_f32 v190, v168, v169
    v_cvt_pk_bf16_f32 v191, v170, v171
    v_cvt_pk_bf16_f32 v192, v172, v173
    v_cvt_pk_bf16_f32 v193, v174, v175
    v_cvt_pk_bf16_f32 v194, v176, v177
    v_cvt_pk_bf16_f32 v195, v178, v179
    buffer_store_dwordx4 v[184:187], v227, s[8:11], s79 offen sc1
    s_mov_b64 exec, s[66:67]
    buffer_store_dwordx4 v[188:191], v224, s[8:11], s79 offen offset:256 sc1
    buffer_store_dwordx4 v[192:195], v224, s[8:11], s79 offen offset:512 sc1
    s_mov_b64 exec, s[68:69]
    buffer_store_dwordx4 v[190:193], v224, s[8:11], s79 offen offset:1024 sc1
    s_mov_b64 exec, -1
    buffer_load_dwordx4 v[88:91], v2, s[8:11], s81 offen offset:2048
    buffer_load_dwordx4 v[92:95], v2, s[8:11], s81 offen offset:3072
    s_add_u32 s81, s81, 4096
    buffer_load_dwordx4 v[96:99], v2, s[8:11], s81 offen offset:0
    buffer_load_dwordx4 v[100:103], v2, s[8:11], s81 offen offset:1024
    buffer_load_dwordx4 v[104:107], v2, s[8:11], s81 offen offset:2048
    buffer_load_dwordx4 v[108:111], v2, s[8:11], s81 offen offset:3072
    s_add_u32 s81, s81, 4096
    buffer_load_dwordx4 v[112:115], v2, s[8:11], s81 offen offset:0
    s_lshl_b32 s35, s25, 6
    s_add_u32 s35, s35, s26
    s_lshl_b32 s36, s29, 2
    s_add_u32 s36, s36, s30
    s_add_u32 s36, s36, 1
    s_waitcnt vmcnt(7)
    s_barrier
    s_cmp_lg_u32 s24, 0
    s_cbranch_scc1 L_fl_row_o
    s_lshl_b32 s32, s35, 2
    s_add_u32 s32, s32, 4096
    v_mov_b32 v254, s36
    v_mov_b32 v255, 0
    s_mov_b64 s[64:65], exec
    s_mov_b64 exec, 1
    s_cmp_eq_u32 s84, 1
    s_cbranch_scc1 L_fl_row_o_f
    buffer_store_dword v254, v255, s[8:11], s32 offen sc1
    s_branch L_fl_row_o_j
L_fl_row_o_f:
    buffer_store_dword v254, v255, s[8:11], s32 offen
L_fl_row_o_j:
    s_mov_b64 exec, s[64:65]
L_fl_row_o:
    s_lshl_b32 s32, s25, 3
    s_lshl_b32 s33, s27, 2
    s_add_u32 s32, s32, s33
    s_mul_i32 s32, s32, 20
    s_mul_i32 s33, s24, 5
    s_add_u32 s32, s32, s33
    s_lshl_b32 s32, s32, 10
    s_mul_i32 s33, s29, 0
    s_add_u32 s32, s32, s33
    s_add_u32 s75, s32, 11534336
    s_lshl_b32 s32, s25, 2
    s_lshl_b32 s33, s27, 1
    s_add_u32 s32, s32, s33
    s_lshr_b32 s33, s24, 1
    s_add_u32 s32, s32, s33
    s_and_b32 s34, s24, 1
    s_lshl_b32 s34, s34, 4
    v_and_b32 v5, 15, v1
    v_add_u32 v5, s34, v5
    v_lshrrev_b32 v0, 5, v1
    v_lshlrev_b32 v0, 5, v0
    v_add_u32 v0, v0, v5
    v_lshlrev_b32 v0, 4, v0
    v_bfe_u32 v253, v1, 4, 1
    v_lshlrev_b32 v253, 3, v253
    v_add_u32 v0, v0, v253
    v_lshlrev_b32 v5, 3, v5
    s_mul_i32 s76, s32, 40
    s_mul_i32 s34, s28, 5
    s_add_u32 s76, s76, s34
    s_lshl_b32 s76, s76, 10
    s_lshl_b32 s78, s32, 3
    s_add_u32 s78, s78, s28
    s_lshl_b32 s78, s78, 8
    s_mul_i32 s36, s29, 0
    s_add_u32 s76, s76, s36
    s_add_u32 s76, s76, 16777216
    s_mul_i32 s36, s29, 0
    s_add_u32 s78, s78, s36
    s_add_u32 s78, s78, 24641536
    s_add_u32 s77, s76, 4096
    s_add_u32 s32, s24, 1
    s_and_b32 s32, s32, 3
    s_mul_i32 s32, s32, 15360
    s_add_u32 s32, s32, 10240
    v_add_u32 v248, s32, v2
    s_add_u32 s32, s24, 2
    s_and_b32 s32, s32, 3
    s_mul_i32 s32, s32, 15360
    s_add_u32 s32, s32, 5120
    v_add_u32 v249, s32, v2
    s_add_u32 s32, s24, 3
    s_and_b32 s32, s32, 3
    s_mul_i32 s32, s32, 15360
    s_add_u32 s32, s32, 0
    v_add_u32 v250, s32, v2
    s_mul_i32 s32, s24, 15360
    s_add_u32 s32, s32, 0
    v_add_u32 v251, s32, v2
    s_lshl_b32 s70, s25, 8
    s_add_u32 s70, s70, 4096
    s_lshl_b32 s71, s29, 2
    s_add_u32 s71, s71, s30
    s_add_u32 s71, s71, 1
    s_cmp_lg_u32 s24, 0
    s_cbranch_scc1 L_po_row_o_done
    s_mov_b64 s[64:65], exec
    s_mov_b64 exec, 0xffff
    v_mul_u32_u24 v255, 4, v1
    s_mov_b32 s33, 0
L_po_row_o:
    buffer_load_dword v254, v255, s[8:11], s70 offen sc1
    s_waitcnt vmcnt(0)
    v_subrev_u32 v254, s71, v254
    v_cmp_gt_u32 vcc, 8, v254
    s_add_u32 s33, s33, 1
    s_cmp_eq_u64 vcc, exec
    s_cbranch_scc1 L_po_row_o_ok
    s_cmp_lt_u32 s33, 0x100000
    s_cbranch_scc1 L_po_row_o
    v_mov_b32 v254, 52
    v_mov_b32 v255, s2
    v_add_u32 v255, 0x1000, v255
    buffer_store_dword v255, v254, s[20:23], 0 offen sc1
L_po_row_o_ok:
    s_mov_b64 exec, s[64:65]
L_po_row_o_done:
    s_barrier
    s_mov_b32 s70, s75
    s_cmp_eq_u32 s29, 0
    s_cbranch_scc0 L_dl_p3_1
    s_add_u32 s32, s24, 1
    s_and_b32 s32, s32, 3
    s_mul_i32 s32, s32, 20480
    s_add_u32 s81, s32, s70
    buffer_load_dwordx4 v[116:119], v2, s[8:11], s81 offen offset:0 sc1
    buffer_load_dwordx4 v[120:123], v2, s[8:11], s81 offen offset:1024 sc1
    buffer_load_dwordx4 v[124:127], v2, s[8:11], s81 offen offset:2048 sc1
    buffer_load_dwordx4 v[128:131], v2, s[8:11], s81 offen offset:3072 sc1
    s_add_u32 s81, s81, 4096
    buffer_load_dwordx4 v[132:135], v2, s[8:11], s81 offen offset:0 sc1
    s_add_u32 s32, s24, 2
    s_and_b32 s32, s32, 3
    s_mul_i32 s32, s32, 20480
    s_add_u32 s81, s32, s70
    buffer_load_dwordx4 v[136:139], v2, s[8:11], s81 offen offset:0 sc1
    buffer_load_dwordx4 v[140:143], v2, s[8:11], s81 offen offset:1024 sc1
    buffer_load_dwordx4 v[144:147], v2, s[8:11], s81 offen offset:2048 sc1
    buffer_load_dwordx4 v[148:151], v2, s[8:11], s81 offen offset:3072 sc1
    s_add_u32 s81, s81, 4096
    buffer_load_dwordx4 v[152:155], v2, s[8:11], s81 offen offset:0 sc1
    s_add_u32 s32, s24, 3
    s_and_b32 s32, s32, 3
    s_mul_i32 s32, s32, 20480
    s_add_u32 s81, s32, s70
    buffer_load_dwordx4 v[156:159], v2, s[8:11], s81 offen offset:0 sc1
    buffer_load_dwordx4 v[160:163], v2, s[8:11], s81 offen offset:1024 sc1
    s_waitcnt vmcnt(11)
    v_mfma_f32_16x16x32_bf16 v[196:199], v[16:19], v[116:119], 0
    v_mfma_f32_16x16x32_bf16 v[200:203], v[20:23], v[116:119], 0
    buffer_load_dwordx4 v[164:167], v2, s[8:11], s81 offen offset:2048 sc1
    v_mfma_f32_16x16x32_bf16 v[204:207], v[24:27], v[116:119], 0
    v_mfma_f32_16x16x32_bf16 v[208:211], v[28:31], v[116:119], 0
    v_mfma_f32_16x16x32_bf16 v[212:215], v[32:35], v[116:119], 0
    s_waitcnt vmcnt(11)
    v_mfma_f32_16x16x32_bf16 v[196:199], v[36:39], v[120:123], v[196:199]
    v_mfma_f32_16x16x32_bf16 v[200:203], v[40:43], v[120:123], v[200:203]
    buffer_load_dwordx4 v[168:171], v2, s[8:11], s81 offen offset:3072 sc1
    v_mfma_f32_16x16x32_bf16 v[204:207], v[44:47], v[120:123], v[204:207]
    v_mfma_f32_16x16x32_bf16 v[208:211], v[48:51], v[120:123], v[208:211]
    v_mfma_f32_16x16x32_bf16 v[212:215], v[52:55], v[120:123], v[212:215]
    s_waitcnt vmcnt(11)
    v_mfma_f32_16x16x32_bf16 v[196:199], v[56:59], v[124:127], v[196:199]
    v_mfma_f32_16x16x32_bf16 v[200:203], v[60:63], v[124:127], v[200:203]
    s_add_u32 s81, s81, 4096
    buffer_load_dwordx4 v[172:175], v2, s[8:11], s81 offen offset:0 sc1
    v_mfma_f32_16x16x32_bf16 v[204:207], v[64:67], v[124:127], v[204:207]
    v_mfma_f32_16x16x32_bf16 v[208:211], v[68:71], v[124:127], v[208:211]
    v_mfma_f32_16x16x32_bf16 v[212:215], v[72:75], v[124:127], v[212:215]
    s_waitcnt vmcnt(11)
    v_mfma_f32_16x16x32_bf16 v[196:199], v[76:79], v[128:131], v[196:199]
    v_mfma_f32_16x16x32_bf16 v[200:203], v[80:83], v[128:131], v[200:203]
    s_add_u32 s32, s24, 4
    s_and_b32 s32, s32, 3
    s_mul_i32 s32, s32, 20480
    s_add_u32 s81, s32, s70
    buffer_load_dwordx4 v[176:179], v2, s[8:11], s81 offen offset:0 sc1
    v_mfma_f32_16x16x32_bf16 v[204:207], v[84:87], v[128:131], v[204:207]
    v_mfma_f32_16x16x32_bf16 v[208:211], v[88:91], v[128:131], v[208:211]
    v_mfma_f32_16x16x32_bf16 v[212:215], v[92:95], v[128:131], v[212:215]
    s_waitcnt vmcnt(11)
    v_mfma_f32_16x16x32_bf16 v[196:199], v[96:99], v[132:135], v[196:199]
    v_mfma_f32_16x16x32_bf16 v[200:203], v[100:103], v[132:135], v[200:203]
    buffer_load_dwordx4 v[180:183], v2, s[8:11], s81 offen offset:1024 sc1
    v_mfma_f32_16x16x32_bf16 v[204:207], v[104:107], v[132:135], v[204:207]
    v_mfma_f32_16x16x32_bf16 v[208:211], v[108:111], v[132:135], v[208:211]
    v_mfma_f32_16x16x32_bf16 v[212:215], v[112:115], v[132:135], v[212:215]
    s_waitcnt vmcnt(11)
    v_mfma_f32_16x16x32_bf16 v[216:219], v[16:19], v[136:139], 0
    v_mfma_f32_16x16x32_bf16 v[220:223], v[20:23], v[136:139], 0
    buffer_load_dwordx4 v[184:187], v2, s[8:11], s81 offen offset:2048 sc1
    v_mfma_f32_16x16x32_bf16 v[224:227], v[24:27], v[136:139], 0
    v_mfma_f32_16x16x32_bf16 v[228:231], v[28:31], v[136:139], 0
    v_mfma_f32_16x16x32_bf16 v[232:235], v[32:35], v[136:139], 0
    ds_write_b128 v248, v[196:199] offset:0
    s_waitcnt vmcnt(11)
    v_mfma_f32_16x16x32_bf16 v[216:219], v[36:39], v[140:143], v[216:219]
    v_mfma_f32_16x16x32_bf16 v[220:223], v[40:43], v[140:143], v[220:223]
    buffer_load_dwordx4 v[188:191], v2, s[8:11], s81 offen offset:3072 sc1
    v_mfma_f32_16x16x32_bf16 v[224:227], v[44:47], v[140:143], v[224:227]
    v_mfma_f32_16x16x32_bf16 v[228:231], v[48:51], v[140:143], v[228:231]
    v_mfma_f32_16x16x32_bf16 v[232:235], v[52:55], v[140:143], v[232:235]
    ds_write_b128 v248, v[200:203] offset:1024
    s_waitcnt vmcnt(11)
    v_mfma_f32_16x16x32_bf16 v[216:219], v[56:59], v[144:147], v[216:219]
    v_mfma_f32_16x16x32_bf16 v[220:223], v[60:63], v[144:147], v[220:223]
    s_add_u32 s81, s81, 4096
    buffer_load_dwordx4 v[192:195], v2, s[8:11], s81 offen offset:0 sc1
    v_mfma_f32_16x16x32_bf16 v[224:227], v[64:67], v[144:147], v[224:227]
    v_mfma_f32_16x16x32_bf16 v[228:231], v[68:71], v[144:147], v[228:231]
    v_mfma_f32_16x16x32_bf16 v[232:235], v[72:75], v[144:147], v[232:235]
    ds_write_b128 v248, v[204:207] offset:2048
    s_waitcnt vmcnt(11)
    v_mfma_f32_16x16x32_bf16 v[216:219], v[76:79], v[148:151], v[216:219]
    v_mfma_f32_16x16x32_bf16 v[220:223], v[80:83], v[148:151], v[220:223]
    v_mfma_f32_16x16x32_bf16 v[224:227], v[84:87], v[148:151], v[224:227]
    v_mfma_f32_16x16x32_bf16 v[228:231], v[88:91], v[148:151], v[228:231]
    s_add_u32 s83, s82, 20480
    buffer_load_dwordx4 a[80:83], v2, s[8:11], s83 offen
    v_mfma_f32_16x16x32_bf16 v[232:235], v[92:95], v[148:151], v[232:235]
    ds_write_b128 v248, v[208:211] offset:3072
    s_waitcnt vmcnt(11)
    v_mfma_f32_16x16x32_bf16 v[216:219], v[96:99], v[152:155], v[216:219]
    v_mfma_f32_16x16x32_bf16 v[220:223], v[100:103], v[152:155], v[220:223]
    v_mfma_f32_16x16x32_bf16 v[224:227], v[104:107], v[152:155], v[224:227]
    v_mfma_f32_16x16x32_bf16 v[228:231], v[108:111], v[152:155], v[228:231]
    s_add_u32 s83, s82, 21504
    buffer_load_dwordx4 a[84:87], v2, s[8:11], s83 offen
    v_mfma_f32_16x16x32_bf16 v[232:235], v[112:115], v[152:155], v[232:235]
    ds_write_b128 v248, v[212:215] offset:4096
    s_waitcnt vmcnt(11)
    v_mfma_f32_16x16x32_bf16 v[196:199], v[16:19], v[156:159], 0
    v_mfma_f32_16x16x32_bf16 v[200:203], v[20:23], v[156:159], 0
    v_mfma_f32_16x16x32_bf16 v[204:207], v[24:27], v[156:159], 0
    v_mfma_f32_16x16x32_bf16 v[208:211], v[28:31], v[156:159], 0
    s_add_u32 s83, s82, 22528
    buffer_load_dwordx4 a[88:91], v2, s[8:11], s83 offen
    v_mfma_f32_16x16x32_bf16 v[212:215], v[32:35], v[156:159], 0
    ds_write_b128 v249, v[216:219] offset:0
    s_waitcnt vmcnt(11)
    v_mfma_f32_16x16x32_bf16 v[196:199], v[36:39], v[160:163], v[196:199]
    v_mfma_f32_16x16x32_bf16 v[200:203], v[40:43], v[160:163], v[200:203]
    v_mfma_f32_16x16x32_bf16 v[204:207], v[44:47], v[160:163], v[204:207]
    v_mfma_f32_16x16x32_bf16 v[208:211], v[48:51], v[160:163], v[208:211]
    s_add_u32 s83, s82, 23552
    buffer_load_dwordx4 a[92:95], v2, s[8:11], s83 offen
    v_mfma_f32_16x16x32_bf16 v[212:215], v[52:55], v[160:163], v[212:215]
    ds_write_b128 v249, v[220:223] offset:1024
    s_waitcnt vmcnt(11)
    v_mfma_f32_16x16x32_bf16 v[196:199], v[56:59], v[164:167], v[196:199]
    v_mfma_f32_16x16x32_bf16 v[200:203], v[60:63], v[164:167], v[200:203]
    v_mfma_f32_16x16x32_bf16 v[204:207], v[64:67], v[164:167], v[204:207]
    v_mfma_f32_16x16x32_bf16 v[208:211], v[68:71], v[164:167], v[208:211]
    s_add_u32 s83, s82, 24576
    buffer_load_dwordx4 a[96:99], v2, s[8:11], s83 offen
    v_mfma_f32_16x16x32_bf16 v[212:215], v[72:75], v[164:167], v[212:215]
    ds_write_b128 v249, v[224:227] offset:2048
    s_waitcnt vmcnt(11)
    v_mfma_f32_16x16x32_bf16 v[196:199], v[76:79], v[168:171], v[196:199]
    v_mfma_f32_16x16x32_bf16 v[200:203], v[80:83], v[168:171], v[200:203]
    v_mfma_f32_16x16x32_bf16 v[204:207], v[84:87], v[168:171], v[204:207]
    v_mfma_f32_16x16x32_bf16 v[208:211], v[88:91], v[168:171], v[208:211]
    s_add_u32 s83, s82, 25600
    buffer_load_dwordx4 a[100:103], v2, s[8:11], s83 offen
    v_mfma_f32_16x16x32_bf16 v[212:215], v[92:95], v[168:171], v[212:215]
    ds_write_b128 v249, v[228:231] offset:3072
    s_waitcnt vmcnt(11)
    v_mfma_f32_16x16x32_bf16 v[196:199], v[96:99], v[172:175], v[196:199]
    v_mfma_f32_16x16x32_bf16 v[200:203], v[100:103], v[172:175], v[200:203]
    v_mfma_f32_16x16x32_bf16 v[204:207], v[104:107], v[172:175], v[204:207]
    v_mfma_f32_16x16x32_bf16 v[208:211], v[108:111], v[172:175], v[208:211]
    s_add_u32 s83, s82, 26624
    buffer_load_dwordx4 a[104:107], v2, s[8:11], s83 offen
    v_mfma_f32_16x16x32_bf16 v[212:215], v[112:115], v[172:175], v[212:215]
    ds_write_b128 v249, v[232:235] offset:4096
    s_waitcnt vmcnt(11)
    v_mfma_f32_16x16x32_bf16 v[216:219], v[16:19], v[176:179], 0
    v_mfma_f32_16x16x32_bf16 v[220:223], v[20:23], v[176:179], 0
    v_mfma_f32_16x16x32_bf16 v[224:227], v[24:27], v[176:179], 0
    v_mfma_f32_16x16x32_bf16 v[228:231], v[28:31], v[176:179], 0
    s_add_u32 s83, s82, 27648
    buffer_load_dwordx4 a[108:111], v2, s[8:11], s83 offen
    v_mfma_f32_16x16x32_bf16 v[232:235], v[32:35], v[176:179], 0
    ds_write_b128 v250, v[196:199] offset:0
    s_waitcnt vmcnt(11)
    v_mfma_f32_16x16x32_bf16 v[216:219], v[36:39], v[180:183], v[216:219]
    v_mfma_f32_16x16x32_bf16 v[220:223], v[40:43], v[180:183], v[220:223]
    v_mfma_f32_16x16x32_bf16 v[224:227], v[44:47], v[180:183], v[224:227]
    v_mfma_f32_16x16x32_bf16 v[228:231], v[48:51], v[180:183], v[228:231]
    s_add_u32 s83, s82, 28672
    buffer_load_dwordx4 a[112:115], v2, s[8:11], s83 offen
    v_mfma_f32_16x16x32_bf16 v[232:235], v[52:55], v[180:183], v[232:235]
    ds_write_b128 v250, v[200:203] offset:1024
    s_waitcnt vmcnt(11)
    v_mfma_f32_16x16x32_bf16 v[216:219], v[56:59], v[184:187], v[216:219]
    v_mfma_f32_16x16x32_bf16 v[220:223], v[60:63], v[184:187], v[220:223]
    v_mfma_f32_16x16x32_bf16 v[224:227], v[64:67], v[184:187], v[224:227]
    v_mfma_f32_16x16x32_bf16 v[228:231], v[68:71], v[184:187], v[228:231]
    s_add_u32 s83, s82, 29696
    buffer_load_dwordx4 a[116:119], v2, s[8:11], s83 offen
    v_mfma_f32_16x16x32_bf16 v[232:235], v[72:75], v[184:187], v[232:235]
    ds_write_b128 v250, v[204:207] offset:2048
    s_waitcnt vmcnt(11)
    v_mfma_f32_16x16x32_bf16 v[216:219], v[76:79], v[188:191], v[216:219]
    v_mfma_f32_16x16x32_bf16 v[220:223], v[80:83], v[188:191], v[220:223]
    v_mfma_f32_16x16x32_bf16 v[224:227], v[84:87], v[188:191], v[224:227]
    v_mfma_f32_16x16x32_bf16 v[228:231], v[88:91], v[188:191], v[228:231]
    s_add_u32 s83, s82, 30720
    buffer_load_dwordx4 a[120:123], v2, s[8:11], s83 offen
    v_mfma_f32_16x16x32_bf16 v[232:235], v[92:95], v[188:191], v[232:235]
    ds_write_b128 v250, v[208:211] offset:3072
    s_waitcnt vmcnt(11)
    v_mfma_f32_16x16x32_bf16 v[216:219], v[96:99], v[192:195], v[216:219]
    v_mfma_f32_16x16x32_bf16 v[220:223], v[100:103], v[192:195], v[220:223]
    v_mfma_f32_16x16x32_bf16 v[224:227], v[104:107], v[192:195], v[224:227]
    v_mfma_f32_16x16x32_bf16 v[228:231], v[108:111], v[192:195], v[228:231]
    s_add_u32 s83, s82, 31744
    buffer_load_dwordx4 a[124:127], v2, s[8:11], s83 offen
    v_mfma_f32_16x16x32_bf16 v[232:235], v[112:115], v[192:195], v[232:235]
    ds_write_b128 v250, v[212:215] offset:4096
    s_add_u32 s83, s82, 32768
    buffer_load_dwordx4 a[128:131], v2, s[8:11], s83 offen
    s_add_u32 s83, s82, 33792
    buffer_load_dwordx4 a[132:135], v2, s[8:11], s83 offen
    s_add_u32 s83, s82, 34816
    buffer_load_dwordx4 a[136:139], v2, s[8:11], s83 offen
    s_add_u32 s83, s82, 35840
    buffer_load_dwordx4 a[140:143], v2, s[8:11], s83 offen
    s_add_u32 s83, s82, 36864
    buffer_load_dwordx4 a[144:147], v2, s[8:11], s83 offen
    s_add_u32 s83, s82, 37888
    buffer_load_dwordx4 a[148:151], v2, s[8:11], s83 offen
    s_add_u32 s83, s82, 38912
    buffer_load_dwordx4 a[152:155], v2, s[8:11], s83 offen
    s_add_u32 s83, s82, 39936
    buffer_load_dwordx4 a[156:159], v2, s[8:11], s83 offen
    s_branch L_dl_p3_j
L_dl_p3_1:
    s_add_u32 s32, s24, 1
    s_and_b32 s32, s32, 3
    s_mul_i32 s32, s32, 20480
    s_add_u32 s81, s32, s70
    buffer_load_dwordx4 v[116:119], v2, s[8:11], s81 offen offset:0 sc1
    buffer_load_dwordx4 v[120:123], v2, s[8:11], s81 offen offset:1024 sc1
    buffer_load_dwordx4 v[124:127], v2, s[8:11], s81 offen offset:2048 sc1
    buffer_load_dwordx4 v[128:131], v2, s[8:11], s81 offen offset:3072 sc1
    s_add_u32 s81, s81, 4096
    buffer_load_dwordx4 v[132:135], v2, s[8:11], s81 offen offset:0 sc1
    s_add_u32 s32, s24, 2
    s_and_b32 s32, s32, 3
    s_mul_i32 s32, s32, 20480
    s_add_u32 s81, s32, s70
    buffer_load_dwordx4 v[136:139], v2, s[8:11], s81 offen offset:0 sc1
    buffer_load_dwordx4 v[140:143], v2, s[8:11], s81 offen offset:1024 sc1
    buffer_load_dwordx4 v[144:147], v2, s[8:11], s81 offen offset:2048 sc1
    buffer_load_dwordx4 v[148:151], v2, s[8:11], s81 offen offset:3072 sc1
    s_add_u32 s81, s81, 4096
    buffer_load_dwordx4 v[152:155], v2, s[8:11], s81 offen offset:0 sc1
    s_add_u32 s32, s24, 3
    s_and_b32 s32, s32, 3
    s_mul_i32 s32, s32, 20480
    s_add_u32 s81, s32, s70
    buffer_load_dwordx4 v[156:159], v2, s[8:11], s81 offen offset:0 sc1
    buffer_load_dwordx4 v[160:163], v2, s[8:11], s81 offen offset:1024 sc1
    s_waitcnt vmcnt(11)
    v_mfma_f32_16x16x32_bf16 v[196:199], v[16:19], v[116:119], 0
    v_mfma_f32_16x16x32_bf16 v[200:203], v[20:23], v[116:119], 0
    buffer_load_dwordx4 v[164:167], v2, s[8:11], s81 offen offset:2048 sc1
    v_mfma_f32_16x16x32_bf16 v[204:207], v[24:27], v[116:119], 0
    v_mfma_f32_16x16x32_bf16 v[208:211], v[28:31], v[116:119], 0
    v_mfma_f32_16x16x32_bf16 v[212:215], v[32:35], v[116:119], 0
    s_waitcnt vmcnt(11)
    v_mfma_f32_16x16x32_bf16 v[196:199], v[36:39], v[120:123], v[196:199]
    v_mfma_f32_16x16x32_bf16 v[200:203], v[40:43], v[120:123], v[200:203]
    buffer_load_dwordx4 v[168:171], v2, s[8:11], s81 offen offset:3072 sc1
    v_mfma_f32_16x16x32_bf16 v[204:207], v[44:47], v[120:123], v[204:207]
    v_mfma_f32_16x16x32_bf16 v[208:211], v[48:51], v[120:123], v[208:211]
    v_mfma_f32_16x16x32_bf16 v[212:215], v[52:55], v[120:123], v[212:215]
    s_waitcnt vmcnt(11)
    v_mfma_f32_16x16x32_bf16 v[196:199], v[56:59], v[124:127], v[196:199]
    v_mfma_f32_16x16x32_bf16 v[200:203], v[60:63], v[124:127], v[200:203]
    s_add_u32 s81, s81, 4096
    buffer_load_dwordx4 v[172:175], v2, s[8:11], s81 offen offset:0 sc1
    v_mfma_f32_16x16x32_bf16 v[204:207], v[64:67], v[124:127], v[204:207]
    v_mfma_f32_16x16x32_bf16 v[208:211], v[68:71], v[124:127], v[208:211]
    v_mfma_f32_16x16x32_bf16 v[212:215], v[72:75], v[124:127], v[212:215]
    s_waitcnt vmcnt(11)
    v_mfma_f32_16x16x32_bf16 v[196:199], v[76:79], v[128:131], v[196:199]
    v_mfma_f32_16x16x32_bf16 v[200:203], v[80:83], v[128:131], v[200:203]
    s_add_u32 s32, s24, 4
    s_and_b32 s32, s32, 3
    s_mul_i32 s32, s32, 20480
    s_add_u32 s81, s32, s70
    buffer_load_dwordx4 v[176:179], v2, s[8:11], s81 offen offset:0 sc1
    v_mfma_f32_16x16x32_bf16 v[204:207], v[84:87], v[128:131], v[204:207]
    v_mfma_f32_16x16x32_bf16 v[208:211], v[88:91], v[128:131], v[208:211]
    v_mfma_f32_16x16x32_bf16 v[212:215], v[92:95], v[128:131], v[212:215]
    s_waitcnt vmcnt(11)
    v_mfma_f32_16x16x32_bf16 v[196:199], v[96:99], v[132:135], v[196:199]
    v_mfma_f32_16x16x32_bf16 v[200:203], v[100:103], v[132:135], v[200:203]
    buffer_load_dwordx4 v[180:183], v2, s[8:11], s81 offen offset:1024 sc1
    v_mfma_f32_16x16x32_bf16 v[204:207], v[104:107], v[132:135], v[204:207]
    v_mfma_f32_16x16x32_bf16 v[208:211], v[108:111], v[132:135], v[208:211]
    v_mfma_f32_16x16x32_bf16 v[212:215], v[112:115], v[132:135], v[212:215]
    s_waitcnt vmcnt(11)
    v_mfma_f32_16x16x32_bf16 v[216:219], v[16:19], v[136:139], 0
    v_mfma_f32_16x16x32_bf16 v[220:223], v[20:23], v[136:139], 0
    buffer_load_dwordx4 v[184:187], v2, s[8:11], s81 offen offset:2048 sc1
    v_mfma_f32_16x16x32_bf16 v[224:227], v[24:27], v[136:139], 0
    v_mfma_f32_16x16x32_bf16 v[228:231], v[28:31], v[136:139], 0
    v_mfma_f32_16x16x32_bf16 v[232:235], v[32:35], v[136:139], 0
    ds_write_b128 v248, v[196:199] offset:0
    s_waitcnt vmcnt(11)
    v_mfma_f32_16x16x32_bf16 v[216:219], v[36:39], v[140:143], v[216:219]
    v_mfma_f32_16x16x32_bf16 v[220:223], v[40:43], v[140:143], v[220:223]
    buffer_load_dwordx4 v[188:191], v2, s[8:11], s81 offen offset:3072 sc1
    v_mfma_f32_16x16x32_bf16 v[224:227], v[44:47], v[140:143], v[224:227]
    v_mfma_f32_16x16x32_bf16 v[228:231], v[48:51], v[140:143], v[228:231]
    v_mfma_f32_16x16x32_bf16 v[232:235], v[52:55], v[140:143], v[232:235]
    ds_write_b128 v248, v[200:203] offset:1024
    s_waitcnt vmcnt(11)
    v_mfma_f32_16x16x32_bf16 v[216:219], v[56:59], v[144:147], v[216:219]
    v_mfma_f32_16x16x32_bf16 v[220:223], v[60:63], v[144:147], v[220:223]
    s_add_u32 s81, s81, 4096
    buffer_load_dwordx4 v[192:195], v2, s[8:11], s81 offen offset:0 sc1
    v_mfma_f32_16x16x32_bf16 v[224:227], v[64:67], v[144:147], v[224:227]
    v_mfma_f32_16x16x32_bf16 v[228:231], v[68:71], v[144:147], v[228:231]
    v_mfma_f32_16x16x32_bf16 v[232:235], v[72:75], v[144:147], v[232:235]
    ds_write_b128 v248, v[204:207] offset:2048
    s_waitcnt vmcnt(11)
    v_mfma_f32_16x16x32_bf16 v[216:219], v[76:79], v[148:151], v[216:219]
    v_mfma_f32_16x16x32_bf16 v[220:223], v[80:83], v[148:151], v[220:223]
    v_mfma_f32_16x16x32_bf16 v[224:227], v[84:87], v[148:151], v[224:227]
    v_mfma_f32_16x16x32_bf16 v[228:231], v[88:91], v[148:151], v[228:231]
    v_mfma_f32_16x16x32_bf16 v[232:235], v[92:95], v[148:151], v[232:235]
    ds_write_b128 v248, v[208:211] offset:3072
    s_waitcnt vmcnt(10)
    v_mfma_f32_16x16x32_bf16 v[216:219], v[96:99], v[152:155], v[216:219]
    v_mfma_f32_16x16x32_bf16 v[220:223], v[100:103], v[152:155], v[220:223]
    v_mfma_f32_16x16x32_bf16 v[224:227], v[104:107], v[152:155], v[224:227]
    v_mfma_f32_16x16x32_bf16 v[228:231], v[108:111], v[152:155], v[228:231]
    v_mfma_f32_16x16x32_bf16 v[232:235], v[112:115], v[152:155], v[232:235]
    ds_write_b128 v248, v[212:215] offset:4096
    s_waitcnt vmcnt(9)
    v_mfma_f32_16x16x32_bf16 v[196:199], v[16:19], v[156:159], 0
    v_mfma_f32_16x16x32_bf16 v[200:203], v[20:23], v[156:159], 0
    v_mfma_f32_16x16x32_bf16 v[204:207], v[24:27], v[156:159], 0
    v_mfma_f32_16x16x32_bf16 v[208:211], v[28:31], v[156:159], 0
    v_mfma_f32_16x16x32_bf16 v[212:215], v[32:35], v[156:159], 0
    ds_write_b128 v249, v[216:219] offset:0
    s_waitcnt vmcnt(8)
    v_mfma_f32_16x16x32_bf16 v[196:199], v[36:39], v[160:163], v[196:199]
    v_mfma_f32_16x16x32_bf16 v[200:203], v[40:43], v[160:163], v[200:203]
    v_mfma_f32_16x16x32_bf16 v[204:207], v[44:47], v[160:163], v[204:207]
    v_mfma_f32_16x16x32_bf16 v[208:211], v[48:51], v[160:163], v[208:211]
    v_mfma_f32_16x16x32_bf16 v[212:215], v[52:55], v[160:163], v[212:215]
    ds_write_b128 v249, v[220:223] offset:1024
    s_waitcnt vmcnt(7)
    v_mfma_f32_16x16x32_bf16 v[196:199], v[56:59], v[164:167], v[196:199]
    v_mfma_f32_16x16x32_bf16 v[200:203], v[60:63], v[164:167], v[200:203]
    v_mfma_f32_16x16x32_bf16 v[204:207], v[64:67], v[164:167], v[204:207]
    v_mfma_f32_16x16x32_bf16 v[208:211], v[68:71], v[164:167], v[208:211]
    v_mfma_f32_16x16x32_bf16 v[212:215], v[72:75], v[164:167], v[212:215]
    ds_write_b128 v249, v[224:227] offset:2048
    s_waitcnt vmcnt(6)
    v_mfma_f32_16x16x32_bf16 v[196:199], v[76:79], v[168:171], v[196:199]
    v_mfma_f32_16x16x32_bf16 v[200:203], v[80:83], v[168:171], v[200:203]
    v_mfma_f32_16x16x32_bf16 v[204:207], v[84:87], v[168:171], v[204:207]
    v_mfma_f32_16x16x32_bf16 v[208:211], v[88:91], v[168:171], v[208:211]
    v_mfma_f32_16x16x32_bf16 v[212:215], v[92:95], v[168:171], v[212:215]
    ds_write_b128 v249, v[228:231] offset:3072
    s_waitcnt vmcnt(5)
    v_mfma_f32_16x16x32_bf16 v[196:199], v[96:99], v[172:175], v[196:199]
    v_mfma_f32_16x16x32_bf16 v[200:203], v[100:103], v[172:175], v[200:203]
    v_mfma_f32_16x16x32_bf16 v[204:207], v[104:107], v[172:175], v[204:207]
    v_mfma_f32_16x16x32_bf16 v[208:211], v[108:111], v[172:175], v[208:211]
    v_mfma_f32_16x16x32_bf16 v[212:215], v[112:115], v[172:175], v[212:215]
    ds_write_b128 v249, v[232:235] offset:4096
    s_waitcnt vmcnt(4)
    v_mfma_f32_16x16x32_bf16 v[216:219], v[16:19], v[176:179], 0
    v_mfma_f32_16x16x32_bf16 v[220:223], v[20:23], v[176:179], 0
    v_mfma_f32_16x16x32_bf16 v[224:227], v[24:27], v[176:179], 0
    v_mfma_f32_16x16x32_bf16 v[228:231], v[28:31], v[176:179], 0
    v_mfma_f32_16x16x32_bf16 v[232:235], v[32:35], v[176:179], 0
    ds_write_b128 v250, v[196:199] offset:0
    s_waitcnt vmcnt(3)
    v_mfma_f32_16x16x32_bf16 v[216:219], v[36:39], v[180:183], v[216:219]
    v_mfma_f32_16x16x32_bf16 v[220:223], v[40:43], v[180:183], v[220:223]
    v_mfma_f32_16x16x32_bf16 v[224:227], v[44:47], v[180:183], v[224:227]
    v_mfma_f32_16x16x32_bf16 v[228:231], v[48:51], v[180:183], v[228:231]
    v_mfma_f32_16x16x32_bf16 v[232:235], v[52:55], v[180:183], v[232:235]
    ds_write_b128 v250, v[200:203] offset:1024
    s_waitcnt vmcnt(2)
    v_mfma_f32_16x16x32_bf16 v[216:219], v[56:59], v[184:187], v[216:219]
    v_mfma_f32_16x16x32_bf16 v[220:223], v[60:63], v[184:187], v[220:223]
    v_mfma_f32_16x16x32_bf16 v[224:227], v[64:67], v[184:187], v[224:227]
    v_mfma_f32_16x16x32_bf16 v[228:231], v[68:71], v[184:187], v[228:231]
    v_mfma_f32_16x16x32_bf16 v[232:235], v[72:75], v[184:187], v[232:235]
    ds_write_b128 v250, v[204:207] offset:2048
    s_waitcnt vmcnt(1)
    v_mfma_f32_16x16x32_bf16 v[216:219], v[76:79], v[188:191], v[216:219]
    v_mfma_f32_16x16x32_bf16 v[220:223], v[80:83], v[188:191], v[220:223]
    v_mfma_f32_16x16x32_bf16 v[224:227], v[84:87], v[188:191], v[224:227]
    v_mfma_f32_16x16x32_bf16 v[228:231], v[88:91], v[188:191], v[228:231]
    v_mfma_f32_16x16x32_bf16 v[232:235], v[92:95], v[188:191], v[232:235]
    ds_write_b128 v250, v[208:211] offset:3072
    s_waitcnt vmcnt(0)
    v_mfma_f32_16x16x32_bf16 v[216:219], v[96:99], v[192:195], v[216:219]
    v_mfma_f32_16x16x32_bf16 v[220:223], v[100:103], v[192:195], v[220:223]
    v_mfma_f32_16x16x32_bf16 v[224:227], v[104:107], v[192:195], v[224:227]
    v_mfma_f32_16x16x32_bf16 v[228:231], v[108:111], v[192:195], v[228:231]
    v_mfma_f32_16x16x32_bf16 v[232:235], v[112:115], v[192:195], v[232:235]
    ds_write_b128 v250, v[212:215] offset:4096
L_dl_p3_j:
    s_waitcnt lgkmcnt(0)
    s_barrier
    ds_read_b128 v[132:135], v251 offset:0
    ds_read_b128 v[136:139], v251 offset:1024
    ds_read_b128 v[140:143], v251 offset:2048
    ds_read_b128 v[144:147], v251 offset:3072
    ds_read_b128 v[148:151], v251 offset:4096
    ds_read_b128 v[152:155], v251 offset:5120
    ds_read_b128 v[156:159], v251 offset:6144
    ds_read_b128 v[160:163], v251 offset:7168
    ds_read_b128 v[164:167], v251 offset:8192
    ds_read_b128 v[168:171], v251 offset:9216
    ds_read_b128 v[172:175], v251 offset:10240
    ds_read_b128 v[176:179], v251 offset:11264
    ds_read_b128 v[180:183], v251 offset:12288
    ds_read_b128 v[184:187], v251 offset:13312
    ds_read_b128 v[188:191], v251 offset:14336
    s_waitcnt lgkmcnt(14)
    v_pk_add_f32 v[216:217], v[216:217], v[132:133]
    v_pk_add_f32 v[218:219], v[218:219], v[134:135]
    s_waitcnt lgkmcnt(13)
    v_pk_add_f32 v[220:221], v[220:221], v[136:137]
    v_pk_add_f32 v[222:223], v[222:223], v[138:139]
    s_waitcnt lgkmcnt(12)
    v_pk_add_f32 v[224:225], v[224:225], v[140:141]
    v_pk_add_f32 v[226:227], v[226:227], v[142:143]
    s_waitcnt lgkmcnt(11)
    v_pk_add_f32 v[228:229], v[228:229], v[144:145]
    v_pk_add_f32 v[230:231], v[230:231], v[146:147]
    s_waitcnt lgkmcnt(10)
    v_pk_add_f32 v[232:233], v[232:233], v[148:149]
    v_pk_add_f32 v[234:235], v[234:235], v[150:151]
    s_waitcnt lgkmcnt(9)
    v_pk_add_f32 v[216:217], v[216:217], v[152:153]
    v_pk_add_f32 v[218:219], v[218:219], v[154:155]
    s_waitcnt lgkmcnt(8)
    v_pk_add_f32 v[220:221], v[220:221], v[156:157]
    v_pk_add_f32 v[222:223], v[222:223], v[158:159]
    s_waitcnt lgkmcnt(7)
    v_pk_add_f32 v[224:225], v[224:225], v[160:161]
    v_pk_add_f32 v[226:227], v[226:227], v[162:163]
    s_waitcnt lgkmcnt(6)
    v_pk_add_f32 v[228:229], v[228:229], v[164:165]
    v_pk_add_f32 v[230:231], v[230:231], v[166:167]
    s_waitcnt lgkmcnt(5)
    v_pk_add_f32 v[232:233], v[232:233], v[168:169]
    v_pk_add_f32 v[234:235], v[234:235], v[170:171]
    s_waitcnt lgkmcnt(4)
    v_pk_add_f32 v[216:217], v[216:217], v[172:173]
    v_pk_add_f32 v[218:219], v[218:219], v[174:175]
    s_waitcnt lgkmcnt(3)
    v_pk_add_f32 v[220:221], v[220:221], v[176:177]
    v_pk_add_f32 v[222:223], v[222:223], v[178:179]
    s_waitcnt lgkmcnt(2)
    v_pk_add_f32 v[224:225], v[224:225], v[180:181]
    v_pk_add_f32 v[226:227], v[226:227], v[182:183]
    s_waitcnt lgkmcnt(1)
    v_pk_add_f32 v[228:229], v[228:229], v[184:185]
    v_pk_add_f32 v[230:231], v[230:231], v[186:187]
    s_waitcnt lgkmcnt(0)
    v_pk_add_f32 v[232:233], v[232:233], v[188:189]
    v_pk_add_f32 v[234:235], v[234:235], v[190:191]
    v_lshlrev_b32 v16, 16, v6
    v_and_b32 v17, 0xffff0000, v6
    v_pk_add_f32 v[216:217], v[216:217], v[16:17]
    v_cvt_pk_bf16_f32 v6, v216, v217
    v_lshlrev_b32 v20, 16, v7
    v_and_b32 v21, 0xffff0000, v7
    v_pk_add_f32 v[218:219], v[218:219], v[20:21]
    v_cvt_pk_bf16_f32 v7, v218, v219
    v_lshlrev_b32 v16, 16, v8
    v_and_b32 v17, 0xffff0000, v8
    v_pk_add_f32 v[220:221], v[220:221], v[16:17]
    v_cvt_pk_bf16_f32 v8, v220, v221
    v_lshlrev_b32 v20, 16, v9
    v_and_b32 v21, 0xffff0000, v9
    v_pk_add_f32 v[222:223], v[222:223], v[20:21]
    v_cvt_pk_bf16_f32 v9, v222, v223
    v_lshlrev_b32 v16, 16, v10
    v_and_b32 v17, 0xffff0000, v10
    v_pk_add_f32 v[224:225], v[224:225], v[16:17]
    v_cvt_pk_bf16_f32 v10, v224, v225
    v_lshlrev_b32 v20, 16, v11
    v_and_b32 v21, 0xffff0000, v11
    v_pk_add_f32 v[226:227], v[226:227], v[20:21]
    v_cvt_pk_bf16_f32 v11, v226, v227
    v_lshlrev_b32 v16, 16, v12
    v_and_b32 v17, 0xffff0000, v12
    v_pk_add_f32 v[228:229], v[228:229], v[16:17]
    v_cvt_pk_bf16_f32 v12, v228, v229
    v_lshlrev_b32 v20, 16, v13
    v_and_b32 v21, 0xffff0000, v13
    v_pk_add_f32 v[230:231], v[230:231], v[20:21]
    v_cvt_pk_bf16_f32 v13, v230, v231
    v_lshlrev_b32 v16, 16, v14
    v_and_b32 v17, 0xffff0000, v14
    v_pk_add_f32 v[232:233], v[232:233], v[16:17]
    v_cvt_pk_bf16_f32 v14, v232, v233
    v_lshlrev_b32 v20, 16, v15
    v_and_b32 v21, 0xffff0000, v15
    v_pk_add_f32 v[234:235], v[234:235], v[20:21]
    v_cvt_pk_bf16_f32 v15, v234, v235
    buffer_store_dwordx2 v[6:7], v0, s[8:11], s76 offen offset:0 sc1
    buffer_store_dwordx2 v[8:9], v0, s[8:11], s76 offen offset:1024 sc1
    buffer_store_dwordx2 v[10:11], v0, s[8:11], s76 offen offset:2048 sc1
    buffer_store_dwordx2 v[12:13], v0, s[8:11], s76 offen offset:3072 sc1
    buffer_store_dwordx2 v[14:15], v0, s[8:11], s77 offen sc1
    s_mov_b32 s32, 0x3f803f80
    v_dot2_f32_bf16 v24, v6, s32, 0
    v_dot2_f32_bf16 v26, v6, v6, 0
    v_dot2_f32_bf16 v25, v7, s32, 0
    v_dot2_f32_bf16 v27, v7, v7, 0
    v_dot2_f32_bf16 v24, v8, s32, v24
    v_dot2_f32_bf16 v26, v8, v8, v26
    v_dot2_f32_bf16 v25, v9, s32, v25
    v_dot2_f32_bf16 v27, v9, v9, v27
    v_dot2_f32_bf16 v24, v10, s32, v24
    v_dot2_f32_bf16 v26, v10, v10, v26
    v_dot2_f32_bf16 v25, v11, s32, v25
    v_dot2_f32_bf16 v27, v11, v11, v27
    v_dot2_f32_bf16 v24, v12, s32, v24
    v_dot2_f32_bf16 v26, v12, v12, v26
    v_dot2_f32_bf16 v25, v13, s32, v25
    v_dot2_f32_bf16 v27, v13, v13, v27
    v_dot2_f32_bf16 v24, v14, s32, v24
    v_dot2_f32_bf16 v26, v14, v14, v26
    v_dot2_f32_bf16 v25, v15, s32, v25
    v_dot2_f32_bf16 v27, v15, v15, v27
    s_nop 1
    v_add_f32 v24, v24, v25
    v_add_f32 v25, v26, v27
    v_mov_b32 v26, v24
    v_mov_b32 v27, v25
    s_nop 0
    v_permlane32_swap_b32 v24, v26
    v_permlane32_swap_b32 v25, v27
    v_pk_add_f32 v[24:25], v[24:25], v[26:27]
    v_mov_b32 v26, v24
    v_mov_b32 v27, v25
    s_nop 0
    v_permlane16_swap_b32 v24, v26
    v_permlane16_swap_b32 v25, v27
    v_pk_add_f32 v[24:25], v[24:25], v[26:27]
    s_mov_b64 exec, 0xffff
    buffer_store_dwordx2 v[24:25], v5, s[8:11], s78 offen sc1
    s_mov_b64 exec, -1
    s_lshl_b32 s35, s25, 6
    s_add_u32 s35, s35, s26
    s_lshl_b32 s36, s29, 2
    s_add_u32 s36, s36, s30
    s_add_u32 s36, s36, 2
    s_waitcnt vmcnt(0)
    s_barrier
    s_cmp_lg_u32 s24, 0
    s_cbranch_scc1 L_fl_row_x1
    s_lshl_b32 s32, s35, 2
    s_add_u32 s32, s32, 4096
    v_mov_b32 v254, s36
    v_mov_b32 v255, 0
    s_mov_b64 s[64:65], exec
    s_mov_b64 exec, 1
    s_cmp_eq_u32 s84, 1
    s_cbranch_scc1 L_fl_row_x1_f
    buffer_store_dword v254, v255, s[8:11], s32 offen sc1
    s_branch L_fl_row_x1_j
L_fl_row_x1_f:
    buffer_store_dword v254, v255, s[8:11], s32 offen
L_fl_row_x1_j:
    s_mov_b64 exec, s[64:65]
L_fl_row_x1:
    s_mul_i32 s72, s29, 0
    s_add_u32 s72, s72, 16777216
    s_mul_i32 s73, s29, 0
    s_add_u32 s73, s73, 24641536
    s_lshl_b32 s32, s25, 2
    s_add_u32 s32, s32, s24
    s_mul_i32 s81, s32, 40960
    s_add_u32 s81, s81, s72
    s_lshl_b32 s33, s32, 11
    s_add_u32 s95, s33, s73
    v_lshlrev_b32 v48, 3, v3
    v_lshlrev_b32 v49, 10, v4
    v_add_u32 v48, v48, v49
    v_add_u32 v242, 0x10000, v2
    v_add_u32 v243, 0x20000, v2
    v_mov_b32 v241, v2
    s_lshl_b32 s70, s25, 8
    s_add_u32 s70, s70, 4096
    s_lshl_b32 s71, s29, 2
    s_add_u32 s71, s71, s30
    s_add_u32 s71, s71, 2
    s_waitcnt vmcnt(0)
    s_cmp_lg_u32 s24, 0
    s_cbranch_scc1 L_po_row_x1_done
    s_mov_b64 s[64:65], exec
    s_mov_b64 exec, 0xffff
    v_mul_u32_u24 v255, 4, v1
    s_mov_b32 s33, 0
L_po_row_x1:
    buffer_load_dword v254, v255, s[8:11], s70 offen sc1
    s_waitcnt vmcnt(0)
    v_subrev_u32 v254, s71, v254
    v_cmp_gt_u32 vcc, 8, v254
    s_add_u32 s33, s33, 1
    s_cmp_eq_u64 vcc, exec
    s_cbranch_scc1 L_po_row_x1_ok
    s_cmp_lt_u32 s33, 0x100000
    s_cbranch_scc1 L_po_row_x1
    v_mov_b32 v254, 56
    v_mov_b32 v255, s2
    v_add_u32 v255, 0x1000, v255
    buffer_store_dword v255, v254, s[20:23], 0 offen sc1
L_po_row_x1_ok:
    s_mov_b64 exec, s[64:65]
L_po_row_x1_done:
    s_barrier
    buffer_load_dwordx4 v[64:67], v2, s[8:11], s81 offen offset:0 sc1
    buffer_load_dwordx4 v[68:71], v2, s[8:11], s81 offen offset:1024 sc1
    buffer_load_dwordx4 v[72:75], v2, s[8:11], s81 offen offset:2048 sc1
    buffer_load_dwordx4 v[76:79], v2, s[8:11], s81 offen offset:3072 sc1
    s_add_u32 s81, s81, 4096
    buffer_load_dwordx4 v[80:83], v2, s[8:11], s81 offen offset:0 sc1
    buffer_load_dwordx4 v[84:87], v2, s[8:11], s81 offen offset:1024 sc1
    buffer_load_dwordx4 v[88:91], v2, s[8:11], s81 offen offset:2048 sc1
    buffer_load_dwordx4 v[92:95], v2, s[8:11], s81 offen offset:3072 sc1
    s_add_u32 s81, s81, 4096
    buffer_load_dwordx4 v[96:99], v2, s[8:11], s81 offen offset:0 sc1
    buffer_load_dwordx4 v[100:103], v2, s[8:11], s81 offen offset:1024 sc1
    buffer_load_dwordx4 v[104:107], v2, s[8:11], s81 offen offset:2048 sc1
    buffer_load_dwordx4 v[108:111], v2, s[8:11], s81 offen offset:3072 sc1
    ds_read_b128 v[224:227], v241 offset:61440
    ds_read_b128 v[228:231], v242 offset:36864
    ds_read_b128 v[232:235], v241 offset:62464
    ds_read_b128 v[236:239], v242 offset:37888
    s_waitcnt vmcnt(11) lgkmcnt(3)
    v_mfma_f32_32x32x16_bf16 v[16:31], v[224:227], v[64:67], 0
    s_add_u32 s81, s81, 4096
    buffer_load_dwordx4 v[112:115], v2, s[8:11], s81 offen offset:0 sc1
    s_waitcnt lgkmcnt(2)
    v_mfma_f32_32x32x16_bf16 v[32:47], v[228:231], v[64:67], 0
    ds_read_b128 v[224:227], v241 offset:63488
    ds_read_b128 v[228:231], v242 offset:38912
    s_waitcnt vmcnt(11) lgkmcnt(3)
    v_mfma_f32_32x32x16_bf16 v[16:31], v[232:235], v[68:71], v[16:31]
    buffer_load_dwordx4 v[116:119], v2, s[8:11], s81 offen offset:1024 sc1
    s_waitcnt lgkmcnt(2)
    v_mfma_f32_32x32x16_bf16 v[32:47], v[236:239], v[68:71], v[32:47]
    ds_read_b128 v[232:235], v241 offset:64512
    ds_read_b128 v[236:239], v242 offset:39936
    s_waitcnt vmcnt(11) lgkmcnt(3)
    v_mfma_f32_32x32x16_bf16 v[16:31], v[224:227], v[72:75], v[16:31]
    buffer_load_dwordx4 v[120:123], v2, s[8:11], s81 offen offset:2048 sc1
    buffer_load_dwordx2 v[50:51], v48, s[8:11], s95 offen offset:0 sc1
    s_waitcnt lgkmcnt(2)
    v_mfma_f32_32x32x16_bf16 v[32:47], v[228:231], v[72:75], v[32:47]
    ds_read_b128 v[224:227], v242 offset:0
    ds_read_b128 v[228:231], v242 offset:40960
    s_waitcnt vmcnt(12) lgkmcnt(3)
    v_mfma_f32_32x32x16_bf16 v[16:31], v[232:235], v[76:79], v[16:31]
    buffer_load_dwordx4 v[124:127], v2, s[8:11], s81 offen offset:3072 sc1
    buffer_load_dwordx2 v[52:53], v48, s[8:11], s95 offen offset:256 sc1
    s_waitcnt lgkmcnt(2)
    v_mfma_f32_32x32x16_bf16 v[32:47], v[236:239], v[76:79], v[32:47]
    ds_read_b128 v[232:235], v242 offset:1024
    ds_read_b128 v[236:239], v242 offset:41984
    s_waitcnt vmcnt(13) lgkmcnt(3)
    v_mfma_f32_32x32x16_bf16 v[16:31], v[224:227], v[80:83], v[16:31]
    s_add_u32 s81, s81, 4096
    buffer_load_dwordx4 v[128:131], v2, s[8:11], s81 offen offset:0 sc1
    buffer_load_dwordx2 v[54:55], v48, s[8:11], s95 offen offset:512 sc1
    s_waitcnt lgkmcnt(2)
    v_mfma_f32_32x32x16_bf16 v[32:47], v[228:231], v[80:83], v[32:47]
    ds_read_b128 v[224:227], v242 offset:2048
    ds_read_b128 v[228:231], v242 offset:43008
    s_waitcnt vmcnt(14) lgkmcnt(3)
    v_mfma_f32_32x32x16_bf16 v[16:31], v[232:235], v[84:87], v[16:31]
    buffer_load_dwordx4 v[132:135], v2, s[8:11], s81 offen offset:1024 sc1
    buffer_load_dwordx2 v[56:57], v48, s[8:11], s95 offen offset:768 sc1
    s_waitcnt lgkmcnt(2)
    v_mfma_f32_32x32x16_bf16 v[32:47], v[236:239], v[84:87], v[32:47]
    ds_read_b128 v[232:235], v242 offset:3072
    ds_read_b128 v[236:239], v242 offset:44032
    s_waitcnt vmcnt(15) lgkmcnt(3)
    v_mfma_f32_32x32x16_bf16 v[16:31], v[224:227], v[88:91], v[16:31]
    buffer_load_dwordx4 v[136:139], v2, s[8:11], s81 offen offset:2048 sc1
    buffer_load_dwordx4 v[248:251], v2, s[8:11], s92 offen offset:1024 sc1
    s_waitcnt lgkmcnt(2)
    v_mfma_f32_32x32x16_bf16 v[32:47], v[228:231], v[88:91], v[32:47]
    ds_read_b128 v[224:227], v242 offset:4096
    ds_read_b128 v[228:231], v242 offset:45056
    s_waitcnt vmcnt(16) lgkmcnt(3)
    v_mfma_f32_32x32x16_bf16 v[16:31], v[232:235], v[92:95], v[16:31]
    buffer_load_dwordx4 v[140:143], v2, s[8:11], s81 offen offset:3072 sc1
    buffer_load_dwordx2 v[60:61], v2, s[8:11], s92 offen offset:2048 sc1
    s_waitcnt lgkmcnt(2)
    v_mfma_f32_32x32x16_bf16 v[32:47], v[236:239], v[92:95], v[32:47]
    ds_read_b128 v[232:235], v242 offset:5120
    ds_read_b128 v[236:239], v242 offset:46080
    s_waitcnt vmcnt(17) lgkmcnt(3)
    v_mfma_f32_32x32x16_bf16 v[16:31], v[224:227], v[96:99], v[16:31]
    s_add_u32 s81, s81, 4096
    buffer_load_dwordx4 v[144:147], v2, s[8:11], s81 offen offset:0 sc1
    s_waitcnt lgkmcnt(2)
    v_mfma_f32_32x32x16_bf16 v[32:47], v[228:231], v[96:99], v[32:47]
    ds_read_b128 v[224:227], v242 offset:6144
    ds_read_b128 v[228:231], v242 offset:47104
    s_waitcnt vmcnt(17) lgkmcnt(3)
    v_mfma_f32_32x32x16_bf16 v[16:31], v[232:235], v[100:103], v[16:31]
    buffer_load_dwordx4 v[148:151], v2, s[8:11], s81 offen offset:1024 sc1
    s_waitcnt lgkmcnt(2)
    v_mfma_f32_32x32x16_bf16 v[32:47], v[236:239], v[100:103], v[32:47]
    ds_read_b128 v[232:235], v242 offset:7168
    ds_read_b128 v[236:239], v242 offset:48128
    s_waitcnt vmcnt(17) lgkmcnt(3)
    v_mfma_f32_32x32x16_bf16 v[16:31], v[224:227], v[104:107], v[16:31]
    buffer_load_dwordx4 v[152:155], v2, s[8:11], s81 offen offset:2048 sc1
    s_waitcnt lgkmcnt(2)
    v_mfma_f32_32x32x16_bf16 v[32:47], v[228:231], v[104:107], v[32:47]
    ds_read_b128 v[224:227], v242 offset:8192
    ds_read_b128 v[228:231], v242 offset:49152
    s_waitcnt vmcnt(17) lgkmcnt(3)
    v_mfma_f32_32x32x16_bf16 v[16:31], v[232:235], v[108:111], v[16:31]
    buffer_load_dwordx4 v[156:159], v2, s[8:11], s81 offen offset:3072 sc1
    s_waitcnt lgkmcnt(2)
    v_mfma_f32_32x32x16_bf16 v[32:47], v[236:239], v[108:111], v[32:47]
    ds_read_b128 v[232:235], v242 offset:9216
    ds_read_b128 v[236:239], v242 offset:50176
    s_waitcnt vmcnt(17) lgkmcnt(3)
    v_mfma_f32_32x32x16_bf16 v[16:31], v[224:227], v[112:115], v[16:31]
    s_add_u32 s81, s81, 4096
    buffer_load_dwordx4 v[160:163], v2, s[8:11], s81 offen offset:0 sc1
    s_waitcnt lgkmcnt(2)
    v_mfma_f32_32x32x16_bf16 v[32:47], v[228:231], v[112:115], v[32:47]
    ds_read_b128 v[224:227], v242 offset:10240
    ds_read_b128 v[228:231], v242 offset:51200
    s_waitcnt vmcnt(17) lgkmcnt(3)
    v_mfma_f32_32x32x16_bf16 v[16:31], v[232:235], v[116:119], v[16:31]
    buffer_load_dwordx4 v[164:167], v2, s[8:11], s81 offen offset:1024 sc1
    s_waitcnt lgkmcnt(2)
    v_mfma_f32_32x32x16_bf16 v[32:47], v[236:239], v[116:119], v[32:47]
    ds_read_b128 v[232:235], v242 offset:11264
    ds_read_b128 v[236:239], v242 offset:52224
    s_waitcnt vmcnt(17) lgkmcnt(3)
    v_mfma_f32_32x32x16_bf16 v[16:31], v[224:227], v[120:123], v[16:31]
    buffer_load_dwordx4 v[168:171], v2, s[8:11], s81 offen offset:2048 sc1
    s_waitcnt lgkmcnt(2)
    v_mfma_f32_32x32x16_bf16 v[32:47], v[228:231], v[120:123], v[32:47]
    ds_read_b128 v[224:227], v242 offset:12288
    ds_read_b128 v[228:231], v242 offset:53248
    s_waitcnt vmcnt(16) lgkmcnt(3)
    v_mfma_f32_32x32x16_bf16 v[16:31], v[232:235], v[124:127], v[16:31]
    buffer_load_dwordx4 v[172:175], v2, s[8:11], s81 offen offset:3072 sc1
    s_waitcnt lgkmcnt(2)
    v_mfma_f32_32x32x16_bf16 v[32:47], v[236:239], v[124:127], v[32:47]
    ds_read_b128 v[232:235], v242 offset:13312
    ds_read_b128 v[236:239], v242 offset:54272
    s_waitcnt vmcnt(15) lgkmcnt(3)
    v_mfma_f32_32x32x16_bf16 v[16:31], v[224:227], v[128:131], v[16:31]
    s_add_u32 s81, s81, 4096
    buffer_load_dwordx4 v[176:179], v2, s[8:11], s81 offen offset:0 sc1
    s_waitcnt lgkmcnt(2)
    v_mfma_f32_32x32x16_bf16 v[32:47], v[228:231], v[128:131], v[32:47]
    ds_read_b128 v[224:227], v242 offset:14336
    ds_read_b128 v[228:231], v242 offset:55296
    s_waitcnt vmcnt(14) lgkmcnt(3)
    v_mfma_f32_32x32x16_bf16 v[16:31], v[232:235], v[132:135], v[16:31]
    buffer_load_dwordx4 v[180:183], v2, s[8:11], s81 offen offset:1024 sc1
    s_waitcnt lgkmcnt(2)
    v_mfma_f32_32x32x16_bf16 v[32:47], v[236:239], v[132:135], v[32:47]
    ds_read_b128 v[232:235], v242 offset:15360
    ds_read_b128 v[236:239], v242 offset:56320
    s_waitcnt vmcnt(13) lgkmcnt(3)
    v_mfma_f32_32x32x16_bf16 v[16:31], v[224:227], v[136:139], v[16:31]
    buffer_load_dwordx4 v[184:187], v2, s[8:11], s81 offen offset:2048 sc1
    s_waitcnt lgkmcnt(2)
    v_mfma_f32_32x32x16_bf16 v[32:47], v[228:231], v[136:139], v[32:47]
    ds_read_b128 v[224:227], v242 offset:16384
    ds_read_b128 v[228:231], v242 offset:57344
    s_waitcnt vmcnt(12) lgkmcnt(3)
    v_mfma_f32_32x32x16_bf16 v[16:31], v[232:235], v[140:143], v[16:31]
    buffer_load_dwordx4 v[188:191], v2, s[8:11], s81 offen offset:3072 sc1
    s_waitcnt lgkmcnt(2)
    v_mfma_f32_32x32x16_bf16 v[32:47], v[236:239], v[140:143], v[32:47]
    ds_read_b128 v[232:235], v242 offset:17408
    ds_read_b128 v[236:239], v242 offset:58368
    s_waitcnt vmcnt(11) lgkmcnt(3)
    v_mfma_f32_32x32x16_bf16 v[16:31], v[224:227], v[144:147], v[16:31]
    s_add_u32 s81, s81, 4096
    buffer_load_dwordx4 v[192:195], v2, s[8:11], s81 offen offset:0 sc1
    s_waitcnt lgkmcnt(2)
    v_mfma_f32_32x32x16_bf16 v[32:47], v[228:231], v[144:147], v[32:47]
    ds_read_b128 v[224:227], v242 offset:18432
    ds_read_b128 v[228:231], v242 offset:59392
    s_waitcnt vmcnt(11) lgkmcnt(3)
    v_mfma_f32_32x32x16_bf16 v[16:31], v[232:235], v[148:151], v[16:31]
    buffer_load_dwordx4 v[196:199], v2, s[8:11], s81 offen offset:1024 sc1
    s_waitcnt lgkmcnt(2)
    v_mfma_f32_32x32x16_bf16 v[32:47], v[236:239], v[148:151], v[32:47]
    ds_read_b128 v[232:235], v242 offset:19456
    ds_read_b128 v[236:239], v242 offset:60416
    s_waitcnt vmcnt(11) lgkmcnt(3)
    v_mfma_f32_32x32x16_bf16 v[16:31], v[224:227], v[152:155], v[16:31]
    buffer_load_dwordx4 v[200:203], v2, s[8:11], s81 offen offset:2048 sc1
    s_waitcnt lgkmcnt(2)
    v_mfma_f32_32x32x16_bf16 v[32:47], v[228:231], v[152:155], v[32:47]
    ds_read_b128 v[224:227], v242 offset:20480
    ds_read_b128 v[228:231], v242 offset:61440
    s_waitcnt vmcnt(11) lgkmcnt(3)
    v_mfma_f32_32x32x16_bf16 v[16:31], v[232:235], v[156:159], v[16:31]
    buffer_load_dwordx4 v[204:207], v2, s[8:11], s81 offen offset:3072 sc1
    s_waitcnt lgkmcnt(2)
    v_mfma_f32_32x32x16_bf16 v[32:47], v[236:239], v[156:159], v[32:47]
    ds_read_b128 v[232:235], v242 offset:21504
    ds_read_b128 v[236:239], v242 offset:62464
    s_waitcnt vmcnt(11) lgkmcnt(3)
    v_mfma_f32_32x32x16_bf16 v[16:31], v[224:227], v[160:163], v[16:31]
    s_add_u32 s81, s81, 4096
    buffer_load_dwordx4 v[208:211], v2, s[8:11], s81 offen offset:0 sc1
    s_waitcnt lgkmcnt(2)
    v_mfma_f32_32x32x16_bf16 v[32:47], v[228:231], v[160:163], v[32:47]
    ds_read_b128 v[224:227], v242 offset:22528
    ds_read_b128 v[228:231], v242 offset:63488
    s_waitcnt vmcnt(11) lgkmcnt(3)
    v_mfma_f32_32x32x16_bf16 v[16:31], v[232:235], v[164:167], v[16:31]
    buffer_load_dwordx4 v[212:215], v2, s[8:11], s81 offen offset:1024 sc1
    s_waitcnt lgkmcnt(2)
    v_mfma_f32_32x32x16_bf16 v[32:47], v[236:239], v[164:167], v[32:47]
    ds_read_b128 v[232:235], v242 offset:23552
    ds_read_b128 v[236:239], v242 offset:64512
    s_waitcnt vmcnt(11) lgkmcnt(3)
    v_mfma_f32_32x32x16_bf16 v[16:31], v[224:227], v[168:171], v[16:31]
    buffer_load_dwordx4 v[216:219], v2, s[8:11], s81 offen offset:2048 sc1
    s_waitcnt lgkmcnt(2)
    v_mfma_f32_32x32x16_bf16 v[32:47], v[228:231], v[168:171], v[32:47]
    ds_read_b128 v[224:227], v242 offset:24576
    ds_read_b128 v[228:231], v243 offset:0
    s_waitcnt vmcnt(11) lgkmcnt(3)
    v_mfma_f32_32x32x16_bf16 v[16:31], v[232:235], v[172:175], v[16:31]
    buffer_load_dwordx4 v[220:223], v2, s[8:11], s81 offen offset:3072 sc1
    s_waitcnt lgkmcnt(2)
    v_mfma_f32_32x32x16_bf16 v[32:47], v[236:239], v[172:175], v[32:47]
    ds_read_b128 v[232:235], v242 offset:25600
    ds_read_b128 v[236:239], v243 offset:1024
    s_waitcnt vmcnt(11) lgkmcnt(3)
    v_mfma_f32_32x32x16_bf16 v[16:31], v[224:227], v[176:179], v[16:31]
    s_sub_u32 s32, s24, 0
    s_mul_i32 s32, s32, 5120
    s_add_u32 s93, s32, s91
    s_add_u32 s93, s93, 102400
    s_add_u32 s94, s32, 0
    s_mov_b32 m0, s94
    s_waitcnt lgkmcnt(2)
    v_mfma_f32_32x32x16_bf16 v[32:47], v[228:231], v[176:179], v[32:47]
    ds_read_b128 v[224:227], v242 offset:26624
    ds_read_b128 v[228:231], v243 offset:2048
    s_waitcnt vmcnt(10) lgkmcnt(3)
    v_mfma_f32_32x32x16_bf16 v[16:31], v[232:235], v[180:183], v[16:31]
    buffer_load_dwordx4 v2, s[8:11], s93 offen offset:0 lds
    v_add_f32 v48, v50, v52
    v_add_f32 v49, v51, v53
    v_add_f32 v50, v54, v56
    s_waitcnt lgkmcnt(2)
    v_mfma_f32_32x32x16_bf16 v[32:47], v[236:239], v[180:183], v[32:47]
    ds_read_b128 v[232:235], v242 offset:27648
    ds_read_b128 v[236:239], v243 offset:3072
    s_waitcnt vmcnt(10) lgkmcnt(3)
    v_mfma_f32_32x32x16_bf16 v[16:31], v[224:227], v[184:187], v[16:31]
    buffer_load_dwordx4 v2, s[8:11], s93 offen offset:1024 lds
    v_add_f32 v51, v55, v57
    v_add_f32 v48, v48, v50
    v_add_f32 v49, v49, v51
    s_waitcnt lgkmcnt(2)
    v_mfma_f32_32x32x16_bf16 v[32:47], v[228:231], v[184:187], v[32:47]
    ds_read_b128 v[224:227], v242 offset:28672
    ds_read_b128 v[228:231], v243 offset:4096
    s_waitcnt vmcnt(10) lgkmcnt(3)
    v_mfma_f32_32x32x16_bf16 v[16:31], v[232:235], v[188:191], v[16:31]
    buffer_load_dwordx4 v2, s[8:11], s93 offen offset:2048 lds
    v_mov_b32 v50, v48
    v_mov_b32 v51, v49
    s_nop 0
    v_permlane32_swap_b32 v48, v50
    v_permlane32_swap_b32 v49, v51
    s_waitcnt lgkmcnt(2)
    v_mfma_f32_32x32x16_bf16 v[32:47], v[236:239], v[188:191], v[32:47]
    ds_read_b128 v[232:235], v242 offset:29696
    ds_read_b128 v[236:239], v243 offset:5120
    s_waitcnt vmcnt(10) lgkmcnt(3)
    v_mfma_f32_32x32x16_bf16 v[16:31], v[224:227], v[192:195], v[16:31]
    buffer_load_dwordx4 v2, s[8:11], s93 offen offset:3072 lds
    v_add_f32 v48, v48, v50
    v_add_f32 v49, v49, v51
    v_mul_f32 v48, 0x3acccccd, v48
    s_waitcnt lgkmcnt(2)
    v_mfma_f32_32x32x16_bf16 v[32:47], v[228:231], v[192:195], v[32:47]
    ds_read_b128 v[224:227], v242 offset:30720
    ds_read_b128 v[228:231], v243 offset:6144
    s_waitcnt vmcnt(10) lgkmcnt(3)
    v_mfma_f32_32x32x16_bf16 v[16:31], v[232:235], v[196:199], v[16:31]
    s_add_u32 s94, s94, 4096
    s_mov_b32 m0, s94
    s_add_u32 s93, s93, 4096
    buffer_load_dwordx4 v2, s[8:11], s93 offen offset:0 lds
    v_mul_f32 v49, 0x3acccccd, v49
    v_fma_f32 v49, -v48, v48, v49
    v_max_f32 v49, 0, v49
    s_waitcnt lgkmcnt(2)
    v_mfma_f32_32x32x16_bf16 v[32:47], v[236:239], v[196:199], v[32:47]
    ds_read_b128 v[232:235], v242 offset:31744
    ds_read_b128 v[236:239], v243 offset:7168
    s_waitcnt vmcnt(10) lgkmcnt(3)
    v_mfma_f32_32x32x16_bf16 v[16:31], v[224:227], v[200:203], v[16:31]
    v_add_f32 v50, 0x3727c5ac, v49
    v_rsq_f32 v240, v50
    s_nop 0
    v_mul_f32 v50, v240, v240
    v_mul_f32 v50, v50, v49
    s_waitcnt lgkmcnt(2)
    v_mfma_f32_32x32x16_bf16 v[32:47], v[228:231], v[200:203], v[32:47]
    ds_read_b128 v[224:227], v242 offset:32768
    ds_read_b128 v[228:231], v243 offset:8192
    s_waitcnt vmcnt(9) lgkmcnt(3)
    v_mfma_f32_32x32x16_bf16 v[16:31], v[232:235], v[204:207], v[16:31]
    v_add_f32 v50, 0x3727c5ac, v50
    v_rsq_f32 v50, v50
    s_nop 0
    v_mul_f32 v240, v240, v50
    s_waitcnt lgkmcnt(2)
    v_mfma_f32_32x32x16_bf16 v[32:47], v[236:239], v[204:207], v[32:47]
    ds_read_b128 v[232:235], v242 offset:33792
    ds_read_b128 v[236:239], v243 offset:9216
    s_waitcnt vmcnt(8) lgkmcnt(3)
    v_mfma_f32_32x32x16_bf16 v[16:31], v[224:227], v[208:211], v[16:31]
    v_rcp_f32 v51, v240
    s_nop 0
    v_cvt_pk_bf16_f32 v52, v51, v51
    v_and_b32 v52, 0xffff0000, v52
    s_waitcnt lgkmcnt(2)
    v_mfma_f32_32x32x16_bf16 v[32:47], v[228:231], v[208:211], v[32:47]
    ds_read_b128 v[224:227], v242 offset:34816
    ds_read_b128 v[228:231], v243 offset:10240
    s_waitcnt vmcnt(7) lgkmcnt(3)
    v_mfma_f32_32x32x16_bf16 v[16:31], v[232:235], v[212:215], v[16:31]
    v_sub_f32 v52, v51, v52
    v_cvt_pk_bf16_f32 v246, v51, v52
    v_cndmask_b32 v246, 0, v246, s[66:67]
    v_sub_f32 v48, 0, v48
    s_waitcnt lgkmcnt(2)
    v_mfma_f32_32x32x16_bf16 v[32:47], v[236:239], v[212:215], v[32:47]
    ds_read_b128 v[232:235], v242 offset:35840
    ds_read_b128 v[236:239], v243 offset:11264
    s_waitcnt vmcnt(6) lgkmcnt(3)
    v_mfma_f32_32x32x16_bf16 v[16:31], v[224:227], v[216:219], v[16:31]
    v_cvt_pk_bf16_f32 v244, v48, v48
    v_and_b32 v52, 0xffff0000, v244
    v_sub_f32 v52, v48, v52
    s_waitcnt lgkmcnt(2)
    v_mfma_f32_32x32x16_bf16 v[32:47], v[228:231], v[216:219], v[32:47]
    s_waitcnt vmcnt(5) lgkmcnt(1)
    v_mfma_f32_32x32x16_bf16 v[16:31], v[232:235], v[220:223], v[16:31]
    v_cvt_pk_bf16_f32 v245, v52, v52
    v_cndmask_b32 v244, 0, v244, s[66:67]
    v_cndmask_b32 v245, 0, v245, s[66:67]
    v_mov_b32 v247, 0
    s_waitcnt lgkmcnt(0)
    v_mfma_f32_32x32x16_bf16 v[32:47], v[236:239], v[220:223], v[32:47]
    v_mov_b32 v252, v248
    v_mov_b32 v253, v248
    v_mov_b32 v254, v60
    v_mov_b32 v255, 0
    s_nop 1
    v_mfma_f32_32x32x16_bf16 v[16:31], v[252:255], v[244:247], v[16:31]
    v_mov_b32 v252, v249
    v_mov_b32 v253, v249
    v_mov_b32 v254, v61
    v_mov_b32 v255, 0
    s_nop 1
    v_mfma_f32_32x32x16_bf16 v[32:47], v[252:255], v[244:247], v[32:47]
    s_lshl_b32 s32, s25, 2
    s_add_u32 s32, s32, s24
    s_lshl_b32 s32, s32, 1
    s_mul_i32 s32, s32, 48
    s_mul_i32 s33, s26, 3
    s_add_u32 s32, s32, s33
    s_lshl_b32 s32, s32, 10
    s_mul_i32 s33, s29, 0
    s_add_u32 s32, s32, s33
    s_add_u32 s72, s32, 25165824
    v_lshrrev_b32 v0, 4, v3
    v_mul_u32_u24 v0, 49152, v0
    v_and_b32 v236, 15, v3
    v_lshlrev_b32 v237, 4, v4
    v_add_u32 v236, v236, v237
    v_lshlrev_b32 v236, 4, v236
    v_add_u32 v0, v0, v236
    s_cmp_eq_u32 s29, 0
    s_cbranch_scc0 L_dl_p4B_1
    ds_read_b128 v[224:227], v243 offset:12288
    ds_read_b128 v[228:231], v243 offset:13312
    ds_read_b128 v[232:235], v243 offset:14336
    v_mov_b32 v252, v250
    v_mov_b32 v253, v250
    v_mov_b32 v254, v251
    v_mov_b32 v255, 0
    s_nop 1
    v_mfma_f32_32x32x16_bf16 v[48:63], v[252:255], v[244:247], 0
    v_mul_f32 v5, 0xc0135761, v240
    v_mul_f32 v251, v240, v240
    v_mul_f32 v251, v251, v240
    v_mul_f32 v251, 0xbdd2d3e8, v251
    v_rcp_f32 v250, v240
    s_waitcnt lgkmcnt(2)
    v_mfma_f32_32x32x16_bf16 v[48:63], v[224:227], v[64:67], v[48:63]
    s_add_u32 s83, s82, 40960
    buffer_load_dwordx4 a[160:163], v2, s[8:11], s83 offen
    ds_read_b128 v[224:227], v243 offset:15360
    v_mul_f32 v236, v16, v16
    v_mul_f32 v237, v17, v17
    v_mul_f32 v238, v18, v18
    v_mul_f32 v239, v19, v19
    v_fma_f32 v236, v236, v251, v5
    v_fma_f32 v237, v237, v251, v5
    s_waitcnt lgkmcnt(2)
    v_mfma_f32_32x32x16_bf16 v[48:63], v[228:231], v[68:71], v[48:63]
    ds_read_b128 v[228:231], v243 offset:16384
    v_fma_f32 v238, v238, v251, v5
    v_fma_f32 v239, v239, v251, v5
    v_mul_f32 v236, v236, v16
    v_mul_f32 v237, v237, v17
    v_mul_f32 v238, v238, v18
    v_mul_f32 v239, v239, v19
    s_waitcnt lgkmcnt(2)
    v_mfma_f32_32x32x16_bf16 v[48:63], v[232:235], v[72:75], v[48:63]
    s_add_u32 s83, s82, 41984
    buffer_load_dwordx4 a[164:167], v2, s[8:11], s83 offen
    ds_read_b128 v[232:235], v243 offset:17408
    v_exp_f32 v236, v236
    v_exp_f32 v237, v237
    v_exp_f32 v238, v238
    v_exp_f32 v239, v239
    v_fma_f32 v236, v236, v250, v250
    v_fma_f32 v237, v237, v250, v250
    s_waitcnt lgkmcnt(2)
    v_mfma_f32_32x32x16_bf16 v[48:63], v[224:227], v[76:79], v[48:63]
    ds_read_b128 v[224:227], v243 offset:18432
    v_fma_f32 v238, v238, v250, v250
    v_fma_f32 v239, v239, v250, v250
    v_rcp_f32 v236, v236
    v_rcp_f32 v237, v237
    v_rcp_f32 v238, v238
    v_rcp_f32 v239, v239
    s_waitcnt lgkmcnt(2)
    v_mfma_f32_32x32x16_bf16 v[48:63], v[228:231], v[80:83], v[48:63]
    s_add_u32 s83, s82, 43008
    buffer_load_dwordx4 a[168:171], v2, s[8:11], s83 offen
    ds_read_b128 v[228:231], v243 offset:19456
    v_mul_f32 v16, v16, v236
    v_mul_f32 v17, v17, v237
    v_mul_f32 v18, v18, v238
    v_mul_f32 v19, v19, v239
    v_mul_f32 v236, v20, v20
    v_mul_f32 v237, v21, v21
    s_waitcnt lgkmcnt(2)
    v_mfma_f32_32x32x16_bf16 v[48:63], v[232:235], v[84:87], v[48:63]
    ds_read_b128 v[232:235], v243 offset:20480
    v_mul_f32 v238, v22, v22
    v_mul_f32 v239, v23, v23
    v_fma_f32 v236, v236, v251, v5
    v_fma_f32 v237, v237, v251, v5
    v_fma_f32 v238, v238, v251, v5
    v_fma_f32 v239, v239, v251, v5
    s_waitcnt lgkmcnt(2)
    v_mfma_f32_32x32x16_bf16 v[48:63], v[224:227], v[88:91], v[48:63]
    s_add_u32 s83, s82, 44032
    buffer_load_dwordx4 a[172:175], v2, s[8:11], s83 offen
    ds_read_b128 v[224:227], v243 offset:21504
    v_mul_f32 v236, v236, v20
    v_mul_f32 v237, v237, v21
    v_mul_f32 v238, v238, v22
    v_mul_f32 v239, v239, v23
    v_exp_f32 v236, v236
    v_exp_f32 v237, v237
    s_waitcnt lgkmcnt(2)
    v_mfma_f32_32x32x16_bf16 v[48:63], v[228:231], v[92:95], v[48:63]
    ds_read_b128 v[228:231], v243 offset:22528
    v_exp_f32 v238, v238
    v_exp_f32 v239, v239
    v_fma_f32 v236, v236, v250, v250
    v_fma_f32 v237, v237, v250, v250
    v_fma_f32 v238, v238, v250, v250
    v_fma_f32 v239, v239, v250, v250
    s_waitcnt lgkmcnt(2)
    v_mfma_f32_32x32x16_bf16 v[48:63], v[232:235], v[96:99], v[48:63]
    s_add_u32 s83, s82, 45056
    buffer_load_dwordx4 a[176:179], v2, s[8:11], s83 offen
    ds_read_b128 v[232:235], v243 offset:23552
    v_rcp_f32 v236, v236
    v_rcp_f32 v237, v237
    v_rcp_f32 v238, v238
    v_rcp_f32 v239, v239
    v_mul_f32 v20, v20, v236
    v_mul_f32 v21, v21, v237
    s_waitcnt lgkmcnt(2)
    v_mfma_f32_32x32x16_bf16 v[48:63], v[224:227], v[100:103], v[48:63]
    ds_read_b128 v[224:227], v243 offset:24576
    v_mul_f32 v22, v22, v238
    v_mul_f32 v23, v23, v239
    v_mul_f32 v236, v24, v24
    v_mul_f32 v237, v25, v25
    v_mul_f32 v238, v26, v26
    v_mul_f32 v239, v27, v27
    s_waitcnt lgkmcnt(2)
    v_mfma_f32_32x32x16_bf16 v[48:63], v[228:231], v[104:107], v[48:63]
    s_add_u32 s83, s82, 46080
    buffer_load_dwordx4 a[180:183], v2, s[8:11], s83 offen
    ds_read_b128 v[228:231], v243 offset:25600
    v_fma_f32 v236, v236, v251, v5
    v_fma_f32 v237, v237, v251, v5
    v_fma_f32 v238, v238, v251, v5
    v_fma_f32 v239, v239, v251, v5
    v_mul_f32 v236, v236, v24
    v_mul_f32 v237, v237, v25
    s_waitcnt lgkmcnt(2)
    v_mfma_f32_32x32x16_bf16 v[48:63], v[232:235], v[108:111], v[48:63]
    ds_read_b128 v[232:235], v243 offset:26624
    v_mul_f32 v238, v238, v26
    v_mul_f32 v239, v239, v27
    v_exp_f32 v236, v236
    v_exp_f32 v237, v237
    v_exp_f32 v238, v238
    v_exp_f32 v239, v239
    s_waitcnt lgkmcnt(2)
    v_mfma_f32_32x32x16_bf16 v[48:63], v[224:227], v[112:115], v[48:63]
    s_add_u32 s83, s82, 47104
    buffer_load_dwordx4 a[184:187], v2, s[8:11], s83 offen
    ds_read_b128 v[224:227], v243 offset:27648
    v_fma_f32 v236, v236, v250, v250
    v_fma_f32 v237, v237, v250, v250
    v_fma_f32 v238, v238, v250, v250
    v_fma_f32 v239, v239, v250, v250
    v_rcp_f32 v236, v236
    v_rcp_f32 v237, v237
    s_waitcnt lgkmcnt(2)
    v_mfma_f32_32x32x16_bf16 v[48:63], v[228:231], v[116:119], v[48:63]
    ds_read_b128 v[228:231], v243 offset:28672
    v_rcp_f32 v238, v238
    v_rcp_f32 v239, v239
    v_mul_f32 v24, v24, v236
    v_mul_f32 v25, v25, v237
    v_mul_f32 v26, v26, v238
    v_mul_f32 v27, v27, v239
    s_waitcnt lgkmcnt(2)
    v_mfma_f32_32x32x16_bf16 v[48:63], v[232:235], v[120:123], v[48:63]
    s_add_u32 s83, s82, 48128
    buffer_load_dwordx4 a[188:191], v2, s[8:11], s83 offen
    ds_read_b128 v[232:235], v243 offset:29696
    v_mul_f32 v236, v28, v28
    v_mul_f32 v237, v29, v29
    v_mul_f32 v238, v30, v30
    v_mul_f32 v239, v31, v31
    v_fma_f32 v236, v236, v251, v5
    v_fma_f32 v237, v237, v251, v5
    s_waitcnt lgkmcnt(2)
    v_mfma_f32_32x32x16_bf16 v[48:63], v[224:227], v[124:127], v[48:63]
    ds_read_b128 v[224:227], v243 offset:30720
    v_fma_f32 v238, v238, v251, v5
    v_fma_f32 v239, v239, v251, v5
    v_mul_f32 v236, v236, v28
    v_mul_f32 v237, v237, v29
    v_mul_f32 v238, v238, v30
    v_mul_f32 v239, v239, v31
    s_waitcnt lgkmcnt(2)
    v_mfma_f32_32x32x16_bf16 v[48:63], v[228:231], v[128:131], v[48:63]
    s_waitcnt vmcnt(8)
    s_barrier
    s_add_u32 s83, s82, 49152
    buffer_load_dwordx4 a[192:195], v2, s[8:11], s83 offen
    ds_read_b128 v[228:231], v243 offset:31744
    v_exp_f32 v236, v236
    v_exp_f32 v237, v237
    v_exp_f32 v238, v238
    v_exp_f32 v239, v239
    v_fma_f32 v236, v236, v250, v250
    v_fma_f32 v237, v237, v250, v250
    s_waitcnt lgkmcnt(2)
    v_mfma_f32_32x32x16_bf16 v[48:63], v[232:235], v[132:135], v[48:63]
    ds_read_b128 v[232:235], v241 offset:0
    v_fma_f32 v238, v238, v250, v250
    v_fma_f32 v239, v239, v250, v250
    v_rcp_f32 v236, v236
    v_rcp_f32 v237, v237
    v_rcp_f32 v238, v238
    v_rcp_f32 v239, v239
    s_waitcnt lgkmcnt(2)
    v_mfma_f32_32x32x16_bf16 v[48:63], v[224:227], v[136:139], v[48:63]
    s_add_u32 s83, s82, 50176
    buffer_load_dwordx4 a[196:199], v2, s[8:11], s83 offen
    ds_read_b128 v[224:227], v241 offset:1024
    v_mul_f32 v28, v28, v236
    v_mul_f32 v29, v29, v237
    v_mul_f32 v30, v30, v238
    v_mul_f32 v31, v31, v239
    v_cvt_pk_bf16_f32 v16, v16, v17
    v_cvt_pk_bf16_f32 v17, v18, v19
    s_waitcnt lgkmcnt(2)
    v_mfma_f32_32x32x16_bf16 v[48:63], v[228:231], v[140:143], v[48:63]
    ds_read_b128 v[228:231], v241 offset:2048
    v_cvt_pk_bf16_f32 v18, v20, v21
    v_cvt_pk_bf16_f32 v19, v22, v23
    v_cvt_pk_bf16_f32 v20, v24, v25
    v_cvt_pk_bf16_f32 v21, v26, v27
    v_cvt_pk_bf16_f32 v22, v28, v29
    v_cvt_pk_bf16_f32 v23, v30, v31
    buffer_store_dwordx4 v[16:19], v0, s[8:11], s72 offen offset:0 sc1
    buffer_store_dwordx4 v[20:23], v0, s[8:11], s72 offen offset:512 sc1
    s_waitcnt lgkmcnt(2)
    v_mfma_f32_32x32x16_bf16 v[48:63], v[232:235], v[144:147], v[48:63]
    s_add_u32 s83, s82, 51200
    buffer_load_dwordx4 a[200:203], v2, s[8:11], s83 offen
    ds_read_b128 v[232:235], v241 offset:3072
    v_mul_f32 v236, v32, v32
    v_mul_f32 v237, v33, v33
    v_mul_f32 v238, v34, v34
    v_mul_f32 v239, v35, v35
    v_fma_f32 v236, v236, v251, v5
    v_fma_f32 v237, v237, v251, v5
    s_waitcnt lgkmcnt(2)
    v_mfma_f32_32x32x16_bf16 v[48:63], v[224:227], v[148:151], v[48:63]
    ds_read_b128 v[224:227], v241 offset:4096
    v_fma_f32 v238, v238, v251, v5
    v_fma_f32 v239, v239, v251, v5
    v_mul_f32 v236, v236, v32
    v_mul_f32 v237, v237, v33
    v_mul_f32 v238, v238, v34
    v_mul_f32 v239, v239, v35
    s_waitcnt lgkmcnt(2)
    v_mfma_f32_32x32x16_bf16 v[48:63], v[228:231], v[152:155], v[48:63]
    s_add_u32 s83, s82, 52224
    buffer_load_dwordx4 a[204:207], v2, s[8:11], s83 offen
    ds_read_b128 v[228:231], v241 offset:5120
    v_exp_f32 v236, v236
    v_exp_f32 v237, v237
    v_exp_f32 v238, v238
    v_exp_f32 v239, v239
    v_fma_f32 v236, v236, v250, v250
    v_fma_f32 v237, v237, v250, v250
    s_waitcnt lgkmcnt(2)
    v_mfma_f32_32x32x16_bf16 v[48:63], v[232:235], v[156:159], v[48:63]
    ds_read_b128 v[232:235], v241 offset:6144
    v_fma_f32 v238, v238, v250, v250
    v_fma_f32 v239, v239, v250, v250
    v_rcp_f32 v236, v236
    v_rcp_f32 v237, v237
    v_rcp_f32 v238, v238
    v_rcp_f32 v239, v239
    s_waitcnt lgkmcnt(2)
    v_mfma_f32_32x32x16_bf16 v[48:63], v[224:227], v[160:163], v[48:63]
    s_add_u32 s83, s82, 53248
    buffer_load_dwordx4 a[208:211], v2, s[8:11], s83 offen
    ds_read_b128 v[224:227], v241 offset:7168
    v_mul_f32 v32, v32, v236
    v_mul_f32 v33, v33, v237
    v_mul_f32 v34, v34, v238
    v_mul_f32 v35, v35, v239
    v_mul_f32 v236, v36, v36
    v_mul_f32 v237, v37, v37
    s_waitcnt lgkmcnt(2)
    v_mfma_f32_32x32x16_bf16 v[48:63], v[228:231], v[164:167], v[48:63]
    ds_read_b128 v[228:231], v241 offset:8192
    v_mul_f32 v238, v38, v38
    v_mul_f32 v239, v39, v39
    v_fma_f32 v236, v236, v251, v5
    v_fma_f32 v237, v237, v251, v5
    v_fma_f32 v238, v238, v251, v5
    v_fma_f32 v239, v239, v251, v5
    s_waitcnt lgkmcnt(2)
    v_mfma_f32_32x32x16_bf16 v[48:63], v[232:235], v[168:171], v[48:63]
    s_add_u32 s83, s82, 54272
    buffer_load_dwordx4 a[212:215], v2, s[8:11], s83 offen
    ds_read_b128 v[232:235], v241 offset:9216
    v_mul_f32 v236, v236, v36
    v_mul_f32 v237, v237, v37
    v_mul_f32 v238, v238, v38
    v_mul_f32 v239, v239, v39
    v_exp_f32 v236, v236
    v_exp_f32 v237, v237
    s_waitcnt lgkmcnt(2)
    v_mfma_f32_32x32x16_bf16 v[48:63], v[224:227], v[172:175], v[48:63]
    ds_read_b128 v[224:227], v241 offset:10240
    v_exp_f32 v238, v238
    v_exp_f32 v239, v239
    v_fma_f32 v236, v236, v250, v250
    v_fma_f32 v237, v237, v250, v250
    v_fma_f32 v238, v238, v250, v250
    v_fma_f32 v239, v239, v250, v250
    s_waitcnt lgkmcnt(2)
    v_mfma_f32_32x32x16_bf16 v[48:63], v[228:231], v[176:179], v[48:63]
    s_add_u32 s83, s82, 55296
    buffer_load_dwordx4 a[216:219], v2, s[8:11], s83 offen
    ds_read_b128 v[228:231], v241 offset:11264
    v_rcp_f32 v236, v236
    v_rcp_f32 v237, v237
    v_rcp_f32 v238, v238
    v_rcp_f32 v239, v239
    v_mul_f32 v36, v36, v236
    v_mul_f32 v37, v37, v237
    s_waitcnt lgkmcnt(2)
    v_mfma_f32_32x32x16_bf16 v[48:63], v[232:235], v[180:183], v[48:63]
    ds_read_b128 v[232:235], v241 offset:12288
    v_mul_f32 v38, v38, v238
    v_mul_f32 v39, v39, v239
    v_mul_f32 v236, v40, v40
    v_mul_f32 v237, v41, v41
    v_mul_f32 v238, v42, v42
    v_mul_f32 v239, v43, v43
    s_waitcnt lgkmcnt(2)
    v_mfma_f32_32x32x16_bf16 v[48:63], v[224:227], v[184:187], v[48:63]
    s_add_u32 s83, s82, 56320
    buffer_load_dwordx4 a[220:223], v2, s[8:11], s83 offen
    ds_read_b128 v[224:227], v241 offset:13312
    v_fma_f32 v236, v236, v251, v5
    v_fma_f32 v237, v237, v251, v5
    v_fma_f32 v238, v238, v251, v5
    v_fma_f32 v239, v239, v251, v5
    v_mul_f32 v236, v236, v40
    v_mul_f32 v237, v237, v41
    s_waitcnt lgkmcnt(2)
    v_mfma_f32_32x32x16_bf16 v[48:63], v[228:231], v[188:191], v[48:63]
    ds_read_b128 v[228:231], v241 offset:14336
    v_mul_f32 v238, v238, v42
    v_mul_f32 v239, v239, v43
    v_exp_f32 v236, v236
    v_exp_f32 v237, v237
    v_exp_f32 v238, v238
    v_exp_f32 v239, v239
    s_waitcnt lgkmcnt(2)
    v_mfma_f32_32x32x16_bf16 v[48:63], v[232:235], v[192:195], v[48:63]
    s_add_u32 s83, s82, 57344
    buffer_load_dwordx4 a[224:227], v2, s[8:11], s83 offen
    ds_read_b128 v[232:235], v241 offset:15360
    v_fma_f32 v236, v236, v250, v250
    v_fma_f32 v237, v237, v250, v250
    v_fma_f32 v238, v238, v250, v250
    v_fma_f32 v239, v239, v250, v250
    v_rcp_f32 v236, v236
    v_rcp_f32 v237, v237
    s_waitcnt lgkmcnt(2)
    v_mfma_f32_32x32x16_bf16 v[48:63], v[224:227], v[196:199], v[48:63]
    ds_read_b128 v[224:227], v241 offset:16384
    v_rcp_f32 v238, v238
    v_rcp_f32 v239, v239
    v_mul_f32 v40, v40, v236
    v_mul_f32 v41, v41, v237
    v_mul_f32 v42, v42, v238
    v_mul_f32 v43, v43, v239
    s_waitcnt lgkmcnt(2)
    v_mfma_f32_32x32x16_bf16 v[48:63], v[228:231], v[200:203], v[48:63]
    s_add_u32 s83, s82, 58368
    buffer_load_dwordx4 a[228:231], v2, s[8:11], s83 offen
    ds_read_b128 v[228:231], v241 offset:17408
    v_mul_f32 v236, v44, v44
    v_mul_f32 v237, v45, v45
    v_mul_f32 v238, v46, v46
    v_mul_f32 v239, v47, v47
    v_fma_f32 v236, v236, v251, v5
    v_fma_f32 v237, v237, v251, v5
    s_waitcnt lgkmcnt(2)
    v_mfma_f32_32x32x16_bf16 v[48:63], v[232:235], v[204:207], v[48:63]
    ds_read_b128 v[232:235], v241 offset:18432
    v_fma_f32 v238, v238, v251, v5
    v_fma_f32 v239, v239, v251, v5
    v_mul_f32 v236, v236, v44
    v_mul_f32 v237, v237, v45
    v_mul_f32 v238, v238, v46
    v_mul_f32 v239, v239, v47
    s_waitcnt lgkmcnt(2)
    v_mfma_f32_32x32x16_bf16 v[48:63], v[224:227], v[208:211], v[48:63]
    s_add_u32 s83, s82, 59392
    buffer_load_dwordx4 a[232:235], v2, s[8:11], s83 offen
    ds_read_b128 v[224:227], v241 offset:19456
    v_exp_f32 v236, v236
    v_exp_f32 v237, v237
    v_exp_f32 v238, v238
    v_exp_f32 v239, v239
    v_fma_f32 v236, v236, v250, v250
    v_fma_f32 v237, v237, v250, v250
    s_waitcnt lgkmcnt(2)
    v_mfma_f32_32x32x16_bf16 v[48:63], v[228:231], v[212:215], v[48:63]
    v_fma_f32 v238, v238, v250, v250
    v_fma_f32 v239, v239, v250, v250
    v_rcp_f32 v236, v236
    v_rcp_f32 v237, v237
    v_rcp_f32 v238, v238
    v_rcp_f32 v239, v239
    s_waitcnt lgkmcnt(1)
    v_mfma_f32_32x32x16_bf16 v[48:63], v[232:235], v[216:219], v[48:63]
    s_add_u32 s83, s82, 60416
    buffer_load_dwordx4 a[236:239], v2, s[8:11], s83 offen
    v_mul_f32 v44, v44, v236
    v_mul_f32 v45, v45, v237
    v_mul_f32 v46, v46, v238
    v_mul_f32 v47, v47, v239
    v_cvt_pk_bf16_f32 v32, v32, v33
    v_cvt_pk_bf16_f32 v33, v34, v35
    s_waitcnt lgkmcnt(0)
    v_mfma_f32_32x32x16_bf16 v[48:63], v[224:227], v[220:223], v[48:63]
    v_cvt_pk_bf16_f32 v34, v36, v37
    v_cvt_pk_bf16_f32 v35, v38, v39
    v_cvt_pk_bf16_f32 v36, v40, v41
    v_cvt_pk_bf16_f32 v37, v42, v43
    v_cvt_pk_bf16_f32 v38, v44, v45
    v_cvt_pk_bf16_f32 v39, v46, v47
    buffer_store_dwordx4 v[32:35], v0, s[8:11], s72 offen offset:1024 sc1
    buffer_store_dwordx4 v[36:39], v0, s[8:11], s72 offen offset:1536 sc1
    v_mov_b32 v224, v5
    v_mov_b32 v225, v5
    v_mov_b32 v226, v251
    v_mov_b32 v227, v251
    v_mov_b32 v228, v250
    v_mov_b32 v229, v250
    v_pk_mul_f32 v[232:233], v[48:49], v[48:49]
    v_pk_mul_f32 v[234:235], v[50:51], v[50:51]
    v_pk_mul_f32 v[236:237], v[52:53], v[52:53]
    v_pk_mul_f32 v[238:239], v[54:55], v[54:55]
    v_pk_fma_f32 v[232:233], v[232:233], v[226:227], v[224:225]
    v_pk_fma_f32 v[234:235], v[234:235], v[226:227], v[224:225]
    v_pk_fma_f32 v[236:237], v[236:237], v[226:227], v[224:225]
    v_pk_fma_f32 v[238:239], v[238:239], v[226:227], v[224:225]
    v_pk_mul_f32 v[232:233], v[232:233], v[48:49]
    v_pk_mul_f32 v[234:235], v[234:235], v[50:51]
    v_pk_mul_f32 v[236:237], v[236:237], v[52:53]
    v_pk_mul_f32 v[238:239], v[238:239], v[54:55]
    v_exp_f32 v232, v232
    v_exp_f32 v233, v233
    v_exp_f32 v234, v234
    v_exp_f32 v235, v235
    v_exp_f32 v236, v236
    v_exp_f32 v237, v237
    v_exp_f32 v238, v238
    v_exp_f32 v239, v239
    v_pk_fma_f32 v[232:233], v[232:233], v[228:229], v[228:229]
    v_pk_fma_f32 v[234:235], v[234:235], v[228:229], v[228:229]
    v_pk_fma_f32 v[236:237], v[236:237], v[228:229], v[228:229]
    v_pk_fma_f32 v[238:239], v[238:239], v[228:229], v[228:229]
    v_rcp_f32 v232, v232
    v_rcp_f32 v233, v233
    v_rcp_f32 v234, v234
    v_rcp_f32 v235, v235
    v_rcp_f32 v236, v236
    v_rcp_f32 v237, v237
    v_rcp_f32 v238, v238
    v_rcp_f32 v239, v239
    v_pk_mul_f32 v[48:49], v[48:49], v[232:233]
    v_pk_mul_f32 v[50:51], v[50:51], v[234:235]
    v_pk_mul_f32 v[52:53], v[52:53], v[236:237]
    v_pk_mul_f32 v[54:55], v[54:55], v[238:239]
    v_pk_mul_f32 v[232:233], v[56:57], v[56:57]
    v_pk_mul_f32 v[234:235], v[58:59], v[58:59]
    v_pk_mul_f32 v[236:237], v[60:61], v[60:61]
    v_pk_mul_f32 v[238:239], v[62:63], v[62:63]
    v_pk_fma_f32 v[232:233], v[232:233], v[226:227], v[224:225]
    v_pk_fma_f32 v[234:235], v[234:235], v[226:227], v[224:225]
    v_pk_fma_f32 v[236:237], v[236:237], v[226:227], v[224:225]
    v_pk_fma_f32 v[238:239], v[238:239], v[226:227], v[224:225]
    v_pk_mul_f32 v[232:233], v[232:233], v[56:57]
    v_pk_mul_f32 v[234:235], v[234:235], v[58:59]
    v_pk_mul_f32 v[236:237], v[236:237], v[60:61]
    v_pk_mul_f32 v[238:239], v[238:239], v[62:63]
    v_exp_f32 v232, v232
    v_exp_f32 v233, v233
    v_exp_f32 v234, v234
    v_exp_f32 v235, v235
    v_exp_f32 v236, v236
    v_exp_f32 v237, v237
    v_exp_f32 v238, v238
    v_exp_f32 v239, v239
    v_pk_fma_f32 v[232:233], v[232:233], v[228:229], v[228:229]
    v_pk_fma_f32 v[234:235], v[234:235], v[228:229], v[228:229]
    v_pk_fma_f32 v[236:237], v[236:237], v[228:229], v[228:229]
    v_pk_fma_f32 v[238:239], v[238:239], v[228:229], v[228:229]
    v_rcp_f32 v232, v232
    v_rcp_f32 v233, v233
    v_rcp_f32 v234, v234
    v_rcp_f32 v235, v235
    v_rcp_f32 v236, v236
    v_rcp_f32 v237, v237
    v_rcp_f32 v238, v238
    v_rcp_f32 v239, v239
    v_pk_mul_f32 v[56:57], v[56:57], v[232:233]
    v_pk_mul_f32 v[58:59], v[58:59], v[234:235]
    v_pk_mul_f32 v[60:61], v[60:61], v[236:237]
    v_pk_mul_f32 v[62:63], v[62:63], v[238:239]
    v_cvt_pk_bf16_f32 v48, v48, v49
    v_cvt_pk_bf16_f32 v49, v50, v51
    v_cvt_pk_bf16_f32 v50, v52, v53
    v_cvt_pk_bf16_f32 v51, v54, v55
    v_cvt_pk_bf16_f32 v52, v56, v57
    v_cvt_pk_bf16_f32 v53, v58, v59
    v_cvt_pk_bf16_f32 v54, v60, v61
    v_cvt_pk_bf16_f32 v55, v62, v63
    s_branch L_dl_p4B_j
L_dl_p4B_1:
    ds_read_b128 v[224:227], v243 offset:12288
    ds_read_b128 v[228:231], v243 offset:13312
    ds_read_b128 v[232:235], v243 offset:14336
    v_mov_b32 v252, v250
    v_mov_b32 v253, v250
    v_mov_b32 v254, v251
    v_mov_b32 v255, 0
    s_nop 1
    v_mfma_f32_32x32x16_bf16 v[48:63], v[252:255], v[244:247], 0
    v_mul_f32 v5, 0xc0135761, v240
    v_mul_f32 v251, v240, v240
    v_mul_f32 v251, v251, v240
    v_mul_f32 v251, 0xbdd2d3e8, v251
    v_rcp_f32 v250, v240
    s_waitcnt lgkmcnt(2)
    v_mfma_f32_32x32x16_bf16 v[48:63], v[224:227], v[64:67], v[48:63]
    ds_read_b128 v[224:227], v243 offset:15360
    v_mul_f32 v236, v16, v16
    v_mul_f32 v237, v17, v17
    v_mul_f32 v238, v18, v18
    v_mul_f32 v239, v19, v19
    v_fma_f32 v236, v236, v251, v5
    v_fma_f32 v237, v237, v251, v5
    s_waitcnt lgkmcnt(2)
    v_mfma_f32_32x32x16_bf16 v[48:63], v[228:231], v[68:71], v[48:63]
    ds_read_b128 v[228:231], v243 offset:16384
    v_fma_f32 v238, v238, v251, v5
    v_fma_f32 v239, v239, v251, v5
    v_mul_f32 v236, v236, v16
    v_mul_f32 v237, v237, v17
    v_mul_f32 v238, v238, v18
    v_mul_f32 v239, v239, v19
    s_waitcnt lgkmcnt(2)
    v_mfma_f32_32x32x16_bf16 v[48:63], v[232:235], v[72:75], v[48:63]
    ds_read_b128 v[232:235], v243 offset:17408
    v_exp_f32 v236, v236
    v_exp_f32 v237, v237
    v_exp_f32 v238, v238
    v_exp_f32 v239, v239
    v_fma_f32 v236, v236, v250, v250
    v_fma_f32 v237, v237, v250, v250
    s_waitcnt lgkmcnt(2)
    v_mfma_f32_32x32x16_bf16 v[48:63], v[224:227], v[76:79], v[48:63]
    ds_read_b128 v[224:227], v243 offset:18432
    v_fma_f32 v238, v238, v250, v250
    v_fma_f32 v239, v239, v250, v250
    v_rcp_f32 v236, v236
    v_rcp_f32 v237, v237
    v_rcp_f32 v238, v238
    v_rcp_f32 v239, v239
    s_waitcnt lgkmcnt(2)
    v_mfma_f32_32x32x16_bf16 v[48:63], v[228:231], v[80:83], v[48:63]
    ds_read_b128 v[228:231], v243 offset:19456
    v_mul_f32 v16, v16, v236
    v_mul_f32 v17, v17, v237
    v_mul_f32 v18, v18, v238
    v_mul_f32 v19, v19, v239
    v_mul_f32 v236, v20, v20
    v_mul_f32 v237, v21, v21
    s_waitcnt lgkmcnt(2)
    v_mfma_f32_32x32x16_bf16 v[48:63], v[232:235], v[84:87], v[48:63]
    ds_read_b128 v[232:235], v243 offset:20480
    v_mul_f32 v238, v22, v22
    v_mul_f32 v239, v23, v23
    v_fma_f32 v236, v236, v251, v5
    v_fma_f32 v237, v237, v251, v5
    v_fma_f32 v238, v238, v251, v5
    v_fma_f32 v239, v239, v251, v5
    s_waitcnt lgkmcnt(2)
    v_mfma_f32_32x32x16_bf16 v[48:63], v[224:227], v[88:91], v[48:63]
    ds_read_b128 v[224:227], v243 offset:21504
    v_mul_f32 v236, v236, v20
    v_mul_f32 v237, v237, v21
    v_mul_f32 v238, v238, v22
    v_mul_f32 v239, v239, v23
    v_exp_f32 v236, v236
    v_exp_f32 v237, v237
    s_waitcnt lgkmcnt(2)
    v_mfma_f32_32x32x16_bf16 v[48:63], v[228:231], v[92:95], v[48:63]
    ds_read_b128 v[228:231], v243 offset:22528
    v_exp_f32 v238, v238
    v_exp_f32 v239, v239
    v_fma_f32 v236, v236, v250, v250
    v_fma_f32 v237, v237, v250, v250
    v_fma_f32 v238, v238, v250, v250
    v_fma_f32 v239, v239, v250, v250
    s_waitcnt lgkmcnt(2)
    v_mfma_f32_32x32x16_bf16 v[48:63], v[232:235], v[96:99], v[48:63]
    ds_read_b128 v[232:235], v243 offset:23552
    v_rcp_f32 v236, v236
    v_rcp_f32 v237, v237
    v_rcp_f32 v238, v238
    v_rcp_f32 v239, v239
    v_mul_f32 v20, v20, v236
    v_mul_f32 v21, v21, v237
    s_waitcnt lgkmcnt(2)
    v_mfma_f32_32x32x16_bf16 v[48:63], v[224:227], v[100:103], v[48:63]
    ds_read_b128 v[224:227], v243 offset:24576
    v_mul_f32 v22, v22, v238
    v_mul_f32 v23, v23, v239
    v_mul_f32 v236, v24, v24
    v_mul_f32 v237, v25, v25
    v_mul_f32 v238, v26, v26
    v_mul_f32 v239, v27, v27
    s_waitcnt lgkmcnt(2)
    v_mfma_f32_32x32x16_bf16 v[48:63], v[228:231], v[104:107], v[48:63]
    ds_read_b128 v[228:231], v243 offset:25600
    v_fma_f32 v236, v236, v251, v5
    v_fma_f32 v237, v237, v251, v5
    v_fma_f32 v238, v238, v251, v5
    v_fma_f32 v239, v239, v251, v5
    v_mul_f32 v236, v236, v24
    v_mul_f32 v237, v237, v25
    s_waitcnt lgkmcnt(2)
    v_mfma_f32_32x32x16_bf16 v[48:63], v[232:235], v[108:111], v[48:63]
    ds_read_b128 v[232:235], v243 offset:26624
    v_mul_f32 v238, v238, v26
    v_mul_f32 v239, v239, v27
    v_exp_f32 v236, v236
    v_exp_f32 v237, v237
    v_exp_f32 v238, v238
    v_exp_f32 v239, v239
    s_waitcnt lgkmcnt(2)
    v_mfma_f32_32x32x16_bf16 v[48:63], v[224:227], v[112:115], v[48:63]
    ds_read_b128 v[224:227], v243 offset:27648
    v_fma_f32 v236, v236, v250, v250
    v_fma_f32 v237, v237, v250, v250
    v_fma_f32 v238, v238, v250, v250
    v_fma_f32 v239, v239, v250, v250
    v_rcp_f32 v236, v236
    v_rcp_f32 v237, v237
    s_waitcnt lgkmcnt(2)
    v_mfma_f32_32x32x16_bf16 v[48:63], v[228:231], v[116:119], v[48:63]
    ds_read_b128 v[228:231], v243 offset:28672
    v_rcp_f32 v238, v238
    v_rcp_f32 v239, v239
    v_mul_f32 v24, v24, v236
    v_mul_f32 v25, v25, v237
    v_mul_f32 v26, v26, v238
    v_mul_f32 v27, v27, v239
    s_waitcnt lgkmcnt(2)
    v_mfma_f32_32x32x16_bf16 v[48:63], v[232:235], v[120:123], v[48:63]
    ds_read_b128 v[232:235], v243 offset:29696
    v_mul_f32 v236, v28, v28
    v_mul_f32 v237, v29, v29
    v_mul_f32 v238, v30, v30
    v_mul_f32 v239, v31, v31
    v_fma_f32 v236, v236, v251, v5
    v_fma_f32 v237, v237, v251, v5
    s_waitcnt lgkmcnt(2)
    v_mfma_f32_32x32x16_bf16 v[48:63], v[224:227], v[124:127], v[48:63]
    ds_read_b128 v[224:227], v243 offset:30720
    v_fma_f32 v238, v238, v251, v5
    v_fma_f32 v239, v239, v251, v5
    v_mul_f32 v236, v236, v28
    v_mul_f32 v237, v237, v29
    v_mul_f32 v238, v238, v30
    v_mul_f32 v239, v239, v31
    s_waitcnt lgkmcnt(2)
    v_mfma_f32_32x32x16_bf16 v[48:63], v[228:231], v[128:131], v[48:63]
    s_waitcnt vmcnt(0)
    s_barrier
    ds_read_b128 v[228:231], v243 offset:31744
    v_exp_f32 v236, v236
    v_exp_f32 v237, v237
    v_exp_f32 v238, v238
    v_exp_f32 v239, v239
    v_fma_f32 v236, v236, v250, v250
    v_fma_f32 v237, v237, v250, v250
    s_waitcnt lgkmcnt(2)
    v_mfma_f32_32x32x16_bf16 v[48:63], v[232:235], v[132:135], v[48:63]
    ds_read_b128 v[232:235], v241 offset:0
    v_fma_f32 v238, v238, v250, v250
    v_fma_f32 v239, v239, v250, v250
    v_rcp_f32 v236, v236
    v_rcp_f32 v237, v237
    v_rcp_f32 v238, v238
    v_rcp_f32 v239, v239
    s_waitcnt lgkmcnt(2)
    v_mfma_f32_32x32x16_bf16 v[48:63], v[224:227], v[136:139], v[48:63]
    ds_read_b128 v[224:227], v241 offset:1024
    v_mul_f32 v28, v28, v236
    v_mul_f32 v29, v29, v237
    v_mul_f32 v30, v30, v238
    v_mul_f32 v31, v31, v239
    v_cvt_pk_bf16_f32 v16, v16, v17
    v_cvt_pk_bf16_f32 v17, v18, v19
    s_waitcnt lgkmcnt(2)
    v_mfma_f32_32x32x16_bf16 v[48:63], v[228:231], v[140:143], v[48:63]
    ds_read_b128 v[228:231], v241 offset:2048
    v_cvt_pk_bf16_f32 v18, v20, v21
    v_cvt_pk_bf16_f32 v19, v22, v23
    v_cvt_pk_bf16_f32 v20, v24, v25
    v_cvt_pk_bf16_f32 v21, v26, v27
    v_cvt_pk_bf16_f32 v22, v28, v29
    v_cvt_pk_bf16_f32 v23, v30, v31
    buffer_store_dwordx4 v[16:19], v0, s[8:11], s72 offen offset:0 sc1
    buffer_store_dwordx4 v[20:23], v0, s[8:11], s72 offen offset:512 sc1
    s_waitcnt lgkmcnt(2)
    v_mfma_f32_32x32x16_bf16 v[48:63], v[232:235], v[144:147], v[48:63]
    ds_read_b128 v[232:235], v241 offset:3072
    v_mul_f32 v236, v32, v32
    v_mul_f32 v237, v33, v33
    v_mul_f32 v238, v34, v34
    v_mul_f32 v239, v35, v35
    v_fma_f32 v236, v236, v251, v5
    v_fma_f32 v237, v237, v251, v5
    s_waitcnt lgkmcnt(2)
    v_mfma_f32_32x32x16_bf16 v[48:63], v[224:227], v[148:151], v[48:63]
    ds_read_b128 v[224:227], v241 offset:4096
    v_fma_f32 v238, v238, v251, v5
    v_fma_f32 v239, v239, v251, v5
    v_mul_f32 v236, v236, v32
    v_mul_f32 v237, v237, v33
    v_mul_f32 v238, v238, v34
    v_mul_f32 v239, v239, v35
    s_waitcnt lgkmcnt(2)
    v_mfma_f32_32x32x16_bf16 v[48:63], v[228:231], v[152:155], v[48:63]
    ds_read_b128 v[228:231], v241 offset:5120
    v_exp_f32 v236, v236
    v_exp_f32 v237, v237
    v_exp_f32 v238, v238
    v_exp_f32 v239, v239
    v_fma_f32 v236, v236, v250, v250
    v_fma_f32 v237, v237, v250, v250
    s_waitcnt lgkmcnt(2)
    v_mfma_f32_32x32x16_bf16 v[48:63], v[232:235], v[156:159], v[48:63]
    ds_read_b128 v[232:235], v241 offset:6144
    v_fma_f32 v238, v238, v250, v250
    v_fma_f32 v239, v239, v250, v250
    v_rcp_f32 v236, v236
    v_rcp_f32 v237, v237
    v_rcp_f32 v238, v238
    v_rcp_f32 v239, v239
    s_waitcnt lgkmcnt(2)
    v_mfma_f32_32x32x16_bf16 v[48:63], v[224:227], v[160:163], v[48:63]
    ds_read_b128 v[224:227], v241 offset:7168
    v_mul_f32 v32, v32, v236
    v_mul_f32 v33, v33, v237
    v_mul_f32 v34, v34, v238
    v_mul_f32 v35, v35, v239
    v_mul_f32 v236, v36, v36
    v_mul_f32 v237, v37, v37
    s_waitcnt lgkmcnt(2)
    v_mfma_f32_32x32x16_bf16 v[48:63], v[228:231], v[164:167], v[48:63]
    ds_read_b128 v[228:231], v241 offset:8192
    v_mul_f32 v238, v38, v38
    v_mul_f32 v239, v39, v39
    v_fma_f32 v236, v236, v251, v5
    v_fma_f32 v237, v237, v251, v5
    v_fma_f32 v238, v238, v251, v5
    v_fma_f32 v239, v239, v251, v5
    s_waitcnt lgkmcnt(2)
    v_mfma_f32_32x32x16_bf16 v[48:63], v[232:235], v[168:171], v[48:63]
    ds_read_b128 v[232:235], v241 offset:9216
    v_mul_f32 v236, v236, v36
    v_mul_f32 v237, v237, v37
    v_mul_f32 v238, v238, v38
    v_mul_f32 v239, v239, v39
    v_exp_f32 v236, v236
    v_exp_f32 v237, v237
    s_waitcnt lgkmcnt(2)
    v_mfma_f32_32x32x16_bf16 v[48:63], v[224:227], v[172:175], v[48:63]
    ds_read_b128 v[224:227], v241 offset:10240
    v_exp_f32 v238, v238
    v_exp_f32 v239, v239
    v_fma_f32 v236, v236, v250, v250
    v_fma_f32 v237, v237, v250, v250
    v_fma_f32 v238, v238, v250, v250
    v_fma_f32 v239, v239, v250, v250
    s_waitcnt lgkmcnt(2)
    v_mfma_f32_32x32x16_bf16 v[48:63], v[228:231], v[176:179], v[48:63]
    ds_read_b128 v[228:231], v241 offset:11264
    v_rcp_f32 v236, v236
    v_rcp_f32 v237, v237
    v_rcp_f32 v238, v238
    v_rcp_f32 v239, v239
    v_mul_f32 v36, v36, v236
    v_mul_f32 v37, v37, v237
    s_waitcnt lgkmcnt(2)
    v_mfma_f32_32x32x16_bf16 v[48:63], v[232:235], v[180:183], v[48:63]
    ds_read_b128 v[232:235], v241 offset:12288
    v_mul_f32 v38, v38, v238
    v_mul_f32 v39, v39, v239
    v_mul_f32 v236, v40, v40
    v_mul_f32 v237, v41, v41
    v_mul_f32 v238, v42, v42
    v_mul_f32 v239, v43, v43
    s_waitcnt lgkmcnt(2)
    v_mfma_f32_32x32x16_bf16 v[48:63], v[224:227], v[184:187], v[48:63]
    ds_read_b128 v[224:227], v241 offset:13312
    v_fma_f32 v236, v236, v251, v5
    v_fma_f32 v237, v237, v251, v5
    v_fma_f32 v238, v238, v251, v5
    v_fma_f32 v239, v239, v251, v5
    v_mul_f32 v236, v236, v40
    v_mul_f32 v237, v237, v41
    s_waitcnt lgkmcnt(2)
    v_mfma_f32_32x32x16_bf16 v[48:63], v[228:231], v[188:191], v[48:63]
    ds_read_b128 v[228:231], v241 offset:14336
    v_mul_f32 v238, v238, v42
    v_mul_f32 v239, v239, v43
    v_exp_f32 v236, v236
    v_exp_f32 v237, v237
    v_exp_f32 v238, v238
    v_exp_f32 v239, v239
    s_waitcnt lgkmcnt(2)
    v_mfma_f32_32x32x16_bf16 v[48:63], v[232:235], v[192:195], v[48:63]
    ds_read_b128 v[232:235], v241 offset:15360
    v_fma_f32 v236, v236, v250, v250
    v_fma_f32 v237, v237, v250, v250
    v_fma_f32 v238, v238, v250, v250
    v_fma_f32 v239, v239, v250, v250
    v_rcp_f32 v236, v236
    v_rcp_f32 v237, v237
    s_waitcnt lgkmcnt(2)
    v_mfma_f32_32x32x16_bf16 v[48:63], v[224:227], v[196:199], v[48:63]
    ds_read_b128 v[224:227], v241 offset:16384
    v_rcp_f32 v238, v238
    v_rcp_f32 v239, v239
    v_mul_f32 v40, v40, v236
    v_mul_f32 v41, v41, v237
    v_mul_f32 v42, v42, v238
    v_mul_f32 v43, v43, v239
    s_waitcnt lgkmcnt(2)
    v_mfma_f32_32x32x16_bf16 v[48:63], v[228:231], v[200:203], v[48:63]
    ds_read_b128 v[228:231], v241 offset:17408
    v_mul_f32 v236, v44, v44
    v_mul_f32 v237, v45, v45
    v_mul_f32 v238, v46, v46
    v_mul_f32 v239, v47, v47
    v_fma_f32 v236, v236, v251, v5
    v_fma_f32 v237, v237, v251, v5
    s_waitcnt lgkmcnt(2)
    v_mfma_f32_32x32x16_bf16 v[48:63], v[232:235], v[204:207], v[48:63]
    ds_read_b128 v[232:235], v241 offset:18432
    v_fma_f32 v238, v238, v251, v5
    v_fma_f32 v239, v239, v251, v5
    v_mul_f32 v236, v236, v44
    v_mul_f32 v237, v237, v45
    v_mul_f32 v238, v238, v46
    v_mul_f32 v239, v239, v47
    s_waitcnt lgkmcnt(2)
    v_mfma_f32_32x32x16_bf16 v[48:63], v[224:227], v[208:211], v[48:63]
    ds_read_b128 v[224:227], v241 offset:19456
    v_exp_f32 v236, v236
    v_exp_f32 v237, v237
    v_exp_f32 v238, v238
    v_exp_f32 v239, v239
    v_fma_f32 v236, v236, v250, v250
    v_fma_f32 v237, v237, v250, v250
    s_waitcnt lgkmcnt(2)
    v_mfma_f32_32x32x16_bf16 v[48:63], v[228:231], v[212:215], v[48:63]
    v_fma_f32 v238, v238, v250, v250
    v_fma_f32 v239, v239, v250, v250
    v_rcp_f32 v236, v236
    v_rcp_f32 v237, v237
    v_rcp_f32 v238, v238
    v_rcp_f32 v239, v239
    s_waitcnt lgkmcnt(1)
    v_mfma_f32_32x32x16_bf16 v[48:63], v[232:235], v[216:219], v[48:63]
    v_mul_f32 v44, v44, v236
    v_mul_f32 v45, v45, v237
    v_mul_f32 v46, v46, v238
    v_mul_f32 v47, v47, v239
    v_cvt_pk_bf16_f32 v32, v32, v33
    v_cvt_pk_bf16_f32 v33, v34, v35
    s_waitcnt lgkmcnt(0)
    v_mfma_f32_32x32x16_bf16 v[48:63], v[224:227], v[220:223], v[48:63]
    v_cvt_pk_bf16_f32 v34, v36, v37
    v_cvt_pk_bf16_f32 v35, v38, v39
    v_cvt_pk_bf16_f32 v36, v40, v41
    v_cvt_pk_bf16_f32 v37, v42, v43
    v_cvt_pk_bf16_f32 v38, v44, v45
    v_cvt_pk_bf16_f32 v39, v46, v47
    buffer_store_dwordx4 v[32:35], v0, s[8:11], s72 offen offset:1024 sc1
    buffer_store_dwordx4 v[36:39], v0, s[8:11], s72 offen offset:1536 sc1
    v_mov_b32 v224, v5
    v_mov_b32 v225, v5
    v_mov_b32 v226, v251
    v_mov_b32 v227, v251
    v_mov_b32 v228, v250
    v_mov_b32 v229, v250
    v_pk_mul_f32 v[232:233], v[48:49], v[48:49]
    v_pk_mul_f32 v[234:235], v[50:51], v[50:51]
    v_pk_mul_f32 v[236:237], v[52:53], v[52:53]
    v_pk_mul_f32 v[238:239], v[54:55], v[54:55]
    v_pk_fma_f32 v[232:233], v[232:233], v[226:227], v[224:225]
    v_pk_fma_f32 v[234:235], v[234:235], v[226:227], v[224:225]
    v_pk_fma_f32 v[236:237], v[236:237], v[226:227], v[224:225]
    v_pk_fma_f32 v[238:239], v[238:239], v[226:227], v[224:225]
    v_pk_mul_f32 v[232:233], v[232:233], v[48:49]
    v_pk_mul_f32 v[234:235], v[234:235], v[50:51]
    v_pk_mul_f32 v[236:237], v[236:237], v[52:53]
    v_pk_mul_f32 v[238:239], v[238:239], v[54:55]
    v_exp_f32 v232, v232
    v_exp_f32 v233, v233
    v_exp_f32 v234, v234
    v_exp_f32 v235, v235
    v_exp_f32 v236, v236
    v_exp_f32 v237, v237
    v_exp_f32 v238, v238
    v_exp_f32 v239, v239
    v_pk_fma_f32 v[232:233], v[232:233], v[228:229], v[228:229]
    v_pk_fma_f32 v[234:235], v[234:235], v[228:229], v[228:229]
    v_pk_fma_f32 v[236:237], v[236:237], v[228:229], v[228:229]
    v_pk_fma_f32 v[238:239], v[238:239], v[228:229], v[228:229]
    v_rcp_f32 v232, v232
    v_rcp_f32 v233, v233
    v_rcp_f32 v234, v234
    v_rcp_f32 v235, v235
    v_rcp_f32 v236, v236
    v_rcp_f32 v237, v237
    v_rcp_f32 v238, v238
    v_rcp_f32 v239, v239
    v_pk_mul_f32 v[48:49], v[48:49], v[232:233]
    v_pk_mul_f32 v[50:51], v[50:51], v[234:235]
    v_pk_mul_f32 v[52:53], v[52:53], v[236:237]
    v_pk_mul_f32 v[54:55], v[54:55], v[238:239]
    v_pk_mul_f32 v[232:233], v[56:57], v[56:57]
    v_pk_mul_f32 v[234:235], v[58:59], v[58:59]
    v_pk_mul_f32 v[236:237], v[60:61], v[60:61]
    v_pk_mul_f32 v[238:239], v[62:63], v[62:63]
    v_pk_fma_f32 v[232:233], v[232:233], v[226:227], v[224:225]
    v_pk_fma_f32 v[234:235], v[234:235], v[226:227], v[224:225]
    v_pk_fma_f32 v[236:237], v[236:237], v[226:227], v[224:225]
    v_pk_fma_f32 v[238:239], v[238:239], v[226:227], v[224:225]
    v_pk_mul_f32 v[232:233], v[232:233], v[56:57]
    v_pk_mul_f32 v[234:235], v[234:235], v[58:59]
    v_pk_mul_f32 v[236:237], v[236:237], v[60:61]
    v_pk_mul_f32 v[238:239], v[238:239], v[62:63]
    v_exp_f32 v232, v232
    v_exp_f32 v233, v233
    v_exp_f32 v234, v234
    v_exp_f32 v235, v235
    v_exp_f32 v236, v236
    v_exp_f32 v237, v237
    v_exp_f32 v238, v238
    v_exp_f32 v239, v239
    v_pk_fma_f32 v[232:233], v[232:233], v[228:229], v[228:229]
    v_pk_fma_f32 v[234:235], v[234:235], v[228:229], v[228:229]
    v_pk_fma_f32 v[236:237], v[236:237], v[228:229], v[228:229]
    v_pk_fma_f32 v[238:239], v[238:239], v[228:229], v[228:229]
    v_rcp_f32 v232, v232
    v_rcp_f32 v233, v233
    v_rcp_f32 v234, v234
    v_rcp_f32 v235, v235
    v_rcp_f32 v236, v236
    v_rcp_f32 v237, v237
    v_rcp_f32 v238, v238
    v_rcp_f32 v239, v239
    v_pk_mul_f32 v[56:57], v[56:57], v[232:233]
    v_pk_mul_f32 v[58:59], v[58:59], v[234:235]
    v_pk_mul_f32 v[60:61], v[60:61], v[236:237]
    v_pk_mul_f32 v[62:63], v[62:63], v[238:239]
    v_cvt_pk_bf16_f32 v48, v48, v49
    v_cvt_pk_bf16_f32 v49, v50, v51
    v_cvt_pk_bf16_f32 v50, v52, v53
    v_cvt_pk_bf16_f32 v51, v54, v55
    v_cvt_pk_bf16_f32 v52, v56, v57
    v_cvt_pk_bf16_f32 v53, v58, v59
    v_cvt_pk_bf16_f32 v54, v60, v61
    v_cvt_pk_bf16_f32 v55, v62, v63
L_dl_p4B_j:
    buffer_store_dwordx4 v[48:51], v0, s[8:11], s72 offen offset:2048 sc1
    buffer_store_dwordx4 v[52:55], v0, s[8:11], s72 offen offset:2560 sc1
    s_lshl_b32 s35, s25, 6
    s_add_u32 s35, s35, s26
    s_lshl_b32 s36, s29, 2
    s_add_u32 s36, s36, s30
    s_add_u32 s36, s36, 3
    s_waitcnt vmcnt(0)
    s_barrier
    s_cmp_lg_u32 s24, 0
    s_cbranch_scc1 L_fl_row_h
    s_lshl_b32 s32, s35, 2
    s_add_u32 s32, s32, 4096
    v_mov_b32 v254, s36
    v_mov_b32 v255, 0
    s_mov_b64 s[64:65], exec
    s_mov_b64 exec, 1
    s_cmp_eq_u32 s84, 1
    s_cbranch_scc1 L_fl_row_h_f
    buffer_store_dword v254, v255, s[8:11], s32 offen sc1
    s_branch L_fl_row_h_j
L_fl_row_h_f:
    buffer_store_dword v254, v255, s[8:11], s32 offen
L_fl_row_h_j:
    s_mov_b64 exec, s[64:65]
L_fl_row_h:
    s_lshl_b32 s32, s25, 3
    s_lshl_b32 s33, s27, 2
    s_add_u32 s32, s32, s33
    s_mul_i32 s32, s32, 48
    s_mul_i32 s33, s24, 12
    s_add_u32 s32, s32, s33
    s_lshl_b32 s32, s32, 10
    s_mul_i32 s33, s29, 0
    s_add_u32 s32, s32, s33
    s_add_u32 s75, s32, 25165824
    s_mov_b32 s12, s54
    s_and_b32 s13, s55, 0xffff
    s_mov_b32 s14, 1280
    s_mov_b32 s15, 0x00020000
    s_lshl_b32 s32, s25, 2
    s_lshl_b32 s33, s27, 1
    s_add_u32 s32, s32, s33
    s_lshr_b32 s33, s24, 1
    s_add_u32 s32, s32, s33
    s_and_b32 s34, s24, 1
    s_lshl_b32 s34, s34, 4
    v_and_b32 v5, 15, v1
    v_add_u32 v5, s34, v5
    v_lshrrev_b32 v0, 5, v1
    v_lshlrev_b32 v0, 5, v0
    v_add_u32 v0, v0, v5
    v_lshlrev_b32 v0, 4, v0
    v_bfe_u32 v253, v1, 4, 1
    v_lshlrev_b32 v253, 3, v253
    v_add_u32 v0, v0, v253
    v_lshlrev_b32 v5, 3, v5
    s_mul_i32 s76, s32, 40
    s_mul_i32 s34, s28, 5
    s_add_u32 s76, s76, s34
    s_lshl_b32 s76, s76, 10
    s_lshl_b32 s78, s32, 3
    s_add_u32 s78, s78, s28
    s_lshl_b32 s78, s78, 8
    s_add_u32 s76, s76, 22020096
    s_add_u32 s78, s78, 24903680
    s_add_u32 s77, s76, 4096
    s_add_u32 s32, s24, 1
    s_and_b32 s32, s32, 3
    s_mul_i32 s32, s32, 15360
    s_add_u32 s32, s32, 10240
    v_add_u32 v248, s32, v2
    s_add_u32 s32, s24, 2
    s_and_b32 s32, s32, 3
    s_mul_i32 s32, s32, 15360
    s_add_u32 s32, s32, 5120
    v_add_u32 v249, s32, v2
    s_add_u32 s32, s24, 3
    s_and_b32 s32, s32, 3
    s_mul_i32 s32, s32, 15360
    s_add_u32 s32, s32, 0
    v_add_u32 v250, s32, v2
    s_mul_i32 s32, s24, 15360
    s_add_u32 s32, s32, 0
    v_add_u32 v251, s32, v2
    s_lshl_b32 s70, s25, 8
    s_add_u32 s70, s70, 4096
    s_lshl_b32 s71, s29, 2
    s_add_u32 s71, s71, s30
    s_add_u32 s71, s71, 3
    s_cmp_lg_u32 s24, 0
    s_cbranch_scc1 L_po_row_h_done
    s_mov_b64 s[64:65], exec
    s_mov_b64 exec, 0xffff
    v_mul_u32_u24 v255, 4, v1
    s_mov_b32 s33, 0
L_po_row_h:
    buffer_load_dword v254, v255, s[8:11], s70 offen sc1
    s_waitcnt vmcnt(0)
    v_subrev_u32 v254, s71, v254
    v_cmp_gt_u32 vcc, 8, v254
    s_add_u32 s33, s33, 1
    s_cmp_eq_u64 vcc, exec
    s_cbranch_scc1 L_po_row_h_ok
    s_cmp_lt_u32 s33, 0x100000
    s_cbranch_scc1 L_po_row_h
    v_mov_b32 v254, 60
    v_mov_b32 v255, s2
    v_add_u32 v255, 0x1000, v255
    buffer_store_dword v255, v254, s[20:23], 0 offen sc1
L_po_row_h_ok:
    s_mov_b64 exec, s[64:65]
L_po_row_h_done:
    s_barrier
    s_mov_b32 s70, s75
    s_cmp_eq_u32 s29, 0
    s_cbranch_scc0 L_dl_p5_1
    s_sub_u32 s32, s24, 0
    s_mul_i32 s32, s32, 25600
    s_add_u32 s93, s32, s90
    s_add_u32 s93, s93, 0
    s_add_u32 s94, s32, 61440
    s_mov_b32 m0, s94
    s_add_u32 s32, s24, 1
    s_and_b32 s32, s32, 3
    s_mul_i32 s32, s32, 49152
    s_add_u32 s81, s32, s70
    buffer_load_dwordx4 v[16:19], v2, s[8:11], s81 offen offset:0 sc1
    buffer_load_dwordx4 v[20:23], v2, s[8:11], s81 offen offset:1024 sc1
    buffer_load_dwordx4 v[24:27], v2, s[8:11], s81 offen offset:2048 sc1
    buffer_load_dwordx4 v[28:31], v2, s[8:11], s81 offen offset:3072 sc1
    s_add_u32 s81, s81, 4096
    buffer_load_dwordx4 v[32:35], v2, s[8:11], s81 offen offset:0 sc1
    buffer_load_dwordx4 v[36:39], v2, s[8:11], s81 offen offset:1024 sc1
    buffer_load_dwordx4 v[40:43], v2, s[8:11], s81 offen offset:2048 sc1
    buffer_load_dwordx4 v[44:47], v2, s[8:11], s81 offen offset:3072 sc1
    s_add_u32 s81, s81, 4096
    buffer_load_dwordx4 v[48:51], v2, s[8:11], s81 offen offset:0 sc1
    buffer_load_dwordx4 v[52:55], v2, s[8:11], s81 offen offset:1024 sc1
    buffer_load_dwordx4 v[56:59], v2, s[8:11], s81 offen offset:2048 sc1
    buffer_load_dwordx4 v[60:63], v2, s[8:11], s81 offen offset:3072 sc1
    s_waitcnt vmcnt(11)
    v_mfma_f32_16x16x32_bf16 v[208:211], a[0:3], v[16:19], 0
    v_mfma_f32_16x16x32_bf16 v[212:215], a[4:7], v[16:19], 0
    s_add_u32 s32, s24, 2
    s_and_b32 s32, s32, 3
    s_mul_i32 s32, s32, 49152
    s_add_u32 s81, s32, s70
    buffer_load_dwordx4 v[64:67], v2, s[8:11], s81 offen offset:0 sc1
    v_mfma_f32_16x16x32_bf16 v[216:219], a[8:11], v[16:19], 0
    v_mfma_f32_16x16x32_bf16 v[220:223], a[12:15], v[16:19], 0
    v_mfma_f32_16x16x32_bf16 v[224:227], a[16:19], v[16:19], 0
    s_waitcnt vmcnt(11)
    v_mfma_f32_16x16x32_bf16 v[208:211], a[20:23], v[20:23], v[208:211]
    v_mfma_f32_16x16x32_bf16 v[212:215], a[24:27], v[20:23], v[212:215]
    buffer_load_dwordx4 v[68:71], v2, s[8:11], s81 offen offset:1024 sc1
    v_mfma_f32_16x16x32_bf16 v[216:219], a[28:31], v[20:23], v[216:219]
    v_mfma_f32_16x16x32_bf16 v[220:223], a[32:35], v[20:23], v[220:223]
    v_mfma_f32_16x16x32_bf16 v[224:227], a[36:39], v[20:23], v[224:227]
    s_waitcnt vmcnt(11)
    v_mfma_f32_16x16x32_bf16 v[208:211], a[40:43], v[24:27], v[208:211]
    v_mfma_f32_16x16x32_bf16 v[212:215], a[44:47], v[24:27], v[212:215]
    buffer_load_dwordx4 v[72:75], v2, s[8:11], s81 offen offset:2048 sc1
    v_mfma_f32_16x16x32_bf16 v[216:219], a[48:51], v[24:27], v[216:219]
    v_mfma_f32_16x16x32_bf16 v[220:223], a[52:55], v[24:27], v[220:223]
    v_mfma_f32_16x16x32_bf16 v[224:227], a[56:59], v[24:27], v[224:227]
    s_waitcnt vmcnt(11)
    v_mfma_f32_16x16x32_bf16 v[208:211], a[60:63], v[28:31], v[208:211]
    v_mfma_f32_16x16x32_bf16 v[212:215], a[64:67], v[28:31], v[212:215]
    buffer_load_dwordx4 v[76:79], v2, s[8:11], s81 offen offset:3072 sc1
    v_mfma_f32_16x16x32_bf16 v[216:219], a[68:71], v[28:31], v[216:219]
    v_mfma_f32_16x16x32_bf16 v[220:223], a[72:75], v[28:31], v[220:223]
    v_mfma_f32_16x16x32_bf16 v[224:227], a[76:79], v[28:31], v[224:227]
    s_waitcnt vmcnt(11)
    v_mfma_f32_16x16x32_bf16 v[208:211], a[80:83], v[32:35], v[208:211]
    v_mfma_f32_16x16x32_bf16 v[212:215], a[84:87], v[32:35], v[212:215]
    s_add_u32 s81, s81, 4096
    buffer_load_dwordx4 v[80:83], v2, s[8:11], s81 offen offset:0 sc1
    v_mfma_f32_16x16x32_bf16 v[216:219], a[88:91], v[32:35], v[216:219]
    v_mfma_f32_16x16x32_bf16 v[220:223], a[92:95], v[32:35], v[220:223]
    v_mfma_f32_16x16x32_bf16 v[224:227], a[96:99], v[32:35], v[224:227]
    s_waitcnt vmcnt(11)
    v_mfma_f32_16x16x32_bf16 v[208:211], a[100:103], v[36:39], v[208:211]
    v_mfma_f32_16x16x32_bf16 v[212:215], a[104:107], v[36:39], v[212:215]
    buffer_load_dwordx4 v[84:87], v2, s[8:11], s81 offen offset:1024 sc1
    v_mfma_f32_16x16x32_bf16 v[216:219], a[108:111], v[36:39], v[216:219]
    v_mfma_f32_16x16x32_bf16 v[220:223], a[112:115], v[36:39], v[220:223]
    v_mfma_f32_16x16x32_bf16 v[224:227], a[116:119], v[36:39], v[224:227]
    s_waitcnt vmcnt(11)
    v_mfma_f32_16x16x32_bf16 v[208:211], a[120:123], v[40:43], v[208:211]
    v_mfma_f32_16x16x32_bf16 v[212:215], a[124:127], v[40:43], v[212:215]
    buffer_load_dwordx4 v[88:91], v2, s[8:11], s81 offen offset:2048 sc1
    v_mfma_f32_16x16x32_bf16 v[216:219], a[128:131], v[40:43], v[216:219]
    v_mfma_f32_16x16x32_bf16 v[220:223], a[132:135], v[40:43], v[220:223]
    v_mfma_f32_16x16x32_bf16 v[224:227], a[136:139], v[40:43], v[224:227]
    s_waitcnt vmcnt(11)
    v_mfma_f32_16x16x32_bf16 v[208:211], a[140:143], v[44:47], v[208:211]
    v_mfma_f32_16x16x32_bf16 v[212:215], a[144:147], v[44:47], v[212:215]
    buffer_load_dwordx4 v[92:95], v2, s[8:11], s81 offen offset:3072 sc1
    v_mfma_f32_16x16x32_bf16 v[216:219], a[148:151], v[44:47], v[216:219]
    v_mfma_f32_16x16x32_bf16 v[220:223], a[152:155], v[44:47], v[220:223]
    v_mfma_f32_16x16x32_bf16 v[224:227], a[156:159], v[44:47], v[224:227]
    s_waitcnt vmcnt(11)
    v_mfma_f32_16x16x32_bf16 v[208:211], a[160:163], v[48:51], v[208:211]
    v_mfma_f32_16x16x32_bf16 v[212:215], a[164:167], v[48:51], v[212:215]
    s_add_u32 s81, s81, 4096
    buffer_load_dwordx4 v[96:99], v2, s[8:11], s81 offen offset:0 sc1
    v_mfma_f32_16x16x32_bf16 v[216:219], a[168:171], v[48:51], v[216:219]
    v_mfma_f32_16x16x32_bf16 v[220:223], a[172:175], v[48:51], v[220:223]
    buffer_load_dwordx4 v2, s[8:11], s93 offen offset:0 lds
    v_mfma_f32_16x16x32_bf16 v[224:227], a[176:179], v[48:51], v[224:227]
    s_waitcnt vmcnt(12)
    v_mfma_f32_16x16x32_bf16 v[208:211], a[180:183], v[52:55], v[208:211]
    v_mfma_f32_16x16x32_bf16 v[212:215], a[184:187], v[52:55], v[212:215]
    buffer_load_dwordx4 v[100:103], v2, s[8:11], s81 offen offset:1024 sc1
    v_mfma_f32_16x16x32_bf16 v[216:219], a[188:191], v[52:55], v[216:219]
    v_mfma_f32_16x16x32_bf16 v[220:223], a[192:195], v[52:55], v[220:223]
    buffer_load_dwordx4 v2, s[8:11], s93 offen offset:1024 lds
    v_mfma_f32_16x16x32_bf16 v[224:227], a[196:199], v[52:55], v[224:227]
    s_waitcnt vmcnt(13)
    v_mfma_f32_16x16x32_bf16 v[208:211], a[200:203], v[56:59], v[208:211]
    v_mfma_f32_16x16x32_bf16 v[212:215], a[204:207], v[56:59], v[212:215]
    buffer_load_dwordx4 v[104:107], v2, s[8:11], s81 offen offset:2048 sc1
    v_mfma_f32_16x16x32_bf16 v[216:219], a[208:211], v[56:59], v[216:219]
    v_mfma_f32_16x16x32_bf16 v[220:223], a[212:215], v[56:59], v[220:223]
    buffer_load_dwordx4 v2, s[8:11], s93 offen offset:2048 lds
    v_mfma_f32_16x16x32_bf16 v[224:227], a[216:219], v[56:59], v[224:227]
    s_waitcnt vmcnt(14)
    v_mfma_f32_16x16x32_bf16 v[208:211], a[220:223], v[60:63], v[208:211]
    v_mfma_f32_16x16x32_bf16 v[212:215], a[224:227], v[60:63], v[212:215]
    buffer_load_dwordx4 v[108:111], v2, s[8:11], s81 offen offset:3072 sc1
    v_mfma_f32_16x16x32_bf16 v[216:219], a[228:231], v[60:63], v[216:219]
    v_mfma_f32_16x16x32_bf16 v[220:223], a[232:235], v[60:63], v[220:223]
    buffer_load_dwordx4 v2, s[8:11], s93 offen offset:3072 lds
    v_mfma_f32_16x16x32_bf16 v[224:227], a[236:239], v[60:63], v[224:227]
    v_lshrrev_b32 v252, 4, v1
    v_lshlrev_b32 v252, 3, v252
    s_mul_i32 s33, s28, 160
    buffer_load_dwordx2 v[16:17], v252, s[12:15], s33 offen offset:0
    buffer_load_dwordx2 v[18:19], v252, s[12:15], s33 offen offset:32
    buffer_load_dwordx2 v[20:21], v252, s[12:15], s33 offen offset:64
    buffer_load_dwordx2 v[22:23], v252, s[12:15], s33 offen offset:96
    buffer_load_dwordx2 v[24:25], v252, s[12:15], s33 offen offset:128
    s_waitcnt vmcnt(20)
    v_mfma_f32_16x16x32_bf16 v[228:231], a[0:3], v[64:67], 0
    v_mfma_f32_16x16x32_bf16 v[232:235], a[4:7], v[64:67], 0
    s_add_u32 s32, s24, 3
    s_and_b32 s32, s32, 3
    s_mul_i32 s32, s32, 49152
    s_add_u32 s81, s32, s70
    buffer_load_dwordx4 v[112:115], v2, s[8:11], s81 offen offset:0 sc1
    v_mfma_f32_16x16x32_bf16 v[236:239], a[8:11], v[64:67], 0
    v_mfma_f32_16x16x32_bf16 v[240:243], a[12:15], v[64:67], 0
    s_add_u32 s94, s94, 4096
    s_mov_b32 m0, s94
    s_add_u32 s93, s93, 4096
    buffer_load_dwordx4 v2, s[8:11], s93 offen offset:0 lds
    v_mfma_f32_16x16x32_bf16 v[244:247], a[16:19], v[64:67], 0
    s_waitcnt vmcnt(21)
    v_mfma_f32_16x16x32_bf16 v[228:231], a[20:23], v[68:71], v[228:231]
    v_mfma_f32_16x16x32_bf16 v[232:235], a[24:27], v[68:71], v[232:235]
    buffer_load_dwordx4 v[116:119], v2, s[8:11], s81 offen offset:1024 sc1
    v_mfma_f32_16x16x32_bf16 v[236:239], a[28:31], v[68:71], v[236:239]
    v_mfma_f32_16x16x32_bf16 v[240:243], a[32:35], v[68:71], v[240:243]
    v_mfma_f32_16x16x32_bf16 v[244:247], a[36:39], v[68:71], v[244:247]
    ds_write_b128 v248, v[208:211] offset:0
    s_waitcnt vmcnt(21)
    v_mfma_f32_16x16x32_bf16 v[228:231], a[40:43], v[72:75], v[228:231]
    v_mfma_f32_16x16x32_bf16 v[232:235], a[44:47], v[72:75], v[232:235]
    buffer_load_dwordx4 v[120:123], v2, s[8:11], s81 offen offset:2048 sc1
    v_mfma_f32_16x16x32_bf16 v[236:239], a[48:51], v[72:75], v[236:239]
    v_mfma_f32_16x16x32_bf16 v[240:243], a[52:55], v[72:75], v[240:243]
    v_mfma_f32_16x16x32_bf16 v[244:247], a[56:59], v[72:75], v[244:247]
    ds_write_b128 v248, v[212:215] offset:1024
    s_waitcnt vmcnt(21)
    v_mfma_f32_16x16x32_bf16 v[228:231], a[60:63], v[76:79], v[228:231]
    v_mfma_f32_16x16x32_bf16 v[232:235], a[64:67], v[76:79], v[232:235]
    buffer_load_dwordx4 v[124:127], v2, s[8:11], s81 offen offset:3072 sc1
    v_mfma_f32_16x16x32_bf16 v[236:239], a[68:71], v[76:79], v[236:239]
    v_mfma_f32_16x16x32_bf16 v[240:243], a[72:75], v[76:79], v[240:243]
    v_mfma_f32_16x16x32_bf16 v[244:247], a[76:79], v[76:79], v[244:247]
    ds_write_b128 v248, v[216:219] offset:2048
    s_waitcnt vmcnt(21)
    v_mfma_f32_16x16x32_bf16 v[228:231], a[80:83], v[80:83], v[228:231]
    v_mfma_f32_16x16x32_bf16 v[232:235], a[84:87], v[80:83], v[232:235]
    s_add_u32 s81, s81, 4096
    buffer_load_dwordx4 v[128:131], v2, s[8:11], s81 offen offset:0 sc1
    v_mfma_f32_16x16x32_bf16 v[236:239], a[88:91], v[80:83], v[236:239]
    v_mfma_f32_16x16x32_bf16 v[240:243], a[92:95], v[80:83], v[240:243]
    buffer_load_dwordx4 v2, s[8:11], s93 offen offset:1024 lds
    v_mfma_f32_16x16x32_bf16 v[244:247], a[96:99], v[80:83], v[244:247]
    ds_write_b128 v248, v[220:223] offset:3072
    s_waitcnt vmcnt(22)
    v_mfma_f32_16x16x32_bf16 v[228:231], a[100:103], v[84:87], v[228:231]
    v_mfma_f32_16x16x32_bf16 v[232:235], a[104:107], v[84:87], v[232:235]
    buffer_load_dwordx4 v[132:135], v2, s[8:11], s81 offen offset:1024 sc1
    v_mfma_f32_16x16x32_bf16 v[236:239], a[108:111], v[84:87], v[236:239]
    v_mfma_f32_16x16x32_bf16 v[240:243], a[112:115], v[84:87], v[240:243]
    buffer_load_dwordx4 v2, s[8:11], s93 offen offset:2048 lds
    v_mfma_f32_16x16x32_bf16 v[244:247], a[116:119], v[84:87], v[244:247]
    ds_write_b128 v248, v[224:227] offset:4096
    s_waitcnt vmcnt(23)
    v_mfma_f32_16x16x32_bf16 v[228:231], a[120:123], v[88:91], v[228:231]
    v_mfma_f32_16x16x32_bf16 v[232:235], a[124:127], v[88:91], v[232:235]
    buffer_load_dwordx4 v[136:139], v2, s[8:11], s81 offen offset:2048 sc1
    v_mfma_f32_16x16x32_bf16 v[236:239], a[128:131], v[88:91], v[236:239]
    v_mfma_f32_16x16x32_bf16 v[240:243], a[132:135], v[88:91], v[240:243]
    buffer_load_dwordx4 v2, s[8:11], s93 offen offset:3072 lds
    v_mfma_f32_16x16x32_bf16 v[244:247], a[136:139], v[88:91], v[244:247]
    s_waitcnt vmcnt(24)
    v_mfma_f32_16x16x32_bf16 v[228:231], a[140:143], v[92:95], v[228:231]
    v_mfma_f32_16x16x32_bf16 v[232:235], a[144:147], v[92:95], v[232:235]
    buffer_load_dwordx4 v[140:143], v2, s[8:11], s81 offen offset:3072 sc1
    v_mfma_f32_16x16x32_bf16 v[236:239], a[148:151], v[92:95], v[236:239]
    v_mfma_f32_16x16x32_bf16 v[240:243], a[152:155], v[92:95], v[240:243]
    s_add_u32 s94, s94, 4096
    s_mov_b32 m0, s94
    s_add_u32 s93, s93, 4096
    buffer_load_dwordx4 v2, s[8:11], s93 offen offset:0 lds
    v_mfma_f32_16x16x32_bf16 v[244:247], a[156:159], v[92:95], v[244:247]
    s_waitcnt vmcnt(25)
    v_mfma_f32_16x16x32_bf16 v[228:231], a[160:163], v[96:99], v[228:231]
    v_mfma_f32_16x16x32_bf16 v[232:235], a[164:167], v[96:99], v[232:235]
    s_add_u32 s81, s81, 4096
    buffer_load_dwordx4 v[144:147], v2, s[8:11], s81 offen offset:0 sc1
    v_mfma_f32_16x16x32_bf16 v[236:239], a[168:171], v[96:99], v[236:239]
    v_mfma_f32_16x16x32_bf16 v[240:243], a[172:175], v[96:99], v[240:243]
    buffer_load_dwordx4 v2, s[8:11], s93 offen offset:1024 lds
    v_mfma_f32_16x16x32_bf16 v[244:247], a[176:179], v[96:99], v[244:247]
    s_waitcnt vmcnt(25)
    v_mfma_f32_16x16x32_bf16 v[228:231], a[180:183], v[100:103], v[228:231]
    v_mfma_f32_16x16x32_bf16 v[232:235], a[184:187], v[100:103], v[232:235]
    buffer_load_dwordx4 v[148:151], v2, s[8:11], s81 offen offset:1024 sc1
    v_mfma_f32_16x16x32_bf16 v[236:239], a[188:191], v[100:103], v[236:239]
    v_mfma_f32_16x16x32_bf16 v[240:243], a[192:195], v[100:103], v[240:243]
    v_mfma_f32_16x16x32_bf16 v[244:247], a[196:199], v[100:103], v[244:247]
    s_waitcnt vmcnt(24)
    v_mfma_f32_16x16x32_bf16 v[228:231], a[200:203], v[104:107], v[228:231]
    v_mfma_f32_16x16x32_bf16 v[232:235], a[204:207], v[104:107], v[232:235]
    buffer_load_dwordx4 v[152:155], v2, s[8:11], s81 offen offset:2048 sc1
    v_mfma_f32_16x16x32_bf16 v[236:239], a[208:211], v[104:107], v[236:239]
    v_mfma_f32_16x16x32_bf16 v[240:243], a[212:215], v[104:107], v[240:243]
    v_mfma_f32_16x16x32_bf16 v[244:247], a[216:219], v[104:107], v[244:247]
    s_waitcnt vmcnt(23)
    v_mfma_f32_16x16x32_bf16 v[228:231], a[220:223], v[108:111], v[228:231]
    v_mfma_f32_16x16x32_bf16 v[232:235], a[224:227], v[108:111], v[232:235]
    buffer_load_dwordx4 v[156:159], v2, s[8:11], s81 offen offset:3072 sc1
    v_mfma_f32_16x16x32_bf16 v[236:239], a[228:231], v[108:111], v[236:239]
    v_mfma_f32_16x16x32_bf16 v[240:243], a[232:235], v[108:111], v[240:243]
    v_mfma_f32_16x16x32_bf16 v[244:247], a[236:239], v[108:111], v[244:247]
    s_waitcnt vmcnt(17)
    v_mfma_f32_16x16x32_bf16 v[208:211], a[0:3], v[112:115], 0
    v_mfma_f32_16x16x32_bf16 v[212:215], a[4:7], v[112:115], 0
    s_add_u32 s32, s24, 4
    s_and_b32 s32, s32, 3
    s_mul_i32 s32, s32, 49152
    s_add_u32 s81, s32, s70
    buffer_load_dwordx4 v[160:163], v2, s[8:11], s81 offen offset:0 sc1
    v_mfma_f32_16x16x32_bf16 v[216:219], a[8:11], v[112:115], 0
    v_mfma_f32_16x16x32_bf16 v[220:223], a[12:15], v[112:115], 0
    buffer_load_dwordx4 v2, s[8:11], s93 offen offset:2048 lds
    v_mfma_f32_16x16x32_bf16 v[224:227], a[16:19], v[112:115], 0
    s_waitcnt vmcnt(17)
    v_mfma_f32_16x16x32_bf16 v[208:211], a[20:23], v[116:119], v[208:211]
    v_mfma_f32_16x16x32_bf16 v[212:215], a[24:27], v[116:119], v[212:215]
    buffer_load_dwordx4 v[164:167], v2, s[8:11], s81 offen offset:1024 sc1
    v_mfma_f32_16x16x32_bf16 v[216:219], a[28:31], v[116:119], v[216:219]
    v_mfma_f32_16x16x32_bf16 v[220:223], a[32:35], v[116:119], v[220:223]
    buffer_load_dwordx4 v2, s[8:11], s93 offen offset:3072 lds
    v_mfma_f32_16x16x32_bf16 v[224:227], a[36:39], v[116:119], v[224:227]
    ds_write_b128 v249, v[228:231] offset:0
    s_waitcnt vmcnt(18)
    v_mfma_f32_16x16x32_bf16 v[208:211], a[40:43], v[120:123], v[208:211]
    v_mfma_f32_16x16x32_bf16 v[212:215], a[44:47], v[120:123], v[212:215]
    buffer_load_dwordx4 v[168:171], v2, s[8:11], s81 offen offset:2048 sc1
    v_mfma_f32_16x16x32_bf16 v[216:219], a[48:51], v[120:123], v[216:219]
    v_mfma_f32_16x16x32_bf16 v[220:223], a[52:55], v[120:123], v[220:223]
    s_add_u32 s94, s94, 4096
    s_mov_b32 m0, s94
    s_add_u32 s93, s93, 4096
    buffer_load_dwordx4 v2, s[8:11], s93 offen offset:0 lds
    v_mfma_f32_16x16x32_bf16 v[224:227], a[56:59], v[120:123], v[224:227]
    ds_write_b128 v249, v[232:235] offset:1024
    s_waitcnt vmcnt(19)
    v_mfma_f32_16x16x32_bf16 v[208:211], a[60:63], v[124:127], v[208:211]
    v_mfma_f32_16x16x32_bf16 v[212:215], a[64:67], v[124:127], v[212:215]
    buffer_load_dwordx4 v[172:175], v2, s[8:11], s81 offen offset:3072 sc1
    v_mfma_f32_16x16x32_bf16 v[216:219], a[68:71], v[124:127], v[216:219]
    v_mfma_f32_16x16x32_bf16 v[220:223], a[72:75], v[124:127], v[220:223]
    buffer_load_dwordx4 v2, s[8:11], s93 offen offset:1024 lds
    v_mfma_f32_16x16x32_bf16 v[224:227], a[76:79], v[124:127], v[224:227]
    ds_write_b128 v249, v[236:239] offset:2048
    s_waitcnt vmcnt(20)
    v_mfma_f32_16x16x32_bf16 v[208:211], a[80:83], v[128:131], v[208:211]
    v_mfma_f32_16x16x32_bf16 v[212:215], a[84:87], v[128:131], v[212:215]
    s_add_u32 s81, s81, 4096
    buffer_load_dwordx4 v[176:179], v2, s[8:11], s81 offen offset:0 sc1
    v_mfma_f32_16x16x32_bf16 v[216:219], a[88:91], v[128:131], v[216:219]
    v_mfma_f32_16x16x32_bf16 v[220:223], a[92:95], v[128:131], v[220:223]
    buffer_load_dwordx4 v2, s[8:11], s93 offen offset:2048 lds
    v_mfma_f32_16x16x32_bf16 v[224:227], a[96:99], v[128:131], v[224:227]
    ds_write_b128 v249, v[240:243] offset:3072
    s_waitcnt vmcnt(20)
    v_mfma_f32_16x16x32_bf16 v[208:211], a[100:103], v[132:135], v[208:211]
    v_mfma_f32_16x16x32_bf16 v[212:215], a[104:107], v[132:135], v[212:215]
    buffer_load_dwordx4 v[180:183], v2, s[8:11], s81 offen offset:1024 sc1
    v_mfma_f32_16x16x32_bf16 v[216:219], a[108:111], v[132:135], v[216:219]
    v_mfma_f32_16x16x32_bf16 v[220:223], a[112:115], v[132:135], v[220:223]
    v_mfma_f32_16x16x32_bf16 v[224:227], a[116:119], v[132:135], v[224:227]
    ds_write_b128 v249, v[244:247] offset:4096
    s_waitcnt vmcnt(19)
    v_mfma_f32_16x16x32_bf16 v[208:211], a[120:123], v[136:139], v[208:211]
    v_mfma_f32_16x16x32_bf16 v[212:215], a[124:127], v[136:139], v[212:215]
    buffer_load_dwordx4 v[184:187], v2, s[8:11], s81 offen offset:2048 sc1
    v_mfma_f32_16x16x32_bf16 v[216:219], a[128:131], v[136:139], v[216:219]
    v_mfma_f32_16x16x32_bf16 v[220:223], a[132:135], v[136:139], v[220:223]
    v_mfma_f32_16x16x32_bf16 v[224:227], a[136:139], v[136:139], v[224:227]
    s_waitcnt vmcnt(18)
    v_mfma_f32_16x16x32_bf16 v[208:211], a[140:143], v[140:143], v[208:211]
    v_mfma_f32_16x16x32_bf16 v[212:215], a[144:147], v[140:143], v[212:215]
    buffer_load_dwordx4 v[188:191], v2, s[8:11], s81 offen offset:3072 sc1
    v_mfma_f32_16x16x32_bf16 v[216:219], a[148:151], v[140:143], v[216:219]
    v_mfma_f32_16x16x32_bf16 v[220:223], a[152:155], v[140:143], v[220:223]
    v_mfma_f32_16x16x32_bf16 v[224:227], a[156:159], v[140:143], v[224:227]
    s_waitcnt vmcnt(17)
    v_mfma_f32_16x16x32_bf16 v[208:211], a[160:163], v[144:147], v[208:211]
    v_mfma_f32_16x16x32_bf16 v[212:215], a[164:167], v[144:147], v[212:215]
    s_add_u32 s81, s81, 4096
    buffer_load_dwordx4 v[192:195], v2, s[8:11], s81 offen offset:0 sc1
    v_mfma_f32_16x16x32_bf16 v[216:219], a[168:171], v[144:147], v[216:219]
    v_mfma_f32_16x16x32_bf16 v[220:223], a[172:175], v[144:147], v[220:223]
    buffer_load_dwordx4 v2, s[8:11], s93 offen offset:3072 lds
    v_mfma_f32_16x16x32_bf16 v[224:227], a[176:179], v[144:147], v[224:227]
    s_waitcnt vmcnt(17)
    v_mfma_f32_16x16x32_bf16 v[208:211], a[180:183], v[148:151], v[208:211]
    v_mfma_f32_16x16x32_bf16 v[212:215], a[184:187], v[148:151], v[212:215]
    buffer_load_dwordx4 v[196:199], v2, s[8:11], s81 offen offset:1024 sc1
    v_mfma_f32_16x16x32_bf16 v[216:219], a[188:191], v[148:151], v[216:219]
    v_mfma_f32_16x16x32_bf16 v[220:223], a[192:195], v[148:151], v[220:223]
    s_add_u32 s94, s94, 4096
    s_mov_b32 m0, s94
    s_add_u32 s93, s93, 4096
    buffer_load_dwordx4 v2, s[8:11], s93 offen offset:0 lds
    v_mfma_f32_16x16x32_bf16 v[224:227], a[196:199], v[148:151], v[224:227]
    s_waitcnt vmcnt(18)
    v_mfma_f32_16x16x32_bf16 v[208:211], a[200:203], v[152:155], v[208:211]
    v_mfma_f32_16x16x32_bf16 v[212:215], a[204:207], v[152:155], v[212:215]
    buffer_load_dwordx4 v[200:203], v2, s[8:11], s81 offen offset:2048 sc1
    v_mfma_f32_16x16x32_bf16 v[216:219], a[208:211], v[152:155], v[216:219]
    v_mfma_f32_16x16x32_bf16 v[220:223], a[212:215], v[152:155], v[220:223]
    buffer_load_dwordx4 v2, s[8:11], s93 offen offset:1024 lds
    v_mfma_f32_16x16x32_bf16 v[224:227], a[216:219], v[152:155], v[224:227]
    s_waitcnt vmcnt(19)
    v_mfma_f32_16x16x32_bf16 v[208:211], a[220:223], v[156:159], v[208:211]
    v_mfma_f32_16x16x32_bf16 v[212:215], a[224:227], v[156:159], v[212:215]
    buffer_load_dwordx4 v[204:207], v2, s[8:11], s81 offen offset:3072 sc1
    v_mfma_f32_16x16x32_bf16 v[216:219], a[228:231], v[156:159], v[216:219]
    v_mfma_f32_16x16x32_bf16 v[220:223], a[232:235], v[156:159], v[220:223]
    buffer_load_dwordx4 v2, s[8:11], s93 offen offset:2048 lds
    v_mfma_f32_16x16x32_bf16 v[224:227], a[236:239], v[156:159], v[224:227]
    s_waitcnt vmcnt(20)
    v_mfma_f32_16x16x32_bf16 v[228:231], a[0:3], v[160:163], 0
    v_mfma_f32_16x16x32_bf16 v[232:235], a[4:7], v[160:163], 0
    v_mfma_f32_16x16x32_bf16 v[236:239], a[8:11], v[160:163], 0
    v_mfma_f32_16x16x32_bf16 v[240:243], a[12:15], v[160:163], 0
    buffer_load_dwordx4 v2, s[8:11], s93 offen offset:3072 lds
    v_mfma_f32_16x16x32_bf16 v[244:247], a[16:19], v[160:163], 0
    s_waitcnt vmcnt(19)
    v_mfma_f32_16x16x32_bf16 v[228:231], a[20:23], v[164:167], v[228:231]
    v_mfma_f32_16x16x32_bf16 v[232:235], a[24:27], v[164:167], v[232:235]
    v_mfma_f32_16x16x32_bf16 v[236:239], a[28:31], v[164:167], v[236:239]
    v_mfma_f32_16x16x32_bf16 v[240:243], a[32:35], v[164:167], v[240:243]
    v_mfma_f32_16x16x32_bf16 v[244:247], a[36:39], v[164:167], v[244:247]
    ds_write_b128 v250, v[208:211] offset:0
    s_waitcnt vmcnt(17)
    v_mfma_f32_16x16x32_bf16 v[228:231], a[40:43], v[168:171], v[228:231]
    v_mfma_f32_16x16x32_bf16 v[232:235], a[44:47], v[168:171], v[232:235]
    v_mfma_f32_16x16x32_bf16 v[236:239], a[48:51], v[168:171], v[236:239]
    v_mfma_f32_16x16x32_bf16 v[240:243], a[52:55], v[168:171], v[240:243]
    v_mfma_f32_16x16x32_bf16 v[244:247], a[56:59], v[168:171], v[244:247]
    ds_write_b128 v250, v[212:215] offset:1024
    s_waitcnt vmcnt(15)
    v_mfma_f32_16x16x32_bf16 v[228:231], a[60:63], v[172:175], v[228:231]
    v_mfma_f32_16x16x32_bf16 v[232:235], a[64:67], v[172:175], v[232:235]
    v_mfma_f32_16x16x32_bf16 v[236:239], a[68:71], v[172:175], v[236:239]
    v_mfma_f32_16x16x32_bf16 v[240:243], a[72:75], v[172:175], v[240:243]
    v_mfma_f32_16x16x32_bf16 v[244:247], a[76:79], v[172:175], v[244:247]
    ds_write_b128 v250, v[216:219] offset:2048
    s_waitcnt vmcnt(13)
    v_mfma_f32_16x16x32_bf16 v[228:231], a[80:83], v[176:179], v[228:231]
    v_mfma_f32_16x16x32_bf16 v[232:235], a[84:87], v[176:179], v[232:235]
    v_mfma_f32_16x16x32_bf16 v[236:239], a[88:91], v[176:179], v[236:239]
    v_mfma_f32_16x16x32_bf16 v[240:243], a[92:95], v[176:179], v[240:243]
    s_add_u32 s94, s94, 4096
    s_mov_b32 m0, s94
    s_add_u32 s93, s93, 4096
    buffer_load_dwordx4 v2, s[8:11], s93 offen offset:0 lds
    v_mfma_f32_16x16x32_bf16 v[244:247], a[96:99], v[176:179], v[244:247]
    ds_write_b128 v250, v[220:223] offset:3072
    s_waitcnt vmcnt(12)
    v_mfma_f32_16x16x32_bf16 v[228:231], a[100:103], v[180:183], v[228:231]
    v_mfma_f32_16x16x32_bf16 v[232:235], a[104:107], v[180:183], v[232:235]
    v_mfma_f32_16x16x32_bf16 v[236:239], a[108:111], v[180:183], v[236:239]
    v_mfma_f32_16x16x32_bf16 v[240:243], a[112:115], v[180:183], v[240:243]
    buffer_load_dwordx4 v2, s[8:11], s93 offen offset:1024 lds
    v_mfma_f32_16x16x32_bf16 v[244:247], a[116:119], v[180:183], v[244:247]
    ds_write_b128 v250, v[224:227] offset:4096
    s_waitcnt vmcnt(12)
    v_mfma_f32_16x16x32_bf16 v[228:231], a[120:123], v[184:187], v[228:231]
    v_mfma_f32_16x16x32_bf16 v[232:235], a[124:127], v[184:187], v[232:235]
    v_mfma_f32_16x16x32_bf16 v[236:239], a[128:131], v[184:187], v[236:239]
    v_mfma_f32_16x16x32_bf16 v[240:243], a[132:135], v[184:187], v[240:243]
    buffer_load_dwordx4 v2, s[8:11], s93 offen offset:2048 lds
    v_mfma_f32_16x16x32_bf16 v[244:247], a[136:139], v[184:187], v[244:247]
    s_waitcnt vmcnt(12)
    v_mfma_f32_16x16x32_bf16 v[228:231], a[140:143], v[188:191], v[228:231]
    v_mfma_f32_16x16x32_bf16 v[232:235], a[144:147], v[188:191], v[232:235]
    v_mfma_f32_16x16x32_bf16 v[236:239], a[148:151], v[188:191], v[236:239]
    v_mfma_f32_16x16x32_bf16 v[240:243], a[152:155], v[188:191], v[240:243]
    buffer_load_dwordx4 v2, s[8:11], s93 offen offset:3072 lds
    v_mfma_f32_16x16x32_bf16 v[244:247], a[156:159], v[188:191], v[244:247]
    s_waitcnt vmcnt(12)
    v_mfma_f32_16x16x32_bf16 v[228:231], a[160:163], v[192:195], v[228:231]
    v_mfma_f32_16x16x32_bf16 v[232:235], a[164:167], v[192:195], v[232:235]
    v_mfma_f32_16x16x32_bf16 v[236:239], a[168:171], v[192:195], v[236:239]
    v_mfma_f32_16x16x32_bf16 v[240:243], a[172:175], v[192:195], v[240:243]
    s_add_u32 s94, s94, 4096
    s_mov_b32 m0, s94
    s_add_u32 s93, s93, 4096
    buffer_load_dwordx4 v2, s[8:11], s93 offen offset:0 lds
    v_mfma_f32_16x16x32_bf16 v[244:247], a[176:179], v[192:195], v[244:247]
    s_waitcnt vmcnt(11)
    v_mfma_f32_16x16x32_bf16 v[228:231], a[180:183], v[196:199], v[228:231]
    v_mfma_f32_16x16x32_bf16 v[232:235], a[184:187], v[196:199], v[232:235]
    v_mfma_f32_16x16x32_bf16 v[236:239], a[188:191], v[196:199], v[236:239]
    v_mfma_f32_16x16x32_bf16 v[240:243], a[192:195], v[196:199], v[240:243]
    v_mfma_f32_16x16x32_bf16 v[244:247], a[196:199], v[196:199], v[244:247]
    s_waitcnt vmcnt(9)
    v_mfma_f32_16x16x32_bf16 v[228:231], a[200:203], v[200:203], v[228:231]
    v_mfma_f32_16x16x32_bf16 v[232:235], a[204:207], v[200:203], v[232:235]
    v_mfma_f32_16x16x32_bf16 v[236:239], a[208:211], v[200:203], v[236:239]
    v_mfma_f32_16x16x32_bf16 v[240:243], a[212:215], v[200:203], v[240:243]
    v_mfma_f32_16x16x32_bf16 v[244:247], a[216:219], v[200:203], v[244:247]
    s_waitcnt vmcnt(7)
    v_mfma_f32_16x16x32_bf16 v[228:231], a[220:223], v[204:207], v[228:231]
    v_mfma_f32_16x16x32_bf16 v[232:235], a[224:227], v[204:207], v[232:235]
    v_mfma_f32_16x16x32_bf16 v[236:239], a[228:231], v[204:207], v[236:239]
    v_mfma_f32_16x16x32_bf16 v[240:243], a[232:235], v[204:207], v[240:243]
    v_mfma_f32_16x16x32_bf16 v[244:247], a[236:239], v[204:207], v[244:247]
    s_branch L_dl_p5_j
L_dl_p5_1:
    s_add_u32 s32, s24, 1
    s_and_b32 s32, s32, 3
    s_mul_i32 s32, s32, 49152
    s_add_u32 s81, s32, s70
    buffer_load_dwordx4 v[16:19], v2, s[8:11], s81 offen offset:0 sc1
    buffer_load_dwordx4 v[20:23], v2, s[8:11], s81 offen offset:1024 sc1
    buffer_load_dwordx4 v[24:27], v2, s[8:11], s81 offen offset:2048 sc1
    buffer_load_dwordx4 v[28:31], v2, s[8:11], s81 offen offset:3072 sc1
    s_add_u32 s81, s81, 4096
    buffer_load_dwordx4 v[32:35], v2, s[8:11], s81 offen offset:0 sc1
    buffer_load_dwordx4 v[36:39], v2, s[8:11], s81 offen offset:1024 sc1
    buffer_load_dwordx4 v[40:43], v2, s[8:11], s81 offen offset:2048 sc1
    buffer_load_dwordx4 v[44:47], v2, s[8:11], s81 offen offset:3072 sc1
    s_add_u32 s81, s81, 4096
    buffer_load_dwordx4 v[48:51], v2, s[8:11], s81 offen offset:0 sc1
    buffer_load_dwordx4 v[52:55], v2, s[8:11], s81 offen offset:1024 sc1
    buffer_load_dwordx4 v[56:59], v2, s[8:11], s81 offen offset:2048 sc1
    buffer_load_dwordx4 v[60:63], v2, s[8:11], s81 offen offset:3072 sc1
    s_waitcnt vmcnt(11)
    v_mfma_f32_16x16x32_bf16 v[208:211], a[0:3], v[16:19], 0
    v_mfma_f32_16x16x32_bf16 v[212:215], a[4:7], v[16:19], 0
    s_add_u32 s32, s24, 2
    s_and_b32 s32, s32, 3
    s_mul_i32 s32, s32, 49152
    s_add_u32 s81, s32, s70
    buffer_load_dwordx4 v[64:67], v2, s[8:11], s81 offen offset:0 sc1
    v_mfma_f32_16x16x32_bf16 v[216:219], a[8:11], v[16:19], 0
    v_mfma_f32_16x16x32_bf16 v[220:223], a[12:15], v[16:19], 0
    v_mfma_f32_16x16x32_bf16 v[224:227], a[16:19], v[16:19], 0
    s_waitcnt vmcnt(11)
    v_mfma_f32_16x16x32_bf16 v[208:211], a[20:23], v[20:23], v[208:211]
    v_mfma_f32_16x16x32_bf16 v[212:215], a[24:27], v[20:23], v[212:215]
    buffer_load_dwordx4 v[68:71], v2, s[8:11], s81 offen offset:1024 sc1
    v_mfma_f32_16x16x32_bf16 v[216:219], a[28:31], v[20:23], v[216:219]
    v_mfma_f32_16x16x32_bf16 v[220:223], a[32:35], v[20:23], v[220:223]
    v_mfma_f32_16x16x32_bf16 v[224:227], a[36:39], v[20:23], v[224:227]
    s_waitcnt vmcnt(11)
    v_mfma_f32_16x16x32_bf16 v[208:211], a[40:43], v[24:27], v[208:211]
    v_mfma_f32_16x16x32_bf16 v[212:215], a[44:47], v[24:27], v[212:215]
    buffer_load_dwordx4 v[72:75], v2, s[8:11], s81 offen offset:2048 sc1
    v_mfma_f32_16x16x32_bf16 v[216:219], a[48:51], v[24:27], v[216:219]
    v_mfma_f32_16x16x32_bf16 v[220:223], a[52:55], v[24:27], v[220:223]
    v_mfma_f32_16x16x32_bf16 v[224:227], a[56:59], v[24:27], v[224:227]
    s_waitcnt vmcnt(11)
    v_mfma_f32_16x16x32_bf16 v[208:211], a[60:63], v[28:31], v[208:211]
    v_mfma_f32_16x16x32_bf16 v[212:215], a[64:67], v[28:31], v[212:215]
    buffer_load_dwordx4 v[76:79], v2, s[8:11], s81 offen offset:3072 sc1
    v_mfma_f32_16x16x32_bf16 v[216:219], a[68:71], v[28:31], v[216:219]
    v_mfma_f32_16x16x32_bf16 v[220:223], a[72:75], v[28:31], v[220:223]
    v_mfma_f32_16x16x32_bf16 v[224:227], a[76:79], v[28:31], v[224:227]
    s_waitcnt vmcnt(11)
    v_mfma_f32_16x16x32_bf16 v[208:211], a[80:83], v[32:35], v[208:211]
    v_mfma_f32_16x16x32_bf16 v[212:215], a[84:87], v[32:35], v[212:215]
    s_add_u32 s81, s81, 4096
    buffer_load_dwordx4 v[80:83], v2, s[8:11], s81 offen offset:0 sc1
    v_mfma_f32_16x16x32_bf16 v[216:219], a[88:91], v[32:35], v[216:219]
    v_mfma_f32_16x16x32_bf16 v[220:223], a[92:95], v[32:35], v[220:223]
    v_mfma_f32_16x16x32_bf16 v[224:227], a[96:99], v[32:35], v[224:227]
    s_waitcnt vmcnt(11)
    v_mfma_f32_16x16x32_bf16 v[208:211], a[100:103], v[36:39], v[208:211]
    v_mfma_f32_16x16x32_bf16 v[212:215], a[104:107], v[36:39], v[212:215]
    buffer_load_dwordx4 v[84:87], v2, s[8:11], s81 offen offset:1024 sc1
    v_mfma_f32_16x16x32_bf16 v[216:219], a[108:111], v[36:39], v[216:219]
    v_mfma_f32_16x16x32_bf16 v[220:223], a[112:115], v[36:39], v[220:223]
    v_mfma_f32_16x16x32_bf16 v[224:227], a[116:119], v[36:39], v[224:227]
    s_waitcnt vmcnt(11)
    v_mfma_f32_16x16x32_bf16 v[208:211], a[120:123], v[40:43], v[208:211]
    v_mfma_f32_16x16x32_bf16 v[212:215], a[124:127], v[40:43], v[212:215]
    buffer_load_dwordx4 v[88:91], v2, s[8:11], s81 offen offset:2048 sc1
    v_mfma_f32_16x16x32_bf16 v[216:219], a[128:131], v[40:43], v[216:219]
    v_mfma_f32_16x16x32_bf16 v[220:223], a[132:135], v[40:43], v[220:223]
    v_mfma_f32_16x16x32_bf16 v[224:227], a[136:139], v[40:43], v[224:227]
    s_waitcnt vmcnt(11)
    v_mfma_f32_16x16x32_bf16 v[208:211], a[140:143], v[44:47], v[208:211]
    v_mfma_f32_16x16x32_bf16 v[212:215], a[144:147], v[44:47], v[212:215]
    buffer_load_dwordx4 v[92:95], v2, s[8:11], s81 offen offset:3072 sc1
    v_mfma_f32_16x16x32_bf16 v[216:219], a[148:151], v[44:47], v[216:219]
    v_mfma_f32_16x16x32_bf16 v[220:223], a[152:155], v[44:47], v[220:223]
    v_mfma_f32_16x16x32_bf16 v[224:227], a[156:159], v[44:47], v[224:227]
    s_waitcnt vmcnt(11)
    v_mfma_f32_16x16x32_bf16 v[208:211], a[160:163], v[48:51], v[208:211]
    v_mfma_f32_16x16x32_bf16 v[212:215], a[164:167], v[48:51], v[212:215]
    s_add_u32 s81, s81, 4096
    buffer_load_dwordx4 v[96:99], v2, s[8:11], s81 offen offset:0 sc1
    v_mfma_f32_16x16x32_bf16 v[216:219], a[168:171], v[48:51], v[216:219]
    v_mfma_f32_16x16x32_bf16 v[220:223], a[172:175], v[48:51], v[220:223]
    v_mfma_f32_16x16x32_bf16 v[224:227], a[176:179], v[48:51], v[224:227]
    s_waitcnt vmcnt(11)
    v_mfma_f32_16x16x32_bf16 v[208:211], a[180:183], v[52:55], v[208:211]
    v_mfma_f32_16x16x32_bf16 v[212:215], a[184:187], v[52:55], v[212:215]
    buffer_load_dwordx4 v[100:103], v2, s[8:11], s81 offen offset:1024 sc1
    v_mfma_f32_16x16x32_bf16 v[216:219], a[188:191], v[52:55], v[216:219]
    v_mfma_f32_16x16x32_bf16 v[220:223], a[192:195], v[52:55], v[220:223]
    v_mfma_f32_16x16x32_bf16 v[224:227], a[196:199], v[52:55], v[224:227]
    s_waitcnt vmcnt(11)
    v_mfma_f32_16x16x32_bf16 v[208:211], a[200:203], v[56:59], v[208:211]
    v_mfma_f32_16x16x32_bf16 v[212:215], a[204:207], v[56:59], v[212:215]
    buffer_load_dwordx4 v[104:107], v2, s[8:11], s81 offen offset:2048 sc1
    v_mfma_f32_16x16x32_bf16 v[216:219], a[208:211], v[56:59], v[216:219]
    v_mfma_f32_16x16x32_bf16 v[220:223], a[212:215], v[56:59], v[220:223]
    v_mfma_f32_16x16x32_bf16 v[224:227], a[216:219], v[56:59], v[224:227]
    s_waitcnt vmcnt(11)
    v_mfma_f32_16x16x32_bf16 v[208:211], a[220:223], v[60:63], v[208:211]
    v_mfma_f32_16x16x32_bf16 v[212:215], a[224:227], v[60:63], v[212:215]
    buffer_load_dwordx4 v[108:111], v2, s[8:11], s81 offen offset:3072 sc1
    v_mfma_f32_16x16x32_bf16 v[216:219], a[228:231], v[60:63], v[216:219]
    v_mfma_f32_16x16x32_bf16 v[220:223], a[232:235], v[60:63], v[220:223]
    v_mfma_f32_16x16x32_bf16 v[224:227], a[236:239], v[60:63], v[224:227]
    v_lshrrev_b32 v252, 4, v1
    v_lshlrev_b32 v252, 3, v252
    s_mul_i32 s33, s28, 160
    buffer_load_dwordx2 v[16:17], v252, s[12:15], s33 offen offset:0
    buffer_load_dwordx2 v[18:19], v252, s[12:15], s33 offen offset:32
    buffer_load_dwordx2 v[20:21], v252, s[12:15], s33 offen offset:64
    buffer_load_dwordx2 v[22:23], v252, s[12:15], s33 offen offset:96
    buffer_load_dwordx2 v[24:25], v252, s[12:15], s33 offen offset:128
    s_waitcnt vmcnt(16)
    v_mfma_f32_16x16x32_bf16 v[228:231], a[0:3], v[64:67], 0
    v_mfma_f32_16x16x32_bf16 v[232:235], a[4:7], v[64:67], 0
    s_add_u32 s32, s24, 3
    s_and_b32 s32, s32, 3
    s_mul_i32 s32, s32, 49152
    s_add_u32 s81, s32, s70
    buffer_load_dwordx4 v[112:115], v2, s[8:11], s81 offen offset:0 sc1
    v_mfma_f32_16x16x32_bf16 v[236:239], a[8:11], v[64:67], 0
    v_mfma_f32_16x16x32_bf16 v[240:243], a[12:15], v[64:67], 0
    v_mfma_f32_16x16x32_bf16 v[244:247], a[16:19], v[64:67], 0
    s_waitcnt vmcnt(16)
    v_mfma_f32_16x16x32_bf16 v[228:231], a[20:23], v[68:71], v[228:231]
    v_mfma_f32_16x16x32_bf16 v[232:235], a[24:27], v[68:71], v[232:235]
    buffer_load_dwordx4 v[116:119], v2, s[8:11], s81 offen offset:1024 sc1
    v_mfma_f32_16x16x32_bf16 v[236:239], a[28:31], v[68:71], v[236:239]
    v_mfma_f32_16x16x32_bf16 v[240:243], a[32:35], v[68:71], v[240:243]
    v_mfma_f32_16x16x32_bf16 v[244:247], a[36:39], v[68:71], v[244:247]
    ds_write_b128 v248, v[208:211] offset:0
    s_waitcnt vmcnt(16)
    v_mfma_f32_16x16x32_bf16 v[228:231], a[40:43], v[72:75], v[228:231]
    v_mfma_f32_16x16x32_bf16 v[232:235], a[44:47], v[72:75], v[232:235]
    buffer_load_dwordx4 v[120:123], v2, s[8:11], s81 offen offset:2048 sc1
    v_mfma_f32_16x16x32_bf16 v[236:239], a[48:51], v[72:75], v[236:239]
    v_mfma_f32_16x16x32_bf16 v[240:243], a[52:55], v[72:75], v[240:243]
    v_mfma_f32_16x16x32_bf16 v[244:247], a[56:59], v[72:75], v[244:247]
    ds_write_b128 v248, v[212:215] offset:1024
    s_waitcnt vmcnt(16)
    v_mfma_f32_16x16x32_bf16 v[228:231], a[60:63], v[76:79], v[228:231]
    v_mfma_f32_16x16x32_bf16 v[232:235], a[64:67], v[76:79], v[232:235]
    buffer_load_dwordx4 v[124:127], v2, s[8:11], s81 offen offset:3072 sc1
    v_mfma_f32_16x16x32_bf16 v[236:239], a[68:71], v[76:79], v[236:239]
    v_mfma_f32_16x16x32_bf16 v[240:243], a[72:75], v[76:79], v[240:243]
    v_mfma_f32_16x16x32_bf16 v[244:247], a[76:79], v[76:79], v[244:247]
    ds_write_b128 v248, v[216:219] offset:2048
    s_waitcnt vmcnt(16)
    v_mfma_f32_16x16x32_bf16 v[228:231], a[80:83], v[80:83], v[228:231]
    v_mfma_f32_16x16x32_bf16 v[232:235], a[84:87], v[80:83], v[232:235]
    s_add_u32 s81, s81, 4096
    buffer_load_dwordx4 v[128:131], v2, s[8:11], s81 offen offset:0 sc1
    v_mfma_f32_16x16x32_bf16 v[236:239], a[88:91], v[80:83], v[236:239]
    v_mfma_f32_16x16x32_bf16 v[240:243], a[92:95], v[80:83], v[240:243]
    v_mfma_f32_16x16x32_bf16 v[244:247], a[96:99], v[80:83], v[244:247]
    ds_write_b128 v248, v[220:223] offset:3072
    s_waitcnt vmcnt(16)
    v_mfma_f32_16x16x32_bf16 v[228:231], a[100:103], v[84:87], v[228:231]
    v_mfma_f32_16x16x32_bf16 v[232:235], a[104:107], v[84:87], v[232:235]
    buffer_load_dwordx4 v[132:135], v2, s[8:11], s81 offen offset:1024 sc1
    v_mfma_f32_16x16x32_bf16 v[236:239], a[108:111], v[84:87], v[236:239]
    v_mfma_f32_16x16x32_bf16 v[240:243], a[112:115], v[84:87], v[240:243]
    v_mfma_f32_16x16x32_bf16 v[244:247], a[116:119], v[84:87], v[244:247]
    ds_write_b128 v248, v[224:227] offset:4096
    s_waitcnt vmcnt(16)
    v_mfma_f32_16x16x32_bf16 v[228:231], a[120:123], v[88:91], v[228:231]
    v_mfma_f32_16x16x32_bf16 v[232:235], a[124:127], v[88:91], v[232:235]
    buffer_load_dwordx4 v[136:139], v2, s[8:11], s81 offen offset:2048 sc1
    v_mfma_f32_16x16x32_bf16 v[236:239], a[128:131], v[88:91], v[236:239]
    v_mfma_f32_16x16x32_bf16 v[240:243], a[132:135], v[88:91], v[240:243]
    v_mfma_f32_16x16x32_bf16 v[244:247], a[136:139], v[88:91], v[244:247]
    s_waitcnt vmcnt(16)
    v_mfma_f32_16x16x32_bf16 v[228:231], a[140:143], v[92:95], v[228:231]
    v_mfma_f32_16x16x32_bf16 v[232:235], a[144:147], v[92:95], v[232:235]
    buffer_load_dwordx4 v[140:143], v2, s[8:11], s81 offen offset:3072 sc1
    v_mfma_f32_16x16x32_bf16 v[236:239], a[148:151], v[92:95], v[236:239]
    v_mfma_f32_16x16x32_bf16 v[240:243], a[152:155], v[92:95], v[240:243]
    v_mfma_f32_16x16x32_bf16 v[244:247], a[156:159], v[92:95], v[244:247]
    s_waitcnt vmcnt(16)
    v_mfma_f32_16x16x32_bf16 v[228:231], a[160:163], v[96:99], v[228:231]
    v_mfma_f32_16x16x32_bf16 v[232:235], a[164:167], v[96:99], v[232:235]
    s_add_u32 s81, s81, 4096
    buffer_load_dwordx4 v[144:147], v2, s[8:11], s81 offen offset:0 sc1
    v_mfma_f32_16x16x32_bf16 v[236:239], a[168:171], v[96:99], v[236:239]
    v_mfma_f32_16x16x32_bf16 v[240:243], a[172:175], v[96:99], v[240:243]
    v_mfma_f32_16x16x32_bf16 v[244:247], a[176:179], v[96:99], v[244:247]
    s_waitcnt vmcnt(16)
    v_mfma_f32_16x16x32_bf16 v[228:231], a[180:183], v[100:103], v[228:231]
    v_mfma_f32_16x16x32_bf16 v[232:235], a[184:187], v[100:103], v[232:235]
    buffer_load_dwordx4 v[148:151], v2, s[8:11], s81 offen offset:1024 sc1
    v_mfma_f32_16x16x32_bf16 v[236:239], a[188:191], v[100:103], v[236:239]
    v_mfma_f32_16x16x32_bf16 v[240:243], a[192:195], v[100:103], v[240:243]
    v_mfma_f32_16x16x32_bf16 v[244:247], a[196:199], v[100:103], v[244:247]
    s_waitcnt vmcnt(16)
    v_mfma_f32_16x16x32_bf16 v[228:231], a[200:203], v[104:107], v[228:231]
    v_mfma_f32_16x16x32_bf16 v[232:235], a[204:207], v[104:107], v[232:235]
    buffer_load_dwordx4 v[152:155], v2, s[8:11], s81 offen offset:2048 sc1
    v_mfma_f32_16x16x32_bf16 v[236:239], a[208:211], v[104:107], v[236:239]
    v_mfma_f32_16x16x32_bf16 v[240:243], a[212:215], v[104:107], v[240:243]
    v_mfma_f32_16x16x32_bf16 v[244:247], a[216:219], v[104:107], v[244:247]
    s_waitcnt vmcnt(16)
    v_mfma_f32_16x16x32_bf16 v[228:231], a[220:223], v[108:111], v[228:231]
    v_mfma_f32_16x16x32_bf16 v[232:235], a[224:227], v[108:111], v[232:235]
    buffer_load_dwordx4 v[156:159], v2, s[8:11], s81 offen offset:3072 sc1
    v_mfma_f32_16x16x32_bf16 v[236:239], a[228:231], v[108:111], v[236:239]
    v_mfma_f32_16x16x32_bf16 v[240:243], a[232:235], v[108:111], v[240:243]
    v_mfma_f32_16x16x32_bf16 v[244:247], a[236:239], v[108:111], v[244:247]
    s_waitcnt vmcnt(11)
    v_mfma_f32_16x16x32_bf16 v[208:211], a[0:3], v[112:115], 0
    v_mfma_f32_16x16x32_bf16 v[212:215], a[4:7], v[112:115], 0
    s_add_u32 s32, s24, 4
    s_and_b32 s32, s32, 3
    s_mul_i32 s32, s32, 49152
    s_add_u32 s81, s32, s70
    buffer_load_dwordx4 v[160:163], v2, s[8:11], s81 offen offset:0 sc1
    v_mfma_f32_16x16x32_bf16 v[216:219], a[8:11], v[112:115], 0
    v_mfma_f32_16x16x32_bf16 v[220:223], a[12:15], v[112:115], 0
    v_mfma_f32_16x16x32_bf16 v[224:227], a[16:19], v[112:115], 0
    s_waitcnt vmcnt(11)
    v_mfma_f32_16x16x32_bf16 v[208:211], a[20:23], v[116:119], v[208:211]
    v_mfma_f32_16x16x32_bf16 v[212:215], a[24:27], v[116:119], v[212:215]
    buffer_load_dwordx4 v[164:167], v2, s[8:11], s81 offen offset:1024 sc1
    v_mfma_f32_16x16x32_bf16 v[216:219], a[28:31], v[116:119], v[216:219]
    v_mfma_f32_16x16x32_bf16 v[220:223], a[32:35], v[116:119], v[220:223]
    v_mfma_f32_16x16x32_bf16 v[224:227], a[36:39], v[116:119], v[224:227]
    ds_write_b128 v249, v[228:231] offset:0
    s_waitcnt vmcnt(11)
    v_mfma_f32_16x16x32_bf16 v[208:211], a[40:43], v[120:123], v[208:211]
    v_mfma_f32_16x16x32_bf16 v[212:215], a[44:47], v[120:123], v[212:215]
    buffer_load_dwordx4 v[168:171], v2, s[8:11], s81 offen offset:2048 sc1
    v_mfma_f32_16x16x32_bf16 v[216:219], a[48:51], v[120:123], v[216:219]
    v_mfma_f32_16x16x32_bf16 v[220:223], a[52:55], v[120:123], v[220:223]
    v_mfma_f32_16x16x32_bf16 v[224:227], a[56:59], v[120:123], v[224:227]
    ds_write_b128 v249, v[232:235] offset:1024
    s_waitcnt vmcnt(11)
    v_mfma_f32_16x16x32_bf16 v[208:211], a[60:63], v[124:127], v[208:211]
    v_mfma_f32_16x16x32_bf16 v[212:215], a[64:67], v[124:127], v[212:215]
    buffer_load_dwordx4 v[172:175], v2, s[8:11], s81 offen offset:3072 sc1
    v_mfma_f32_16x16x32_bf16 v[216:219], a[68:71], v[124:127], v[216:219]
    v_mfma_f32_16x16x32_bf16 v[220:223], a[72:75], v[124:127], v[220:223]
    v_mfma_f32_16x16x32_bf16 v[224:227], a[76:79], v[124:127], v[224:227]
    ds_write_b128 v249, v[236:239] offset:2048
    s_waitcnt vmcnt(11)
    v_mfma_f32_16x16x32_bf16 v[208:211], a[80:83], v[128:131], v[208:211]
    v_mfma_f32_16x16x32_bf16 v[212:215], a[84:87], v[128:131], v[212:215]
    s_add_u32 s81, s81, 4096
    buffer_load_dwordx4 v[176:179], v2, s[8:11], s81 offen offset:0 sc1
    v_mfma_f32_16x16x32_bf16 v[216:219], a[88:91], v[128:131], v[216:219]
    v_mfma_f32_16x16x32_bf16 v[220:223], a[92:95], v[128:131], v[220:223]
    v_mfma_f32_16x16x32_bf16 v[224:227], a[96:99], v[128:131], v[224:227]
    ds_write_b128 v249, v[240:243] offset:3072
    s_waitcnt vmcnt(11)
    v_mfma_f32_16x16x32_bf16 v[208:211], a[100:103], v[132:135], v[208:211]
    v_mfma_f32_16x16x32_bf16 v[212:215], a[104:107], v[132:135], v[212:215]
    buffer_load_dwordx4 v[180:183], v2, s[8:11], s81 offen offset:1024 sc1
    v_mfma_f32_16x16x32_bf16 v[216:219], a[108:111], v[132:135], v[216:219]
    v_mfma_f32_16x16x32_bf16 v[220:223], a[112:115], v[132:135], v[220:223]
    v_mfma_f32_16x16x32_bf16 v[224:227], a[116:119], v[132:135], v[224:227]
    ds_write_b128 v249, v[244:247] offset:4096
    s_waitcnt vmcnt(11)
    v_mfma_f32_16x16x32_bf16 v[208:211], a[120:123], v[136:139], v[208:211]
    v_mfma_f32_16x16x32_bf16 v[212:215], a[124:127], v[136:139], v[212:215]
    buffer_load_dwordx4 v[184:187], v2, s[8:11], s81 offen offset:2048 sc1
    v_mfma_f32_16x16x32_bf16 v[216:219], a[128:131], v[136:139], v[216:219]
    v_mfma_f32_16x16x32_bf16 v[220:223], a[132:135], v[136:139], v[220:223]
    v_mfma_f32_16x16x32_bf16 v[224:227], a[136:139], v[136:139], v[224:227]
    s_waitcnt vmcnt(11)
    v_mfma_f32_16x16x32_bf16 v[208:211], a[140:143], v[140:143], v[208:211]
    v_mfma_f32_16x16x32_bf16 v[212:215], a[144:147], v[140:143], v[212:215]
    buffer_load_dwordx4 v[188:191], v2, s[8:11], s81 offen offset:3072 sc1
    v_mfma_f32_16x16x32_bf16 v[216:219], a[148:151], v[140:143], v[216:219]
    v_mfma_f32_16x16x32_bf16 v[220:223], a[152:155], v[140:143], v[220:223]
    v_mfma_f32_16x16x32_bf16 v[224:227], a[156:159], v[140:143], v[224:227]
    s_waitcnt vmcnt(11)
    v_mfma_f32_16x16x32_bf16 v[208:211], a[160:163], v[144:147], v[208:211]
    v_mfma_f32_16x16x32_bf16 v[212:215], a[164:167], v[144:147], v[212:215]
    s_add_u32 s81, s81, 4096
    buffer_load_dwordx4 v[192:195], v2, s[8:11], s81 offen offset:0 sc1
    v_mfma_f32_16x16x32_bf16 v[216:219], a[168:171], v[144:147], v[216:219]
    v_mfma_f32_16x16x32_bf16 v[220:223], a[172:175], v[144:147], v[220:223]
    v_mfma_f32_16x16x32_bf16 v[224:227], a[176:179], v[144:147], v[224:227]
    s_waitcnt vmcnt(11)
    v_mfma_f32_16x16x32_bf16 v[208:211], a[180:183], v[148:151], v[208:211]
    v_mfma_f32_16x16x32_bf16 v[212:215], a[184:187], v[148:151], v[212:215]
    buffer_load_dwordx4 v[196:199], v2, s[8:11], s81 offen offset:1024 sc1
    v_mfma_f32_16x16x32_bf16 v[216:219], a[188:191], v[148:151], v[216:219]
    v_mfma_f32_16x16x32_bf16 v[220:223], a[192:195], v[148:151], v[220:223]
    v_mfma_f32_16x16x32_bf16 v[224:227], a[196:199], v[148:151], v[224:227]
    s_waitcnt vmcnt(11)
    v_mfma_f32_16x16x32_bf16 v[208:211], a[200:203], v[152:155], v[208:211]
    v_mfma_f32_16x16x32_bf16 v[212:215], a[204:207], v[152:155], v[212:215]
    buffer_load_dwordx4 v[200:203], v2, s[8:11], s81 offen offset:2048 sc1
    v_mfma_f32_16x16x32_bf16 v[216:219], a[208:211], v[152:155], v[216:219]
    v_mfma_f32_16x16x32_bf16 v[220:223], a[212:215], v[152:155], v[220:223]
    v_mfma_f32_16x16x32_bf16 v[224:227], a[216:219], v[152:155], v[224:227]
    s_waitcnt vmcnt(11)
    v_mfma_f32_16x16x32_bf16 v[208:211], a[220:223], v[156:159], v[208:211]
    v_mfma_f32_16x16x32_bf16 v[212:215], a[224:227], v[156:159], v[212:215]
    buffer_load_dwordx4 v[204:207], v2, s[8:11], s81 offen offset:3072 sc1
    v_mfma_f32_16x16x32_bf16 v[216:219], a[228:231], v[156:159], v[216:219]
    v_mfma_f32_16x16x32_bf16 v[220:223], a[232:235], v[156:159], v[220:223]
    v_mfma_f32_16x16x32_bf16 v[224:227], a[236:239], v[156:159], v[224:227]
    s_waitcnt vmcnt(11)
    v_mfma_f32_16x16x32_bf16 v[228:231], a[0:3], v[160:163], 0
    v_mfma_f32_16x16x32_bf16 v[232:235], a[4:7], v[160:163], 0
    v_mfma_f32_16x16x32_bf16 v[236:239], a[8:11], v[160:163], 0
    v_mfma_f32_16x16x32_bf16 v[240:243], a[12:15], v[160:163], 0
    v_mfma_f32_16x16x32_bf16 v[244:247], a[16:19], v[160:163], 0
    s_waitcnt vmcnt(10)
    v_mfma_f32_16x16x32_bf16 v[228:231], a[20:23], v[164:167], v[228:231]
    v_mfma_f32_16x16x32_bf16 v[232:235], a[24:27], v[164:167], v[232:235]
    v_mfma_f32_16x16x32_bf16 v[236:239], a[28:31], v[164:167], v[236:239]
    v_mfma_f32_16x16x32_bf16 v[240:243], a[32:35], v[164:167], v[240:243]
    v_mfma_f32_16x16x32_bf16 v[244:247], a[36:39], v[164:167], v[244:247]
    ds_write_b128 v250, v[208:211] offset:0
    s_waitcnt vmcnt(9)
    v_mfma_f32_16x16x32_bf16 v[228:231], a[40:43], v[168:171], v[228:231]
    v_mfma_f32_16x16x32_bf16 v[232:235], a[44:47], v[168:171], v[232:235]
    v_mfma_f32_16x16x32_bf16 v[236:239], a[48:51], v[168:171], v[236:239]
    v_mfma_f32_16x16x32_bf16 v[240:243], a[52:55], v[168:171], v[240:243]
    v_mfma_f32_16x16x32_bf16 v[244:247], a[56:59], v[168:171], v[244:247]
    ds_write_b128 v250, v[212:215] offset:1024
    s_waitcnt vmcnt(8)
    v_mfma_f32_16x16x32_bf16 v[228:231], a[60:63], v[172:175], v[228:231]
    v_mfma_f32_16x16x32_bf16 v[232:235], a[64:67], v[172:175], v[232:235]
    v_mfma_f32_16x16x32_bf16 v[236:239], a[68:71], v[172:175], v[236:239]
    v_mfma_f32_16x16x32_bf16 v[240:243], a[72:75], v[172:175], v[240:243]
    v_mfma_f32_16x16x32_bf16 v[244:247], a[76:79], v[172:175], v[244:247]
    ds_write_b128 v250, v[216:219] offset:2048
    s_waitcnt vmcnt(7)
    v_mfma_f32_16x16x32_bf16 v[228:231], a[80:83], v[176:179], v[228:231]
    v_mfma_f32_16x16x32_bf16 v[232:235], a[84:87], v[176:179], v[232:235]
    v_mfma_f32_16x16x32_bf16 v[236:239], a[88:91], v[176:179], v[236:239]
    v_mfma_f32_16x16x32_bf16 v[240:243], a[92:95], v[176:179], v[240:243]
    v_mfma_f32_16x16x32_bf16 v[244:247], a[96:99], v[176:179], v[244:247]
    ds_write_b128 v250, v[220:223] offset:3072
    s_waitcnt vmcnt(6)
    v_mfma_f32_16x16x32_bf16 v[228:231], a[100:103], v[180:183], v[228:231]
    v_mfma_f32_16x16x32_bf16 v[232:235], a[104:107], v[180:183], v[232:235]
    v_mfma_f32_16x16x32_bf16 v[236:239], a[108:111], v[180:183], v[236:239]
    v_mfma_f32_16x16x32_bf16 v[240:243], a[112:115], v[180:183], v[240:243]
    v_mfma_f32_16x16x32_bf16 v[244:247], a[116:119], v[180:183], v[244:247]
    ds_write_b128 v250, v[224:227] offset:4096
    s_waitcnt vmcnt(5)
    v_mfma_f32_16x16x32_bf16 v[228:231], a[120:123], v[184:187], v[228:231]
    v_mfma_f32_16x16x32_bf16 v[232:235], a[124:127], v[184:187], v[232:235]
    v_mfma_f32_16x16x32_bf16 v[236:239], a[128:131], v[184:187], v[236:239]
    v_mfma_f32_16x16x32_bf16 v[240:243], a[132:135], v[184:187], v[240:243]
    v_mfma_f32_16x16x32_bf16 v[244:247], a[136:139], v[184:187], v[244:247]
    s_waitcnt vmcnt(4)
    v_mfma_f32_16x16x32_bf16 v[228:231], a[140:143], v[188:191], v[228:231]
    v_mfma_f32_16x16x32_bf16 v[232:235], a[144:147], v[188:191], v[232:235]
    v_mfma_f32_16x16x32_bf16 v[236:239], a[148:151], v[188:191], v[236:239]
    v_mfma_f32_16x16x32_bf16 v[240:243], a[152:155], v[188:191], v[240:243]
    v_mfma_f32_16x16x32_bf16 v[244:247], a[156:159], v[188:191], v[244:247]
    s_waitcnt vmcnt(3)
    v_mfma_f32_16x16x32_bf16 v[228:231], a[160:163], v[192:195], v[228:231]
    v_mfma_f32_16x16x32_bf16 v[232:235], a[164:167], v[192:195], v[232:235]
    v_mfma_f32_16x16x32_bf16 v[236:239], a[168:171], v[192:195], v[236:239]
    v_mfma_f32_16x16x32_bf16 v[240:243], a[172:175], v[192:195], v[240:243]
    v_mfma_f32_16x16x32_bf16 v[244:247], a[176:179], v[192:195], v[244:247]
    s_waitcnt vmcnt(2)
    v_mfma_f32_16x16x32_bf16 v[228:231], a[180:183], v[196:199], v[228:231]
    v_mfma_f32_16x16x32_bf16 v[232:235], a[184:187], v[196:199], v[232:235]
    v_mfma_f32_16x16x32_bf16 v[236:239], a[188:191], v[196:199], v[236:239]
    v_mfma_f32_16x16x32_bf16 v[240:243], a[192:195], v[196:199], v[240:243]
    v_mfma_f32_16x16x32_bf16 v[244:247], a[196:199], v[196:199], v[244:247]
    s_waitcnt vmcnt(1)
    v_mfma_f32_16x16x32_bf16 v[228:231], a[200:203], v[200:203], v[228:231]
    v_mfma_f32_16x16x32_bf16 v[232:235], a[204:207], v[200:203], v[232:235]
    v_mfma_f32_16x16x32_bf16 v[236:239], a[208:211], v[200:203], v[236:239]
    v_mfma_f32_16x16x32_bf16 v[240:243], a[212:215], v[200:203], v[240:243]
    v_mfma_f32_16x16x32_bf16 v[244:247], a[216:219], v[200:203], v[244:247]
    s_waitcnt vmcnt(0)
    v_mfma_f32_16x16x32_bf16 v[228:231], a[220:223], v[204:207], v[228:231]
    v_mfma_f32_16x16x32_bf16 v[232:235], a[224:227], v[204:207], v[232:235]
    v_mfma_f32_16x16x32_bf16 v[236:239], a[228:231], v[204:207], v[236:239]
    v_mfma_f32_16x16x32_bf16 v[240:243], a[232:235], v[204:207], v[240:243]
    v_mfma_f32_16x16x32_bf16 v[244:247], a[236:239], v[204:207], v[244:247]
L_dl_p5_j:
    s_waitcnt lgkmcnt(0)
    s_barrier
    ds_read_b128 v[32:35], v251 offset:0
    ds_read_b128 v[36:39], v251 offset:1024
    ds_read_b128 v[40:43], v251 offset:2048
    ds_read_b128 v[44:47], v251 offset:3072
    ds_read_b128 v[48:51], v251 offset:4096
    ds_read_b128 v[52:55], v251 offset:5120
    ds_read_b128 v[56:59], v251 offset:6144
    ds_read_b128 v[60:63], v251 offset:7168
    ds_read_b128 v[64:67], v251 offset:8192
    ds_read_b128 v[68:71], v251 offset:9216
    ds_read_b128 v[72:75], v251 offset:10240
    ds_read_b128 v[76:79], v251 offset:11264
    ds_read_b128 v[80:83], v251 offset:12288
    ds_read_b128 v[84:87], v251 offset:13312
    ds_read_b128 v[88:91], v251 offset:14336
    s_waitcnt lgkmcnt(14)
    v_pk_add_f32 v[228:229], v[228:229], v[32:33]
    v_pk_add_f32 v[230:231], v[230:231], v[34:35]
    s_waitcnt lgkmcnt(13)
    v_pk_add_f32 v[232:233], v[232:233], v[36:37]
    v_pk_add_f32 v[234:235], v[234:235], v[38:39]
    s_waitcnt lgkmcnt(12)
    v_pk_add_f32 v[236:237], v[236:237], v[40:41]
    v_pk_add_f32 v[238:239], v[238:239], v[42:43]
    s_waitcnt lgkmcnt(11)
    v_pk_add_f32 v[240:241], v[240:241], v[44:45]
    v_pk_add_f32 v[242:243], v[242:243], v[46:47]
    s_waitcnt lgkmcnt(10)
    v_pk_add_f32 v[244:245], v[244:245], v[48:49]
    v_pk_add_f32 v[246:247], v[246:247], v[50:51]
    s_waitcnt lgkmcnt(9)
    v_pk_add_f32 v[228:229], v[228:229], v[52:53]
    v_pk_add_f32 v[230:231], v[230:231], v[54:55]
    s_waitcnt lgkmcnt(8)
    v_pk_add_f32 v[232:233], v[232:233], v[56:57]
    v_pk_add_f32 v[234:235], v[234:235], v[58:59]
    s_waitcnt lgkmcnt(7)
    v_pk_add_f32 v[236:237], v[236:237], v[60:61]
    v_pk_add_f32 v[238:239], v[238:239], v[62:63]
    s_waitcnt lgkmcnt(6)
    v_pk_add_f32 v[240:241], v[240:241], v[64:65]
    v_pk_add_f32 v[242:243], v[242:243], v[66:67]
    s_waitcnt lgkmcnt(5)
    v_pk_add_f32 v[244:245], v[244:245], v[68:69]
    v_pk_add_f32 v[246:247], v[246:247], v[70:71]
    s_waitcnt lgkmcnt(4)
    v_pk_add_f32 v[228:229], v[228:229], v[72:73]
    v_pk_add_f32 v[230:231], v[230:231], v[74:75]
    s_waitcnt lgkmcnt(3)
    v_pk_add_f32 v[232:233], v[232:233], v[76:77]
    v_pk_add_f32 v[234:235], v[234:235], v[78:79]
    s_waitcnt lgkmcnt(2)
    v_pk_add_f32 v[236:237], v[236:237], v[80:81]
    v_pk_add_f32 v[238:239], v[238:239], v[82:83]
    s_waitcnt lgkmcnt(1)
    v_pk_add_f32 v[240:241], v[240:241], v[84:85]
    v_pk_add_f32 v[242:243], v[242:243], v[86:87]
    s_waitcnt lgkmcnt(0)
    v_pk_add_f32 v[244:245], v[244:245], v[88:89]
    v_pk_add_f32 v[246:247], v[246:247], v[90:91]
    v_lshlrev_b32 v120, 16, v6
    v_and_b32 v121, 0xffff0000, v6
    v_lshlrev_b32 v122, 16, v16
    v_and_b32 v123, 0xffff0000, v16
    v_pk_add_f32 v[228:229], v[228:229], v[122:123]
    v_pk_add_f32 v[228:229], v[228:229], v[120:121]
    v_cvt_pk_bf16_f32 v6, v228, v229
    v_lshlrev_b32 v124, 16, v7
    v_and_b32 v125, 0xffff0000, v7
    v_lshlrev_b32 v126, 16, v17
    v_and_b32 v127, 0xffff0000, v17
    v_pk_add_f32 v[230:231], v[230:231], v[126:127]
    v_pk_add_f32 v[230:231], v[230:231], v[124:125]
    v_cvt_pk_bf16_f32 v7, v230, v231
    v_lshlrev_b32 v120, 16, v8
    v_and_b32 v121, 0xffff0000, v8
    v_lshlrev_b32 v122, 16, v18
    v_and_b32 v123, 0xffff0000, v18
    v_pk_add_f32 v[232:233], v[232:233], v[122:123]
    v_pk_add_f32 v[232:233], v[232:233], v[120:121]
    v_cvt_pk_bf16_f32 v8, v232, v233
    v_lshlrev_b32 v124, 16, v9
    v_and_b32 v125, 0xffff0000, v9
    v_lshlrev_b32 v126, 16, v19
    v_and_b32 v127, 0xffff0000, v19
    v_pk_add_f32 v[234:235], v[234:235], v[126:127]
    v_pk_add_f32 v[234:235], v[234:235], v[124:125]
    v_cvt_pk_bf16_f32 v9, v234, v235
    v_lshlrev_b32 v120, 16, v10
    v_and_b32 v121, 0xffff0000, v10
    v_lshlrev_b32 v122, 16, v20
    v_and_b32 v123, 0xffff0000, v20
    v_pk_add_f32 v[236:237], v[236:237], v[122:123]
    v_pk_add_f32 v[236:237], v[236:237], v[120:121]
    v_cvt_pk_bf16_f32 v10, v236, v237
    v_lshlrev_b32 v124, 16, v11
    v_and_b32 v125, 0xffff0000, v11
    v_lshlrev_b32 v126, 16, v21
    v_and_b32 v127, 0xffff0000, v21
    v_pk_add_f32 v[238:239], v[238:239], v[126:127]
    v_pk_add_f32 v[238:239], v[238:239], v[124:125]
    v_cvt_pk_bf16_f32 v11, v238, v239
    v_lshlrev_b32 v120, 16, v12
    v_and_b32 v121, 0xffff0000, v12
    v_lshlrev_b32 v122, 16, v22
    v_and_b32 v123, 0xffff0000, v22
    v_pk_add_f32 v[240:241], v[240:241], v[122:123]
    v_pk_add_f32 v[240:241], v[240:241], v[120:121]
    v_cvt_pk_bf16_f32 v12, v240, v241
    v_lshlrev_b32 v124, 16, v13
    v_and_b32 v125, 0xffff0000, v13
    v_lshlrev_b32 v126, 16, v23
    v_and_b32 v127, 0xffff0000, v23
    v_pk_add_f32 v[242:243], v[242:243], v[126:127]
    v_pk_add_f32 v[242:243], v[242:243], v[124:125]
    v_cvt_pk_bf16_f32 v13, v242, v243
    v_lshlrev_b32 v120, 16, v14
    v_and_b32 v121, 0xffff0000, v14
    v_lshlrev_b32 v122, 16, v24
    v_and_b32 v123, 0xffff0000, v24
    v_pk_add_f32 v[244:245], v[244:245], v[122:123]
    v_pk_add_f32 v[244:245], v[244:245], v[120:121]
    v_cvt_pk_bf16_f32 v14, v244, v245
    v_lshlrev_b32 v124, 16, v15
    v_and_b32 v125, 0xffff0000, v15
    v_lshlrev_b32 v126, 16, v25
    v_and_b32 v127, 0xffff0000, v25
    v_pk_add_f32 v[246:247], v[246:247], v[126:127]
    v_pk_add_f32 v[246:247], v[246:247], v[124:125]
    v_cvt_pk_bf16_f32 v15, v246, v247
    s_cmp_eq_u32 s29, 1
    s_cbranch_scc1 L_final_x2
    buffer_store_dwordx2 v[6:7], v0, s[8:11], s76 offen offset:0 sc1
    buffer_store_dwordx2 v[8:9], v0, s[8:11], s76 offen offset:1024 sc1
    buffer_store_dwordx2 v[10:11], v0, s[8:11], s76 offen offset:2048 sc1
    buffer_store_dwordx2 v[12:13], v0, s[8:11], s76 offen offset:3072 sc1
    buffer_store_dwordx2 v[14:15], v0, s[8:11], s77 offen sc1
    s_mov_b32 s32, 0x3f803f80
    v_dot2_f32_bf16 v128, v6, s32, 0
    v_dot2_f32_bf16 v130, v6, v6, 0
    v_dot2_f32_bf16 v129, v7, s32, 0
    v_dot2_f32_bf16 v131, v7, v7, 0
    v_dot2_f32_bf16 v128, v8, s32, v128
    v_dot2_f32_bf16 v130, v8, v8, v130
    v_dot2_f32_bf16 v129, v9, s32, v129
    v_dot2_f32_bf16 v131, v9, v9, v131
    v_dot2_f32_bf16 v128, v10, s32, v128
    v_dot2_f32_bf16 v130, v10, v10, v130
    v_dot2_f32_bf16 v129, v11, s32, v129
    v_dot2_f32_bf16 v131, v11, v11, v131
    v_dot2_f32_bf16 v128, v12, s32, v128
    v_dot2_f32_bf16 v130, v12, v12, v130
    v_dot2_f32_bf16 v129, v13, s32, v129
    v_dot2_f32_bf16 v131, v13, v13, v131
    v_dot2_f32_bf16 v128, v14, s32, v128
    v_dot2_f32_bf16 v130, v14, v14, v130
    v_dot2_f32_bf16 v129, v15, s32, v129
    v_dot2_f32_bf16 v131, v15, v15, v131
    s_nop 1
    v_add_f32 v128, v128, v129
    v_add_f32 v129, v130, v131
    v_mov_b32 v130, v128
    v_mov_b32 v131, v129
    s_nop 0
    v_permlane32_swap_b32 v128, v130
    v_permlane32_swap_b32 v129, v131
    v_pk_add_f32 v[128:129], v[128:129], v[130:131]
    v_mov_b32 v130, v128
    v_mov_b32 v131, v129
    s_nop 0
    v_permlane16_swap_b32 v128, v130
    v_permlane16_swap_b32 v129, v131
    v_pk_add_f32 v[128:129], v[128:129], v[130:131]
    s_mov_b64 exec, 0xffff
    buffer_store_dwordx2 v[128:129], v5, s[8:11], s78 offen sc1
    s_mov_b64 exec, -1
    s_lshl_b32 s35, s25, 6
    s_add_u32 s35, s35, s26
    s_lshl_b32 s36, s29, 2
    s_add_u32 s36, s36, s30
    s_add_u32 s36, s36, 4
    s_waitcnt vmcnt(0)
    s_barrier
    s_cmp_lg_u32 s24, 0
    s_cbranch_scc1 L_fl_row_x2
    s_lshl_b32 s32, s35, 2
    s_add_u32 s32, s32, 4096
    v_mov_b32 v254, s36
    v_mov_b32 v255, 0
    s_mov_b64 s[64:65], exec
    s_mov_b64 exec, 1
    s_cmp_eq_u32 s84, 1
    s_cbranch_scc1 L_fl_row_x2_f
    buffer_store_dword v254, v255, s[8:11], s32 offen sc1
    s_branch L_fl_row_x2_j
L_fl_row_x2_f:
    buffer_store_dword v254, v255, s[8:11], s32 offen
L_fl_row_x2_j:
    s_mov_b64 exec, s[64:65]
L_fl_row_x2:
    s_branch L_final_j_x2
L_final_x2:
    s_lshl_b32 s32, s25, 7
    s_lshl_b32 s33, s27, 6
    s_add_u32 s32, s32, s33
    s_lshl_b32 s33, s24, 4
    s_add_u32 s32, s32, s33
    v_and_b32 v128, 15, v1
    v_add_u32 v128, s32, v128
    v_mul_u32_u24 v128, 1280, v128
    v_lshrrev_b32 v129, 4, v1
    v_lshlrev_b32 v129, 3, v129
    v_add_u32 v128, v128, v129
    s_mul_i32 s33, s28, 160
    s_mov_b32 s16, s56
    s_and_b32 s17, s57, 0xffff
    buffer_store_dwordx2 v[6:7], v128, s[16:19], s33 offen offset:0
    buffer_store_dwordx2 v[8:9], v128, s[16:19], s33 offen offset:32
    buffer_store_dwordx2 v[10:11], v128, s[16:19], s33 offen offset:64
    buffer_store_dwordx2 v[12:13], v128, s[16:19], s33 offen offset:96
    buffer_store_dwordx2 v[14:15], v128, s[16:19], s33 offen offset:128
L_final_j_x2:
    s_cmp_eq_u32 s29, 1
    s_cbranch_scc1 L_fin
    s_add_u32 s29, s29, 1
    s_mov_b32 s6, 0
    s_branch L_layer
L_fin:
    s_waitcnt vmcnt(0) lgkmcnt(0)
    s_branch L_end
L_end:
    s_endpgm
.section .rodata,"a"
.p2align 6
.amdhsa_kernel interleave_layers__linear_kernel_hedgehog__mixer_channel_mlp__prompt_kernel
  .amdhsa_next_free_vgpr 512
  .amdhsa_next_free_sgpr 102
  .amdhsa_accum_offset 256
  .amdhsa_group_segment_fixed_size 0
  .amdhsa_kernarg_size 96
  .amdhsa_user_sgpr_count 2
  .amdhsa_user_sgpr_kernarg_segment_ptr 1
  .amdhsa_system_sgpr_workgroup_id_x 1
.end_amdhsa_kernel
```
